```python
import torch

def _softmax(x, axis=-1):
    return torch.softmax(x, dim=axis)

def _gelu(x):
    return torch.nn.functional.gelu(x, approximate='tanh')

def _silu(x):
    return torch.nn.functional.silu(x)

def _sigmoid(x):
    return torch.sigmoid(x)

def _layernorm(x, axis=-1, eps=1e-05):
    m = x.mean(dim=axis, keepdim=True)
    v = x.var(dim=axis, keepdim=True, unbiased=False)
    return (x - m) / torch.sqrt(v + eps)

def _scatter_add(tgt, idx, src, axis=0):
    return tgt.clone().index_add_(axis, idx, src)

def _segment_sum(src, seg, n):
    out = torch.zeros((n,) + src.shape[1:], dtype=src.dtype)
    return out.index_add_(0, seg, src)

def _pad(x, pw):
    flat = tuple((v for pair in reversed(pw) for v in pair))
    return torch.nn.functional.pad(x, flat)
kernel_name = 'adaLN_cond__ssm_conv_s4__glu_gated_swiglu__prompt'

def setup_inputs():

    _w = lambda a: (lambda t: t.to(torch.bfloat16) if t.is_floating_point() else t)(torch.as_tensor(a))

    def _A_setup():
        B, L, D, N = (1, 2048, 576, 128)
        A_re = -(lambda _x: torch.exp(torch.as_tensor(_x)))((lambda *s: torch.randn(*s, dtype=torch.bfloat16) * 3.2)(D, N))
        A_im = torch.pi * (lambda *s: torch.randn(*s, dtype=torch.bfloat16) * 0.1)(D, N)
        B_re = (lambda *s: torch.randn(*s, dtype=torch.bfloat16) * 0.1)(D, N)
        B_im = (lambda *s: torch.randn(*s, dtype=torch.bfloat16) * 0.1)(D, N)
        C_re = (lambda *s: torch.randn(*s, dtype=torch.bfloat16) * 0.1)(D, N)
        C_im = (lambda *s: torch.randn(*s, dtype=torch.bfloat16) * 0.1)(D, N)
        log_dt = (lambda *s: torch.randn(*s, dtype=torch.bfloat16) * 0.1)(D) * 0.5 - 4.0
        Dskip = (lambda *s: torch.randn(*s, dtype=torch.bfloat16) * 0.1)(D)
        return {'u': _w((lambda *s: torch.randn(*s, dtype=torch.bfloat16) * 0.05)(B, L, D)), 'A_re': _w(A_re), 'A_im': _w(A_im), 'B_re': _w(B_re), 'B_im': _w(B_im), 'C_re': _w(C_re), 'C_im': _w(C_im), 'log_dt': _w(log_dt), 'Dskip': _w(Dskip)}
    _A_in = _A_setup()

    def _B_setup():
        B, S, D, F = (1, 2048, 576, 4608)
        return {'x': _w((lambda *s: torch.randn(*s, dtype=torch.bfloat16) * 0.05)(B, S, D)), 'w1': _w((lambda *s: torch.randn(*s, dtype=torch.bfloat16) * 1.6)(D, F) * (2.0 / D) ** 0.5), 'w3': _w((lambda *s: torch.randn(*s, dtype=torch.bfloat16) * 1.6)(D, F) * (2.0 / D) ** 0.5), 'w2': _w((lambda *s: torch.randn(*s, dtype=torch.bfloat16) * 1.6)(F, D) * (2.0 / F) ** 0.5)}
    _B_in = _B_setup()
    return {'A_u': _A_in['u'], 'A_A_re': _A_in['A_re'], 'A_A_im': _A_in['A_im'], 'A_B_re': _A_in['B_re'], 'A_B_im': _A_in['B_im'], 'A_C_re': _A_in['C_re'], 'A_C_im': _A_in['C_im'], 'A_log_dt': _A_in['log_dt'], 'A_Dskip': _A_in['Dskip'], 'B_x': _B_in['x'], 'B_w1': _B_in['w1'], 'B_w3': _B_in['w3'], 'B_w2': _B_in['w2'], 'c': _w((lambda *s: torch.randn(*s, dtype=torch.bfloat16) * 0.4)(1, 576) * 8.0), 'w_mod': _w((lambda *s: torch.randn(*s, dtype=torch.bfloat16) * 0.4)(576, 6 * 576) * 576 ** (-0.5) * 8.0)}

def reference(A_u, A_A_re, A_A_im, A_B_re, A_B_im, A_C_re, A_C_im, A_log_dt, A_Dskip, B_x, B_w1, B_w3, B_w2, c, w_mod):

    def _A_ref(u, A_re, A_im, B_re, B_im, C_re, C_im, log_dt, Dskip):
        Bsz, L, D = u.shape
        dt = torch.exp(log_dt)[:, None]
        A = A_re + 1j * A_im
        Bc = B_re + 1j * B_im
        Cc = C_re + 1j * C_im
        logdA = dt * A
        dB = dt * Bc
        l = (lambda x, dt: x.to(dt))(torch.arange(L), A_re.dtype)
        P = torch.exp(logdA[:, :, None] * l[None, None, :])
        K = torch.einsum('dn,dnl,dn->dl', Cc, P, dB).real
        L2 = 2 * L
        Kp = _pad(K, ((0, 0), (0, L)))
        up = (lambda x, *d: x.permute(*d))(u, 0, 2, 1)
        up = _pad(up, ((0, 0), (0, 0), (0, L)))
        Kf = (lambda x, axes=(-2, -1): torch.fft.rfft2(x.float(), dim=axes))(Kp[:, None, :], axes=(-2, -1))
        Uf = (lambda x, axes=(-2, -1): torch.fft.rfft2(x.float(), dim=axes))(up[:, :, None, :], axes=(-2, -1))
        Yf = Uf * Kf[None, :, :, :]
        y = (lambda x, s, axes=(-2, -1): torch.fft.irfft2(x, s=s, dim=axes).to(torch.bfloat16))(Yf, (1, L2), axes=(-2, -1))[:, :, 0, :L]
        y = (lambda x, *d: x.permute(*d))(y, 0, 2, 1) + u * Dskip[None, None, :]
        return y

    def _B_ref(x, w1, w3, w2):
        gate = torch.einsum('bsd,df->bsf', x, w1)
        up = torch.einsum('bsd,df->bsf', x, w3)
        h = _silu(gate) * up
        out = torch.einsum('bsf,fd->bsd', h, w2)
        return out
    x = A_u
    mod = (_silu(c) @ w_mod).reshape(c.shape[0], 6, 1, -1)
    sa, ca, ga, sb, cb, gb = (mod[:, 0].clone(), mod[:, 1].clone(), mod[:, 2].clone(), mod[:, 3].clone(), mod[:, 4].clone(), mod[:, 5].clone())
    h = _layernorm(x, axis=-1) * (1 + ca) + sa
    x = x + ga * _A_ref(h, A_A_re, A_A_im, A_B_re, A_B_im, A_C_re, A_C_im, A_log_dt, A_Dskip)
    h = _layernorm(x, axis=-1) * (1 + cb) + sb
    x = x + gb * _B_ref(h, B_w1, B_w3, B_w2)
    return x
```

```asm
; @launch kernel=k1_kernel grid=(894,1,1) block=(256,1,1) lds=36864
; @launch kernel=k2_kernel grid=(576,1,1) block=(256,1,1) lds=45712
; @launch kernel=k34_kernel grid=(256,1,1) block=(256,1,1) lds=147472
.amdgcn_target "amdgcn-amd-amdhsa--gfx950"
.text
.globl k1_kernel
.p2align 8
.type k1_kernel,@function
k1_kernel:

    s_add_u32 s3, s2, 310
    s_sub_u32 s4, s2, 522
    s_sub_u32 s5, s2, 832
    s_cmp_lt_u32 s2, 886
    s_cselect_b32 s5, s5, s2
    s_cmp_lt_u32 s2, 832
    s_cselect_b32 s4, s4, s5
    s_cmp_lt_u32 s2, 576
    s_cselect_b32 s2, s3, s4
    s_cmp_lt_u32 s2, 54
    s_cbranch_scc1 K1_MOD
    s_cmp_lt_u32 s2, 310
    s_cbranch_scc1 K1_LN
    s_cmp_lt_u32 s2, 886
    s_cbranch_scc1 K1_KG
    s_cmp_ge_u32 s2, 894
    s_cbranch_scc1 K1_END
    s_load_dwordx2 s[4:5], s[0:1], 136
    s_load_dwordx2 s[8:9], s[0:1], 80
    s_load_dwordx2 s[12:13], s[0:1], 88
    s_load_dwordx2 s[16:17], s[0:1], 96
    s_load_dwordx2 s[20:21], s[0:1], 120
    v_lshlrev_b32 v1, 21, v0
    s_waitcnt lgkmcnt(0)
    s_add_u32 s24, s4, 0x4000000
    s_addc_u32 s25, s5, 0
    s_mov_b32 s26, 0x492000
    s_mov_b32 s27, 0x20000
    s_mov_b32 s6, 0x3510000
    s_mov_b32 s7, 0x20000
    s_mov_b32 s10, 0x510000
    s_mov_b32 s11, 0x20000
    s_mov_b32 s14, 0x510000
    s_mov_b32 s15, 0x20000
    s_mov_b32 s18, 0x510000
    s_mov_b32 s19, 0x20000
    s_mov_b32 s22, 0x240000
    s_mov_b32 s23, 0x20000
    buffer_load_dword v8, v1, s[4:7], 0 offen
    buffer_load_dword v9, v1, s[24:27], 0 offen
    buffer_load_dword v10, v1, s[8:11], 0 offen
    buffer_load_dword v11, v1, s[12:15], 0 offen
    buffer_load_dword v12, v1, s[16:19], 0 offen
    buffer_load_dword v13, v1, s[20:23], 0 offen
    s_sub_u32 s30, s2, 886
    s_cmp_ge_u32 s30, 7
    s_cbranch_scc1 K1_TW_E
    s_add_u32 s32, s4, 0x980000
    s_addc_u32 s33, s5, 0
    s_mov_b32 s34, 0x240000
    s_mov_b32 s35, 0x20000
    s_mul_i32 s31, s30, 9
    s_cmp_gt_u32 s30, 0
    s_addc_u32 s31, s31, 0
    s_mul_i32 s31, s31, 36864
    v_mov_b32 v40, -1
    v_mov_b32 v41, -1
    v_mov_b32 v42, -1
    v_mov_b32 v43, -1
    v_lshlrev_b32 v3, 4, v0
    buffer_store_dwordx4 v[40:43], v3, s[32:35], s31 offen
    s_add_u32 s31, s31, 4096
    buffer_store_dwordx4 v[40:43], v3, s[32:35], s31 offen
    s_add_u32 s31, s31, 4096
    buffer_store_dwordx4 v[40:43], v3, s[32:35], s31 offen
    s_add_u32 s31, s31, 4096
    buffer_store_dwordx4 v[40:43], v3, s[32:35], s31 offen
    s_add_u32 s31, s31, 4096
    buffer_store_dwordx4 v[40:43], v3, s[32:35], s31 offen
    s_add_u32 s31, s31, 4096
    buffer_store_dwordx4 v[40:43], v3, s[32:35], s31 offen
    s_add_u32 s31, s31, 4096
    buffer_store_dwordx4 v[40:43], v3, s[32:35], s31 offen
    s_add_u32 s31, s31, 4096
    buffer_store_dwordx4 v[40:43], v3, s[32:35], s31 offen
    s_add_u32 s31, s31, 4096
    buffer_store_dwordx4 v[40:43], v3, s[32:35], s31 offen
    s_nop 1
K1_TW_E:
    s_waitcnt vmcnt(0)
    s_endpgm
K1_MOD:
    s_load_dwordx2 s[4:5], s[0:1], 112
    s_load_dwordx2 s[8:9], s[0:1], 104
    s_load_dwordx2 s[12:13], s[0:1], 136
    v_and_b32 v1, 7, v0
    v_lshrrev_b32 v2, 3, v0
    v_mul_u32_u24 v3, 36, v2
    v_mul_u32_u24 v4, 124416, v2
    v_lshl_add_u32 v4, v1, 4, v4
    s_lshl_b32 s3, s2, 7
    v_add_u32 v4, s3, v4
    s_waitcnt lgkmcnt(0)
    s_add_u32 s40, s12, 0x10000
    s_addc_u32 s41, s13, 0
    s_mov_b32 s42, 0x7000
    s_mov_b32 s43, 0x20000
    s_mov_b32 s6, 0x3cc000
    s_mov_b32 s7, 0x20000
    s_mov_b32 s10, 0x480
    s_mov_b32 s11, 0x20000
    s_mov_b32 s14, 0x3600
    s_mov_b32 s15, 0x20000
    v_mov_b32 v112, 0
    v_mov_b32 v113, 0
    v_mov_b32 v114, 0
    v_mov_b32 v115, 0
    v_lshlrev_b32 v116, 4, v0
    s_lshl_b32 s44, s2, 12
    v_add_u32 v116, s44, v116
    buffer_store_dwordx4 v[112:115], v116, s[40:43], 0 offen
    buffer_load_dwordx4 v[8:11], v3, s[8:11], 0 offen
    buffer_load_dwordx4 v[12:15], v3, s[8:11], 0 offen offset:16
    buffer_load_dword v16, v3, s[8:11], 0 offen offset:32
    s_mov_b32 s16, 0
    buffer_load_dwordx4 v[20:23], v4, s[4:7], s16 offen
    s_mov_b32 s17, 6912
    buffer_load_dwordx4 v[24:27], v4, s[4:7], s17 offen
    s_mov_b32 s18, 13824
    buffer_load_dwordx4 v[28:31], v4, s[4:7], s18 offen
    s_mov_b32 s19, 20736
    buffer_load_dwordx4 v[32:35], v4, s[4:7], s19 offen
    s_mov_b32 s20, 27648
    buffer_load_dwordx4 v[36:39], v4, s[4:7], s20 offen
    s_mov_b32 s21, 34560
    buffer_load_dwordx4 v[40:43], v4, s[4:7], s21 offen
    s_mov_b32 s22, 41472
    buffer_load_dwordx4 v[44:47], v4, s[4:7], s22 offen
    s_mov_b32 s23, 48384
    buffer_load_dwordx4 v[48:51], v4, s[4:7], s23 offen
    s_mov_b32 s24, 55296
    buffer_load_dwordx4 v[52:55], v4, s[4:7], s24 offen
    s_mov_b32 s25, 62208
    buffer_load_dwordx4 v[56:59], v4, s[4:7], s25 offen
    s_mov_b32 s26, 69120
    buffer_load_dwordx4 v[60:63], v4, s[4:7], s26 offen
    s_mov_b32 s27, 76032
    buffer_load_dwordx4 v[64:67], v4, s[4:7], s27 offen
    s_mov_b32 s28, 82944
    buffer_load_dwordx4 v[68:71], v4, s[4:7], s28 offen
    s_mov_b32 s29, 89856
    buffer_load_dwordx4 v[72:75], v4, s[4:7], s29 offen
    s_mov_b32 s30, 96768
    buffer_load_dwordx4 v[76:79], v4, s[4:7], s30 offen
    s_mov_b32 s31, 103680
    buffer_load_dwordx4 v[80:83], v4, s[4:7], s31 offen
    s_mov_b32 s32, 110592
    buffer_load_dwordx4 v[84:87], v4, s[4:7], s32 offen
    s_mov_b32 s33, 117504
    buffer_load_dwordx4 v[88:91], v4, s[4:7], s33 offen
    s_waitcnt vmcnt(18)
    v_lshlrev_b32 v92, 16, v8
    v_and_b32 v93, 0xffff0000, v8
    v_lshlrev_b32 v94, 16, v9
    v_and_b32 v95, 0xffff0000, v9
    v_lshlrev_b32 v96, 16, v10
    v_and_b32 v97, 0xffff0000, v10
    v_lshlrev_b32 v98, 16, v11
    v_and_b32 v99, 0xffff0000, v11
    v_lshlrev_b32 v100, 16, v12
    v_and_b32 v101, 0xffff0000, v12
    v_lshlrev_b32 v102, 16, v13
    v_and_b32 v103, 0xffff0000, v13
    v_lshlrev_b32 v104, 16, v14
    v_and_b32 v105, 0xffff0000, v14
    v_lshlrev_b32 v106, 16, v15
    v_and_b32 v107, 0xffff0000, v15
    v_lshlrev_b32 v108, 16, v16
    v_and_b32 v109, 0xffff0000, v16
    v_mul_f32 v110, 0xbfb8aa3b, v92
    v_mul_f32 v111, 0xbfb8aa3b, v93
    v_mul_f32 v112, 0xbfb8aa3b, v94
    v_mul_f32 v113, 0xbfb8aa3b, v95
    v_mul_f32 v114, 0xbfb8aa3b, v96
    v_mul_f32 v115, 0xbfb8aa3b, v97
    v_mul_f32 v116, 0xbfb8aa3b, v98
    v_mul_f32 v117, 0xbfb8aa3b, v99
    v_mul_f32 v118, 0xbfb8aa3b, v100
    v_mul_f32 v119, 0xbfb8aa3b, v101
    v_mul_f32 v120, 0xbfb8aa3b, v102
    v_mul_f32 v121, 0xbfb8aa3b, v103
    v_mul_f32 v122, 0xbfb8aa3b, v104
    v_mul_f32 v123, 0xbfb8aa3b, v105
    v_mul_f32 v124, 0xbfb8aa3b, v106
    v_mul_f32 v125, 0xbfb8aa3b, v107
    v_mul_f32 v126, 0xbfb8aa3b, v108
    v_mul_f32 v127, 0xbfb8aa3b, v109
    v_exp_f32 v110, v110
    v_exp_f32 v111, v111
    v_exp_f32 v112, v112
    v_exp_f32 v113, v113
    v_exp_f32 v114, v114
    v_exp_f32 v115, v115
    v_exp_f32 v116, v116
    v_exp_f32 v117, v117
    v_exp_f32 v118, v118
    v_exp_f32 v119, v119
    v_exp_f32 v120, v120
    v_exp_f32 v121, v121
    v_exp_f32 v122, v122
    v_exp_f32 v123, v123
    v_exp_f32 v124, v124
    v_exp_f32 v125, v125
    v_exp_f32 v126, v126
    v_exp_f32 v127, v127
    v_add_f32 v110, 1.0, v110
    v_add_f32 v111, 1.0, v111
    v_add_f32 v112, 1.0, v112
    v_add_f32 v113, 1.0, v113
    v_add_f32 v114, 1.0, v114
    v_add_f32 v115, 1.0, v115
    v_add_f32 v116, 1.0, v116
    v_add_f32 v117, 1.0, v117
    v_add_f32 v118, 1.0, v118
    v_add_f32 v119, 1.0, v119
    v_add_f32 v120, 1.0, v120
    v_add_f32 v121, 1.0, v121
    v_add_f32 v122, 1.0, v122
    v_add_f32 v123, 1.0, v123
    v_add_f32 v124, 1.0, v124
    v_add_f32 v125, 1.0, v125
    v_add_f32 v126, 1.0, v126
    v_add_f32 v127, 1.0, v127
    v_rcp_f32 v110, v110
    v_rcp_f32 v111, v111
    v_rcp_f32 v112, v112
    v_rcp_f32 v113, v113
    v_rcp_f32 v114, v114
    v_rcp_f32 v115, v115
    v_rcp_f32 v116, v116
    v_rcp_f32 v117, v117
    v_rcp_f32 v118, v118
    v_rcp_f32 v119, v119
    v_rcp_f32 v120, v120
    v_rcp_f32 v121, v121
    v_rcp_f32 v122, v122
    v_rcp_f32 v123, v123
    v_rcp_f32 v124, v124
    v_rcp_f32 v125, v125
    v_rcp_f32 v126, v126
    v_rcp_f32 v127, v127
    v_mul_f32 v92, v92, v110
    v_mul_f32 v93, v93, v111
    v_mul_f32 v94, v94, v112
    v_mul_f32 v95, v95, v113
    v_mul_f32 v96, v96, v114
    v_mul_f32 v97, v97, v115
    v_mul_f32 v98, v98, v116
    v_mul_f32 v99, v99, v117
    v_mul_f32 v100, v100, v118
    v_mul_f32 v101, v101, v119
    v_mul_f32 v102, v102, v120
    v_mul_f32 v103, v103, v121
    v_mul_f32 v104, v104, v122
    v_mul_f32 v105, v105, v123
    v_mul_f32 v106, v106, v124
    v_mul_f32 v107, v107, v125
    v_mul_f32 v108, v108, v126
    v_mul_f32 v109, v109, v127
    v_cvt_pk_bf16_f32 v110, v92, v93
    v_cvt_pk_bf16_f32 v111, v94, v95
    v_cvt_pk_bf16_f32 v112, v96, v97
    v_cvt_pk_bf16_f32 v113, v98, v99
    v_cvt_pk_bf16_f32 v114, v100, v101
    v_cvt_pk_bf16_f32 v115, v102, v103
    v_cvt_pk_bf16_f32 v116, v104, v105
    v_cvt_pk_bf16_f32 v117, v106, v107
    v_cvt_pk_bf16_f32 v118, v108, v109
    v_lshlrev_b32 v92, 16, v110
    v_and_b32 v93, 0xffff0000, v110
    v_lshlrev_b32 v94, 16, v111
    v_and_b32 v95, 0xffff0000, v111
    v_lshlrev_b32 v96, 16, v112
    v_and_b32 v97, 0xffff0000, v112
    v_lshlrev_b32 v98, 16, v113
    v_and_b32 v99, 0xffff0000, v113
    v_lshlrev_b32 v100, 16, v114
    v_and_b32 v101, 0xffff0000, v114
    v_lshlrev_b32 v102, 16, v115
    v_and_b32 v103, 0xffff0000, v115
    v_lshlrev_b32 v104, 16, v116
    v_and_b32 v105, 0xffff0000, v116
    v_lshlrev_b32 v106, 16, v117
    v_and_b32 v107, 0xffff0000, v117
    v_lshlrev_b32 v108, 16, v118
    v_and_b32 v109, 0xffff0000, v118
    s_waitcnt vmcnt(17)
    v_lshlrev_b32 v118, 16, v20
    v_and_b32 v119, 0xffff0000, v20
    v_lshlrev_b32 v120, 16, v21
    v_and_b32 v121, 0xffff0000, v21
    v_lshlrev_b32 v122, 16, v22
    v_and_b32 v123, 0xffff0000, v22
    v_lshlrev_b32 v124, 16, v23
    v_and_b32 v125, 0xffff0000, v23
    v_mul_f32 v110, v92, v118
    v_mul_f32 v111, v92, v119
    v_mul_f32 v112, v92, v120
    v_mul_f32 v113, v92, v121
    v_mul_f32 v114, v92, v122
    v_mul_f32 v115, v92, v123
    v_mul_f32 v116, v92, v124
    v_mul_f32 v117, v92, v125
    s_waitcnt vmcnt(16)
    v_lshlrev_b32 v118, 16, v24
    v_and_b32 v119, 0xffff0000, v24
    v_lshlrev_b32 v120, 16, v25
    v_and_b32 v121, 0xffff0000, v25
    v_lshlrev_b32 v122, 16, v26
    v_and_b32 v123, 0xffff0000, v26
    v_lshlrev_b32 v124, 16, v27
    v_and_b32 v125, 0xffff0000, v27
    v_fmac_f32 v110, v93, v118
    v_fmac_f32 v111, v93, v119
    v_fmac_f32 v112, v93, v120
    v_fmac_f32 v113, v93, v121
    v_fmac_f32 v114, v93, v122
    v_fmac_f32 v115, v93, v123
    v_fmac_f32 v116, v93, v124
    v_fmac_f32 v117, v93, v125
    s_waitcnt vmcnt(15)
    v_lshlrev_b32 v118, 16, v28
    v_and_b32 v119, 0xffff0000, v28
    v_lshlrev_b32 v120, 16, v29
    v_and_b32 v121, 0xffff0000, v29
    v_lshlrev_b32 v122, 16, v30
    v_and_b32 v123, 0xffff0000, v30
    v_lshlrev_b32 v124, 16, v31
    v_and_b32 v125, 0xffff0000, v31
    v_fmac_f32 v110, v94, v118
    v_fmac_f32 v111, v94, v119
    v_fmac_f32 v112, v94, v120
    v_fmac_f32 v113, v94, v121
    v_fmac_f32 v114, v94, v122
    v_fmac_f32 v115, v94, v123
    v_fmac_f32 v116, v94, v124
    v_fmac_f32 v117, v94, v125
    s_waitcnt vmcnt(14)
    v_lshlrev_b32 v118, 16, v32
    v_and_b32 v119, 0xffff0000, v32
    v_lshlrev_b32 v120, 16, v33
    v_and_b32 v121, 0xffff0000, v33
    v_lshlrev_b32 v122, 16, v34
    v_and_b32 v123, 0xffff0000, v34
    v_lshlrev_b32 v124, 16, v35
    v_and_b32 v125, 0xffff0000, v35
    v_fmac_f32 v110, v95, v118
    v_fmac_f32 v111, v95, v119
    v_fmac_f32 v112, v95, v120
    v_fmac_f32 v113, v95, v121
    v_fmac_f32 v114, v95, v122
    v_fmac_f32 v115, v95, v123
    v_fmac_f32 v116, v95, v124
    v_fmac_f32 v117, v95, v125
    s_waitcnt vmcnt(13)
    v_lshlrev_b32 v118, 16, v36
    v_and_b32 v119, 0xffff0000, v36
    v_lshlrev_b32 v120, 16, v37
    v_and_b32 v121, 0xffff0000, v37
    v_lshlrev_b32 v122, 16, v38
    v_and_b32 v123, 0xffff0000, v38
    v_lshlrev_b32 v124, 16, v39
    v_and_b32 v125, 0xffff0000, v39
    v_fmac_f32 v110, v96, v118
    v_fmac_f32 v111, v96, v119
    v_fmac_f32 v112, v96, v120
    v_fmac_f32 v113, v96, v121
    v_fmac_f32 v114, v96, v122
    v_fmac_f32 v115, v96, v123
    v_fmac_f32 v116, v96, v124
    v_fmac_f32 v117, v96, v125
    s_waitcnt vmcnt(12)
    v_lshlrev_b32 v118, 16, v40
    v_and_b32 v119, 0xffff0000, v40
    v_lshlrev_b32 v120, 16, v41
    v_and_b32 v121, 0xffff0000, v41
    v_lshlrev_b32 v122, 16, v42
    v_and_b32 v123, 0xffff0000, v42
    v_lshlrev_b32 v124, 16, v43
    v_and_b32 v125, 0xffff0000, v43
    v_fmac_f32 v110, v97, v118
    v_fmac_f32 v111, v97, v119
    v_fmac_f32 v112, v97, v120
    v_fmac_f32 v113, v97, v121
    v_fmac_f32 v114, v97, v122
    v_fmac_f32 v115, v97, v123
    v_fmac_f32 v116, v97, v124
    v_fmac_f32 v117, v97, v125
    s_waitcnt vmcnt(11)
    v_lshlrev_b32 v118, 16, v44
    v_and_b32 v119, 0xffff0000, v44
    v_lshlrev_b32 v120, 16, v45
    v_and_b32 v121, 0xffff0000, v45
    v_lshlrev_b32 v122, 16, v46
    v_and_b32 v123, 0xffff0000, v46
    v_lshlrev_b32 v124, 16, v47
    v_and_b32 v125, 0xffff0000, v47
    v_fmac_f32 v110, v98, v118
    v_fmac_f32 v111, v98, v119
    v_fmac_f32 v112, v98, v120
    v_fmac_f32 v113, v98, v121
    v_fmac_f32 v114, v98, v122
    v_fmac_f32 v115, v98, v123
    v_fmac_f32 v116, v98, v124
    v_fmac_f32 v117, v98, v125
    s_waitcnt vmcnt(10)
    v_lshlrev_b32 v118, 16, v48
    v_and_b32 v119, 0xffff0000, v48
    v_lshlrev_b32 v120, 16, v49
    v_and_b32 v121, 0xffff0000, v49
    v_lshlrev_b32 v122, 16, v50
    v_and_b32 v123, 0xffff0000, v50
    v_lshlrev_b32 v124, 16, v51
    v_and_b32 v125, 0xffff0000, v51
    v_fmac_f32 v110, v99, v118
    v_fmac_f32 v111, v99, v119
    v_fmac_f32 v112, v99, v120
    v_fmac_f32 v113, v99, v121
    v_fmac_f32 v114, v99, v122
    v_fmac_f32 v115, v99, v123
    v_fmac_f32 v116, v99, v124
    v_fmac_f32 v117, v99, v125
    s_waitcnt vmcnt(9)
    v_lshlrev_b32 v118, 16, v52
    v_and_b32 v119, 0xffff0000, v52
    v_lshlrev_b32 v120, 16, v53
    v_and_b32 v121, 0xffff0000, v53
    v_lshlrev_b32 v122, 16, v54
    v_and_b32 v123, 0xffff0000, v54
    v_lshlrev_b32 v124, 16, v55
    v_and_b32 v125, 0xffff0000, v55
    v_fmac_f32 v110, v100, v118
    v_fmac_f32 v111, v100, v119
    v_fmac_f32 v112, v100, v120
    v_fmac_f32 v113, v100, v121
    v_fmac_f32 v114, v100, v122
    v_fmac_f32 v115, v100, v123
    v_fmac_f32 v116, v100, v124
    v_fmac_f32 v117, v100, v125
    s_waitcnt vmcnt(8)
    v_lshlrev_b32 v118, 16, v56
    v_and_b32 v119, 0xffff0000, v56
    v_lshlrev_b32 v120, 16, v57
    v_and_b32 v121, 0xffff0000, v57
    v_lshlrev_b32 v122, 16, v58
    v_and_b32 v123, 0xffff0000, v58
    v_lshlrev_b32 v124, 16, v59
    v_and_b32 v125, 0xffff0000, v59
    v_fmac_f32 v110, v101, v118
    v_fmac_f32 v111, v101, v119
    v_fmac_f32 v112, v101, v120
    v_fmac_f32 v113, v101, v121
    v_fmac_f32 v114, v101, v122
    v_fmac_f32 v115, v101, v123
    v_fmac_f32 v116, v101, v124
    v_fmac_f32 v117, v101, v125
    s_waitcnt vmcnt(7)
    v_lshlrev_b32 v118, 16, v60
    v_and_b32 v119, 0xffff0000, v60
    v_lshlrev_b32 v120, 16, v61
    v_and_b32 v121, 0xffff0000, v61
    v_lshlrev_b32 v122, 16, v62
    v_and_b32 v123, 0xffff0000, v62
    v_lshlrev_b32 v124, 16, v63
    v_and_b32 v125, 0xffff0000, v63
    v_fmac_f32 v110, v102, v118
    v_fmac_f32 v111, v102, v119
    v_fmac_f32 v112, v102, v120
    v_fmac_f32 v113, v102, v121
    v_fmac_f32 v114, v102, v122
    v_fmac_f32 v115, v102, v123
    v_fmac_f32 v116, v102, v124
    v_fmac_f32 v117, v102, v125
    s_waitcnt vmcnt(6)
    v_lshlrev_b32 v118, 16, v64
    v_and_b32 v119, 0xffff0000, v64
    v_lshlrev_b32 v120, 16, v65
    v_and_b32 v121, 0xffff0000, v65
    v_lshlrev_b32 v122, 16, v66
    v_and_b32 v123, 0xffff0000, v66
    v_lshlrev_b32 v124, 16, v67
    v_and_b32 v125, 0xffff0000, v67
    v_fmac_f32 v110, v103, v118
    v_fmac_f32 v111, v103, v119
    v_fmac_f32 v112, v103, v120
    v_fmac_f32 v113, v103, v121
    v_fmac_f32 v114, v103, v122
    v_fmac_f32 v115, v103, v123
    v_fmac_f32 v116, v103, v124
    v_fmac_f32 v117, v103, v125
    s_waitcnt vmcnt(5)
    v_lshlrev_b32 v118, 16, v68
    v_and_b32 v119, 0xffff0000, v68
    v_lshlrev_b32 v120, 16, v69
    v_and_b32 v121, 0xffff0000, v69
    v_lshlrev_b32 v122, 16, v70
    v_and_b32 v123, 0xffff0000, v70
    v_lshlrev_b32 v124, 16, v71
    v_and_b32 v125, 0xffff0000, v71
    v_fmac_f32 v110, v104, v118
    v_fmac_f32 v111, v104, v119
    v_fmac_f32 v112, v104, v120
    v_fmac_f32 v113, v104, v121
    v_fmac_f32 v114, v104, v122
    v_fmac_f32 v115, v104, v123
    v_fmac_f32 v116, v104, v124
    v_fmac_f32 v117, v104, v125
    s_waitcnt vmcnt(4)
    v_lshlrev_b32 v118, 16, v72
    v_and_b32 v119, 0xffff0000, v72
    v_lshlrev_b32 v120, 16, v73
    v_and_b32 v121, 0xffff0000, v73
    v_lshlrev_b32 v122, 16, v74
    v_and_b32 v123, 0xffff0000, v74
    v_lshlrev_b32 v124, 16, v75
    v_and_b32 v125, 0xffff0000, v75
    v_fmac_f32 v110, v105, v118
    v_fmac_f32 v111, v105, v119
    v_fmac_f32 v112, v105, v120
    v_fmac_f32 v113, v105, v121
    v_fmac_f32 v114, v105, v122
    v_fmac_f32 v115, v105, v123
    v_fmac_f32 v116, v105, v124
    v_fmac_f32 v117, v105, v125
    s_waitcnt vmcnt(3)
    v_lshlrev_b32 v118, 16, v76
    v_and_b32 v119, 0xffff0000, v76
    v_lshlrev_b32 v120, 16, v77
    v_and_b32 v121, 0xffff0000, v77
    v_lshlrev_b32 v122, 16, v78
    v_and_b32 v123, 0xffff0000, v78
    v_lshlrev_b32 v124, 16, v79
    v_and_b32 v125, 0xffff0000, v79
    v_fmac_f32 v110, v106, v118
    v_fmac_f32 v111, v106, v119
    v_fmac_f32 v112, v106, v120
    v_fmac_f32 v113, v106, v121
    v_fmac_f32 v114, v106, v122
    v_fmac_f32 v115, v106, v123
    v_fmac_f32 v116, v106, v124
    v_fmac_f32 v117, v106, v125
    s_waitcnt vmcnt(2)
    v_lshlrev_b32 v118, 16, v80
    v_and_b32 v119, 0xffff0000, v80
    v_lshlrev_b32 v120, 16, v81
    v_and_b32 v121, 0xffff0000, v81
    v_lshlrev_b32 v122, 16, v82
    v_and_b32 v123, 0xffff0000, v82
    v_lshlrev_b32 v124, 16, v83
    v_and_b32 v125, 0xffff0000, v83
    v_fmac_f32 v110, v107, v118
    v_fmac_f32 v111, v107, v119
    v_fmac_f32 v112, v107, v120
    v_fmac_f32 v113, v107, v121
    v_fmac_f32 v114, v107, v122
    v_fmac_f32 v115, v107, v123
    v_fmac_f32 v116, v107, v124
    v_fmac_f32 v117, v107, v125
    s_waitcnt vmcnt(1)
    v_lshlrev_b32 v118, 16, v84
    v_and_b32 v119, 0xffff0000, v84
    v_lshlrev_b32 v120, 16, v85
    v_and_b32 v121, 0xffff0000, v85
    v_lshlrev_b32 v122, 16, v86
    v_and_b32 v123, 0xffff0000, v86
    v_lshlrev_b32 v124, 16, v87
    v_and_b32 v125, 0xffff0000, v87
    v_fmac_f32 v110, v108, v118
    v_fmac_f32 v111, v108, v119
    v_fmac_f32 v112, v108, v120
    v_fmac_f32 v113, v108, v121
    v_fmac_f32 v114, v108, v122
    v_fmac_f32 v115, v108, v123
    v_fmac_f32 v116, v108, v124
    v_fmac_f32 v117, v108, v125
    s_waitcnt vmcnt(0)
    v_lshlrev_b32 v118, 16, v88
    v_and_b32 v119, 0xffff0000, v88
    v_lshlrev_b32 v120, 16, v89
    v_and_b32 v121, 0xffff0000, v89
    v_lshlrev_b32 v122, 16, v90
    v_and_b32 v123, 0xffff0000, v90
    v_lshlrev_b32 v124, 16, v91
    v_and_b32 v125, 0xffff0000, v91
    v_fmac_f32 v110, v109, v118
    v_fmac_f32 v111, v109, v119
    v_fmac_f32 v112, v109, v120
    v_fmac_f32 v113, v109, v121
    v_fmac_f32 v114, v109, v122
    v_fmac_f32 v115, v109, v123
    v_fmac_f32 v116, v109, v124
    v_fmac_f32 v117, v109, v125
    v_add_f32_dpp v110, v110, v110 row_ror:8 row_mask:0xf bank_mask:0xf
    v_add_f32_dpp v111, v111, v111 row_ror:8 row_mask:0xf bank_mask:0xf
    v_add_f32_dpp v112, v112, v112 row_ror:8 row_mask:0xf bank_mask:0xf
    v_add_f32_dpp v113, v113, v113 row_ror:8 row_mask:0xf bank_mask:0xf
    v_add_f32_dpp v114, v114, v114 row_ror:8 row_mask:0xf bank_mask:0xf
    v_add_f32_dpp v115, v115, v115 row_ror:8 row_mask:0xf bank_mask:0xf
    v_add_f32_dpp v116, v116, v116 row_ror:8 row_mask:0xf bank_mask:0xf
    v_add_f32_dpp v117, v117, v117 row_ror:8 row_mask:0xf bank_mask:0xf
    v_mov_b32 v118, v110
    v_mov_b32 v119, v111
    v_mov_b32 v120, v112
    v_mov_b32 v121, v113
    v_mov_b32 v122, v114
    v_mov_b32 v123, v115
    v_mov_b32 v124, v116
    v_mov_b32 v125, v117
    v_permlane16_swap_b32 v110, v118
    v_permlane16_swap_b32 v111, v119
    v_permlane16_swap_b32 v112, v120
    v_permlane16_swap_b32 v113, v121
    v_permlane16_swap_b32 v114, v122
    v_permlane16_swap_b32 v115, v123
    v_permlane16_swap_b32 v116, v124
    v_permlane16_swap_b32 v117, v125
    v_add_f32 v110, v110, v118
    v_add_f32 v111, v111, v119
    v_add_f32 v112, v112, v120
    v_add_f32 v113, v113, v121
    v_add_f32 v114, v114, v122
    v_add_f32 v115, v115, v123
    v_add_f32 v116, v116, v124
    v_add_f32 v117, v117, v125
    v_mov_b32 v118, v110
    v_mov_b32 v119, v111
    v_mov_b32 v120, v112
    v_mov_b32 v121, v113
    v_mov_b32 v122, v114
    v_mov_b32 v123, v115
    v_mov_b32 v124, v116
    v_mov_b32 v125, v117
    v_permlane32_swap_b32 v110, v118
    v_permlane32_swap_b32 v111, v119
    v_permlane32_swap_b32 v112, v120
    v_permlane32_swap_b32 v113, v121
    v_permlane32_swap_b32 v114, v122
    v_permlane32_swap_b32 v115, v123
    v_permlane32_swap_b32 v116, v124
    v_permlane32_swap_b32 v117, v125
    v_add_f32 v110, v110, v118
    v_add_f32 v111, v111, v119
    v_add_f32 v112, v112, v120
    v_add_f32 v113, v113, v121
    v_add_f32 v114, v114, v122
    v_add_f32 v115, v115, v123
    v_add_f32 v116, v116, v124
    v_add_f32 v117, v117, v125
    v_lshrrev_b32 v5, 6, v0
    v_lshlrev_b32 v5, 8, v5
    v_lshl_add_u32 v5, v1, 5, v5
    ds_write_b128 v5, v[110:113]
    ds_write_b128 v5, v[114:117] offset:16
    s_waitcnt lgkmcnt(0)
    s_barrier
    v_cmp_gt_u32 vcc, 64, v0
    s_and_saveexec_b64 s[40:41], vcc
    s_nop 3
    s_cbranch_execz K1_END
    v_lshlrev_b32 v6, 2, v0
    ds_read_b32 v8, v6 offset:0
    ds_read_b32 v9, v6 offset:256
    ds_read_b32 v10, v6 offset:512
    ds_read_b32 v11, v6 offset:768
    s_waitcnt lgkmcnt(0)
    v_add_f32 v8, v8, v9
    v_add_f32 v10, v10, v11
    v_add_f32 v8, v8, v10
    v_cvt_pk_bf16_f32 v8, v8, v8
    v_lshlrev_b32 v8, 16, v8
    s_lshl_b32 s3, s2, 8
    v_add_u32 v6, s3, v6
    buffer_store_dword v8, v6, s[12:15], 0 offen
    s_endpgm
K1_LN:
    v_readfirstlane_b32 s4, v0
    s_cmp_ge_u32 s4, 192
    s_nop 3
    s_cbranch_scc1 K1_END
    s_load_dwordx2 s[4:5], s[0:1], 0
    s_load_dwordx2 s[8:9], s[0:1], 136
    s_sub_u32 s3, s2, 54
    v_and_b32 v1, 7, v0
    v_lshrrev_b32 v2, 3, v0
    v_mul_u32_u24 v3, 1152, v1
    v_lshl_add_u32 v3, v2, 4, v3
    s_mul_i32 s12, s3, 9216
    s_waitcnt lgkmcnt(0)
    s_mov_b32 s6, 0x240000
    s_mov_b32 s7, 0x20000
    s_add_u32 s8, s8, 0x280000
    s_addc_u32 s9, s9, 0
    s_mov_b32 s10, 0x488000
    s_mov_b32 s11, 0x20000
    buffer_load_dwordx4 v[8:11], v3, s[4:7], s12 offen offset:0
    buffer_load_dwordx4 v[12:15], v3, s[4:7], s12 offen offset:384
    buffer_load_dwordx4 v[16:19], v3, s[4:7], s12 offen offset:768
    v_lshrrev_b32 v4, 6, v0
    v_lshlrev_b32 v4, 5, v4
    v_lshl_add_u32 v4, v1, 2, v4
    v_lshlrev_b32 v5, 2, v1
    v_mul_u32_u24 v6, 288, v2
    v_lshl_add_u32 v6, v1, 2, v6
    s_mov_b32 s14, 0x05040100
    s_mov_b32 s15, 0x07060302
    s_waitcnt vmcnt(0)
    v_lshlrev_b32 v20, 16, v8
    v_and_b32 v21, 0xffff0000, v8
    v_lshlrev_b32 v22, 16, v9
    v_and_b32 v23, 0xffff0000, v9
    v_lshlrev_b32 v24, 16, v10
    v_and_b32 v25, 0xffff0000, v10
    v_lshlrev_b32 v26, 16, v11
    v_and_b32 v27, 0xffff0000, v11
    v_lshlrev_b32 v28, 16, v12
    v_and_b32 v29, 0xffff0000, v12
    v_lshlrev_b32 v30, 16, v13
    v_and_b32 v31, 0xffff0000, v13
    v_lshlrev_b32 v32, 16, v14
    v_and_b32 v33, 0xffff0000, v14
    v_lshlrev_b32 v34, 16, v15
    v_and_b32 v35, 0xffff0000, v15
    v_lshlrev_b32 v36, 16, v16
    v_and_b32 v37, 0xffff0000, v16
    v_lshlrev_b32 v38, 16, v17
    v_and_b32 v39, 0xffff0000, v17
    v_lshlrev_b32 v40, 16, v18
    v_and_b32 v41, 0xffff0000, v18
    v_lshlrev_b32 v42, 16, v19
    v_and_b32 v43, 0xffff0000, v19
    v_add_f32 v46, v20, v24
    v_add_f32 v47, v21, v25
    v_add_f32 v48, v22, v26
    v_add_f32 v49, v23, v27
    v_add_f32 v46, v46, v28
    v_add_f32 v47, v47, v29
    v_add_f32 v48, v48, v30
    v_add_f32 v49, v49, v31
    v_add_f32 v46, v46, v32
    v_add_f32 v47, v47, v33
    v_add_f32 v48, v48, v34
    v_add_f32 v49, v49, v35
    v_add_f32 v46, v46, v36
    v_add_f32 v47, v47, v37
    v_add_f32 v48, v48, v38
    v_add_f32 v49, v49, v39
    v_add_f32 v46, v46, v40
    v_add_f32 v47, v47, v41
    v_add_f32 v48, v48, v42
    v_add_f32 v49, v49, v43
    v_add_f32 v46, v46, v47
    v_add_f32 v48, v48, v49
    v_add_f32 v44, v46, v48
    s_nop 1
    v_add_f32_dpp v44, v44, v44 row_ror:8 row_mask:0xf bank_mask:0xf
    v_mov_b32 v45, v44
    s_nop 1
    v_permlane16_swap_b32 v44, v45
    v_add_f32 v44, v44, v45
    v_mov_b32 v45, v44
    s_nop 1
    v_permlane32_swap_b32 v44, v45
    v_add_f32 v44, v44, v45
    ds_write_b32 v4, v44 offset:20736
    s_waitcnt lgkmcnt(0)
    s_barrier
    ds_read_b32 v46, v5 offset:20736
    ds_read_b32 v47, v5 offset:20768
    ds_read_b32 v48, v5 offset:20800
    s_waitcnt lgkmcnt(0)
    v_add_f32 v46, v46, v47
    v_add_f32 v46, v46, v48
    v_mul_f32 v44, 0x3ae38e39, v46
    v_sub_f32 v50, v20, v44
    v_mul_f32 v46, v50, v50
    v_sub_f32 v51, v21, v44
    v_mul_f32 v47, v51, v51
    v_sub_f32 v52, v22, v44
    v_mul_f32 v48, v52, v52
    v_sub_f32 v53, v23, v44
    v_mul_f32 v49, v53, v53
    v_sub_f32 v50, v24, v44
    v_fmac_f32 v46, v50, v50
    v_sub_f32 v51, v25, v44
    v_fmac_f32 v47, v51, v51
    v_sub_f32 v52, v26, v44
    v_fmac_f32 v48, v52, v52
    v_sub_f32 v53, v27, v44
    v_fmac_f32 v49, v53, v53
    v_sub_f32 v50, v28, v44
    v_fmac_f32 v46, v50, v50
    v_sub_f32 v51, v29, v44
    v_fmac_f32 v47, v51, v51
    v_sub_f32 v52, v30, v44
    v_fmac_f32 v48, v52, v52
    v_sub_f32 v53, v31, v44
    v_fmac_f32 v49, v53, v53
    v_sub_f32 v50, v32, v44
    v_fmac_f32 v46, v50, v50
    v_sub_f32 v51, v33, v44
    v_fmac_f32 v47, v51, v51
    v_sub_f32 v52, v34, v44
    v_fmac_f32 v48, v52, v52
    v_sub_f32 v53, v35, v44
    v_fmac_f32 v49, v53, v53
    v_sub_f32 v50, v36, v44
    v_fmac_f32 v46, v50, v50
    v_sub_f32 v51, v37, v44
    v_fmac_f32 v47, v51, v51
    v_sub_f32 v52, v38, v44
    v_fmac_f32 v48, v52, v52
    v_sub_f32 v53, v39, v44
    v_fmac_f32 v49, v53, v53
    v_sub_f32 v50, v40, v44
    v_fmac_f32 v46, v50, v50
    v_sub_f32 v51, v41, v44
    v_fmac_f32 v47, v51, v51
    v_sub_f32 v52, v42, v44
    v_fmac_f32 v48, v52, v52
    v_sub_f32 v53, v43, v44
    v_fmac_f32 v49, v53, v53
    v_add_f32 v46, v46, v47
    v_add_f32 v48, v48, v49
    v_add_f32 v45, v46, v48
    s_nop 1
    v_add_f32_dpp v45, v45, v45 row_ror:8 row_mask:0xf bank_mask:0xf
    v_mov_b32 v50, v45
    s_nop 1
    v_permlane16_swap_b32 v45, v50
    v_add_f32 v45, v45, v50
    v_mov_b32 v50, v45
    s_nop 1
    v_permlane32_swap_b32 v45, v50
    v_add_f32 v45, v45, v50
    ds_write_b32 v4, v45 offset:20832
    v_cvt_pk_bf16_f32 v44, v44, v44
    v_lshlrev_b32 v44, 16, v44
    s_waitcnt lgkmcnt(0)
    s_barrier
    ds_read_b32 v46, v5 offset:20832
    ds_read_b32 v47, v5 offset:20864
    ds_read_b32 v48, v5 offset:20896
    s_waitcnt lgkmcnt(0)
    v_add_f32 v46, v46, v47
    v_add_f32 v46, v46, v48
    v_mul_f32 v45, 0x3ae38e39, v46
    v_cvt_pk_bf16_f32 v45, v45, v45
    v_lshlrev_b32 v45, 16, v45
    v_add_f32 v45, 0x3727c5ac, v45
    v_cvt_pk_bf16_f32 v45, v45, v45
    v_lshlrev_b32 v45, 16, v45
    v_sqrt_f32 v45, v45
    s_nop 0
    v_cvt_pk_bf16_f32 v45, v45, v45
    v_lshlrev_b32 v45, 16, v45
    v_rcp_f32 v45, v45
    v_sub_f32 v20, v20, v44
    v_sub_f32 v21, v21, v44
    v_sub_f32 v22, v22, v44
    v_sub_f32 v23, v23, v44
    v_sub_f32 v24, v24, v44
    v_sub_f32 v25, v25, v44
    v_sub_f32 v26, v26, v44
    v_sub_f32 v27, v27, v44
    v_sub_f32 v28, v28, v44
    v_sub_f32 v29, v29, v44
    v_sub_f32 v30, v30, v44
    v_sub_f32 v31, v31, v44
    v_sub_f32 v32, v32, v44
    v_sub_f32 v33, v33, v44
    v_sub_f32 v34, v34, v44
    v_sub_f32 v35, v35, v44
    v_sub_f32 v36, v36, v44
    v_sub_f32 v37, v37, v44
    v_sub_f32 v38, v38, v44
    v_sub_f32 v39, v39, v44
    v_sub_f32 v40, v40, v44
    v_sub_f32 v41, v41, v44
    v_sub_f32 v42, v42, v44
    v_sub_f32 v43, v43, v44
    v_cvt_pk_bf16_f32 v60, v20, v21
    v_cvt_pk_bf16_f32 v61, v22, v23
    v_cvt_pk_bf16_f32 v62, v24, v25
    v_cvt_pk_bf16_f32 v63, v26, v27
    v_cvt_pk_bf16_f32 v64, v28, v29
    v_cvt_pk_bf16_f32 v65, v30, v31
    v_cvt_pk_bf16_f32 v66, v32, v33
    v_cvt_pk_bf16_f32 v67, v34, v35
    v_cvt_pk_bf16_f32 v68, v36, v37
    v_cvt_pk_bf16_f32 v69, v38, v39
    v_cvt_pk_bf16_f32 v70, v40, v41
    v_cvt_pk_bf16_f32 v71, v42, v43
    v_lshlrev_b32 v20, 16, v60
    v_and_b32 v21, 0xffff0000, v60
    v_lshlrev_b32 v22, 16, v61
    v_and_b32 v23, 0xffff0000, v61
    v_lshlrev_b32 v24, 16, v62
    v_and_b32 v25, 0xffff0000, v62
    v_lshlrev_b32 v26, 16, v63
    v_and_b32 v27, 0xffff0000, v63
    v_lshlrev_b32 v28, 16, v64
    v_and_b32 v29, 0xffff0000, v64
    v_lshlrev_b32 v30, 16, v65
    v_and_b32 v31, 0xffff0000, v65
    v_lshlrev_b32 v32, 16, v66
    v_and_b32 v33, 0xffff0000, v66
    v_lshlrev_b32 v34, 16, v67
    v_and_b32 v35, 0xffff0000, v67
    v_lshlrev_b32 v36, 16, v68
    v_and_b32 v37, 0xffff0000, v68
    v_lshlrev_b32 v38, 16, v69
    v_and_b32 v39, 0xffff0000, v69
    v_lshlrev_b32 v40, 16, v70
    v_and_b32 v41, 0xffff0000, v70
    v_lshlrev_b32 v42, 16, v71
    v_and_b32 v43, 0xffff0000, v71
    v_mul_f32 v20, v20, v45
    v_mul_f32 v21, v21, v45
    v_mul_f32 v22, v22, v45
    v_mul_f32 v23, v23, v45
    v_mul_f32 v24, v24, v45
    v_mul_f32 v25, v25, v45
    v_mul_f32 v26, v26, v45
    v_mul_f32 v27, v27, v45
    v_mul_f32 v28, v28, v45
    v_mul_f32 v29, v29, v45
    v_mul_f32 v30, v30, v45
    v_mul_f32 v31, v31, v45
    v_mul_f32 v32, v32, v45
    v_mul_f32 v33, v33, v45
    v_mul_f32 v34, v34, v45
    v_mul_f32 v35, v35, v45
    v_mul_f32 v36, v36, v45
    v_mul_f32 v37, v37, v45
    v_mul_f32 v38, v38, v45
    v_mul_f32 v39, v39, v45
    v_mul_f32 v40, v40, v45
    v_mul_f32 v41, v41, v45
    v_mul_f32 v42, v42, v45
    v_mul_f32 v43, v43, v45
    v_cvt_pk_bf16_f32 v60, v20, v21
    v_cvt_pk_bf16_f32 v61, v22, v23
    v_cvt_pk_bf16_f32 v62, v24, v25
    v_cvt_pk_bf16_f32 v63, v26, v27
    v_cvt_pk_bf16_f32 v64, v28, v29
    v_cvt_pk_bf16_f32 v65, v30, v31
    v_cvt_pk_bf16_f32 v66, v32, v33
    v_cvt_pk_bf16_f32 v67, v34, v35
    v_cvt_pk_bf16_f32 v68, v36, v37
    v_cvt_pk_bf16_f32 v69, v38, v39
    v_cvt_pk_bf16_f32 v70, v40, v41
    v_cvt_pk_bf16_f32 v71, v42, v43
    v_perm_b32 v20, v8, v60, s14
    v_perm_b32 v21, v8, v60, s15
    v_perm_b32 v22, v9, v61, s14
    v_perm_b32 v23, v9, v61, s15
    v_perm_b32 v24, v10, v62, s14
    v_perm_b32 v25, v10, v62, s15
    v_perm_b32 v26, v11, v63, s14
    v_perm_b32 v27, v11, v63, s15
    ds_write_b32 v6, v20 offset:0
    ds_write_b32 v6, v21 offset:32
    ds_write_b32 v6, v22 offset:64
    ds_write_b32 v6, v23 offset:96
    ds_write_b32 v6, v24 offset:128
    ds_write_b32 v6, v25 offset:160
    ds_write_b32 v6, v26 offset:192
    ds_write_b32 v6, v27 offset:224
    v_perm_b32 v28, v12, v64, s14
    v_perm_b32 v29, v12, v64, s15
    v_perm_b32 v30, v13, v65, s14
    v_perm_b32 v31, v13, v65, s15
    v_perm_b32 v32, v14, v66, s14
    v_perm_b32 v33, v14, v66, s15
    v_perm_b32 v34, v15, v67, s14
    v_perm_b32 v35, v15, v67, s15
    ds_write_b32 v6, v28 offset:6912
    ds_write_b32 v6, v29 offset:6944
    ds_write_b32 v6, v30 offset:6976
    ds_write_b32 v6, v31 offset:7008
    ds_write_b32 v6, v32 offset:7040
    ds_write_b32 v6, v33 offset:7072
    ds_write_b32 v6, v34 offset:7104
    ds_write_b32 v6, v35 offset:7136
    v_perm_b32 v36, v16, v68, s14
    v_perm_b32 v37, v16, v68, s15
    v_perm_b32 v38, v17, v69, s14
    v_perm_b32 v39, v17, v69, s15
    v_perm_b32 v40, v18, v70, s14
    v_perm_b32 v41, v18, v70, s15
    v_perm_b32 v42, v19, v71, s14
    v_perm_b32 v43, v19, v71, s15
    ds_write_b32 v6, v36 offset:13824
    ds_write_b32 v6, v37 offset:13856
    ds_write_b32 v6, v38 offset:13888
    ds_write_b32 v6, v39 offset:13920
    ds_write_b32 v6, v40 offset:13952
    ds_write_b32 v6, v41 offset:13984
    ds_write_b32 v6, v42 offset:14016
    ds_write_b32 v6, v43 offset:14048
    s_waitcnt lgkmcnt(0)
    s_barrier
    v_lshrrev_b32 v1, 4, v0
    v_mul_u32_u24 v1, 288, v1
    v_and_b32 v2, 15, v0
    v_lshl_add_u32 v1, v2, 4, v1
    v_lshlrev_b32 v2, 4, v0
    s_mul_i32 s12, s3, 18560
    ds_read_b128 v[20:23], v1 offset:0
    ds_read_b128 v[24:27], v1 offset:3456
    ds_read_b128 v[28:31], v1 offset:6912
    ds_read_b128 v[32:35], v1 offset:10368
    ds_read_b128 v[36:39], v1 offset:13824
    ds_read_b128 v[40:43], v1 offset:17280
    s_waitcnt lgkmcnt(5)
    s_add_u32 s13, s12, 0
    buffer_store_dwordx4 v[20:23], v2, s[8:11], s13 offen
    s_waitcnt lgkmcnt(4)
    s_add_u32 s13, s12, 3072
    buffer_store_dwordx4 v[24:27], v2, s[8:11], s13 offen
    s_waitcnt lgkmcnt(3)
    s_add_u32 s13, s12, 6144
    buffer_store_dwordx4 v[28:31], v2, s[8:11], s13 offen
    s_waitcnt lgkmcnt(2)
    s_add_u32 s13, s12, 9216
    buffer_store_dwordx4 v[32:35], v2, s[8:11], s13 offen
    s_waitcnt lgkmcnt(1)
    s_add_u32 s13, s12, 12288
    buffer_store_dwordx4 v[36:39], v2, s[8:11], s13 offen
    s_waitcnt lgkmcnt(0)
    s_add_u32 s13, s12, 15360
    buffer_store_dwordx4 v[40:43], v2, s[8:11], s13 offen
    s_endpgm
    s_nop 0
K1_KG:
    s_load_dwordx2 s[4:5], s[0:1], 8
    s_load_dwordx2 s[8:9], s[0:1], 16
    s_load_dwordx2 s[12:13], s[0:1], 24
    s_load_dwordx2 s[16:17], s[0:1], 32
    s_load_dwordx2 s[20:21], s[0:1], 40
    s_load_dwordx2 s[24:25], s[0:1], 48
    s_load_dwordx2 s[28:29], s[0:1], 56
    s_load_dwordx2 s[32:33], s[0:1], 136
    s_sub_u32 s3, s2, 310
    s_and_b32 s36, s3, 7
    s_mul_i32 s36, s36, 72
    s_lshr_b32 s37, s3, 3
    s_add_u32 s3, s36, s37
    v_and_b32 v1, 127, v0
    v_lshlrev_b32 v2, 1, v1
    s_lshl_b32 s36, s3, 8
    s_and_b32 s37, s3, -2
    s_lshl_b32 s37, s37, 1
    v_readfirstlane_b32 s38, v0
    s_waitcnt lgkmcnt(0)
    s_load_dword s39, s[28:29], s37
    s_mov_b32 s6, 0x24000
    s_mov_b32 s7, 0x20000
    s_mov_b32 s10, 0x24000
    s_mov_b32 s11, 0x20000
    s_mov_b32 s14, 0x24000
    s_mov_b32 s15, 0x20000
    s_mov_b32 s18, 0x24000
    s_mov_b32 s19, 0x20000
    s_mov_b32 s22, 0x24000
    s_mov_b32 s23, 0x20000
    s_mov_b32 s26, 0x24000
    s_mov_b32 s27, 0x20000
    s_add_u32 s32, s32, 0x4000000
    s_addc_u32 s33, s33, 0
    s_mov_b32 s34, 0x492000
    s_mov_b32 s35, 0x20000
    buffer_load_ushort v8, v2, s[4:7], s36 offen
    buffer_load_ushort v9, v2, s[8:11], s36 offen
    buffer_load_ushort v10, v2, s[12:15], s36 offen
    buffer_load_ushort v11, v2, s[16:19], s36 offen
    buffer_load_ushort v12, v2, s[20:23], s36 offen
    buffer_load_ushort v13, v2, s[24:27], s36 offen
    v_lshlrev_b32 v3, 3, v0
    v_sub_u32 v3, 2047, v3
    v_subrev_u32 v100, 0, v3
    v_subrev_u32 v101, 1, v3
    v_subrev_u32 v102, 2, v3
    v_subrev_u32 v103, 3, v3
    v_subrev_u32 v104, 4, v3
    v_subrev_u32 v105, 5, v3
    v_subrev_u32 v106, 6, v3
    v_subrev_u32 v107, 7, v3
    v_subrev_u32 v108, 8, v3
    v_cvt_f32_u32 v110, v100
    v_cvt_f32_u32 v111, v101
    v_cvt_f32_u32 v112, v102
    v_cvt_f32_u32 v113, v103
    v_cvt_f32_u32 v114, v104
    v_cvt_f32_u32 v115, v105
    v_cvt_f32_u32 v116, v106
    v_cvt_f32_u32 v117, v107
    v_cvt_f32_u32 v118, v108
    v_cvt_f32_u32 v119, v108
    v_cvt_pk_bf16_f32 v120, v110, v111
    v_cvt_pk_bf16_f32 v121, v112, v113
    v_cvt_pk_bf16_f32 v122, v114, v115
    v_cvt_pk_bf16_f32 v123, v116, v117
    v_cvt_pk_bf16_f32 v124, v118, v119
    v_and_b32 v110, 0xffff, v120
    v_lshrrev_b32 v111, 16, v120
    v_and_b32 v112, 0xffff, v121
    v_lshrrev_b32 v113, 16, v121
    v_and_b32 v114, 0xffff, v122
    v_lshrrev_b32 v115, 16, v122
    v_and_b32 v116, 0xffff, v123
    v_lshrrev_b32 v117, 16, v123
    v_and_b32 v118, 0xffff, v124
    v_cmp_gt_u32 vcc, 240, v0
    v_subrev_u32 v110, 17024, v110
    v_subrev_u32 v111, 17024, v111
    v_subrev_u32 v112, 17024, v112
    v_subrev_u32 v113, 17024, v113
    v_subrev_u32 v114, 17024, v114
    v_subrev_u32 v115, 17024, v115
    v_subrev_u32 v116, 17024, v116
    v_subrev_u32 v117, 17024, v117
    v_subrev_u32 v118, 17024, v118
    v_cndmask_b32 v100, v100, v110, vcc
    v_cndmask_b32 v101, v101, v111, vcc
    v_cndmask_b32 v102, v102, v112, vcc
    v_cndmask_b32 v103, v103, v113, vcc
    v_cndmask_b32 v104, v104, v114, vcc
    v_cndmask_b32 v105, v105, v115, vcc
    v_cndmask_b32 v106, v106, v116, vcc
    v_cndmask_b32 v107, v107, v117, vcc
    v_cmp_gt_u32 vcc, 239, v0
    s_nop 1
    v_cndmask_b32 v108, v108, v118, vcc
    v_max_i32 v108, 0, v108
    v_lshlrev_b32 v100, 1, v100
    v_lshlrev_b32 v101, 1, v101
    v_lshlrev_b32 v102, 1, v102
    v_lshlrev_b32 v103, 1, v103
    v_lshlrev_b32 v104, 1, v104
    v_lshlrev_b32 v105, 1, v105
    v_lshlrev_b32 v106, 1, v106
    v_lshlrev_b32 v107, 1, v107
    v_lshlrev_b32 v108, 1, v108
    s_lshr_b32 s40, s38, 6
    s_and_b32 s41, s40, 1
    s_lshr_b32 s42, s40, 1
    v_and_b32 v4, 15, v0
    s_lshl_b32 s43, s41, 4
    v_add_u32 v4, s43, v4
    v_bfe_u32 v5, v0, 4, 2
    s_cmp_eq_u32 s42, 0
    s_nop 0
    s_cbranch_scc0 K1_KG_RT1
    v_lshlrev_b32 v124, 3, v4
    v_lshl_add_u32 v124, v5, 2, v124
    v_lshlrev_b32 v6, 2, v4
    v_add_u32 v6, 256, v6
    v_cmp_eq_u32 vcc, 2, v5
    s_nop 1
    v_cndmask_b32 v124, v124, v6, vcc
    v_lshlrev_b32 v6, 1, v4
    v_add_u32 v6, 384, v6
    v_cmp_eq_u32 vcc, 3, v5
    s_nop 1
    v_cndmask_b32 v124, v124, v6, vcc
    v_mov_b32 v125, 1
    v_mov_b32 v6, 64
    v_cndmask_b32 v126, 2, v6, vcc
    s_nop 1
    s_branch K1_KG_A
K1_KG_RT1:
    v_add_u32 v124, 700, v4
    v_add_u32 v6, 640, v4
    v_cmp_eq_u32 vcc, 1, v5
    s_nop 1
    v_cndmask_b32 v124, v124, v6, vcc
    v_add_u32 v6, 512, v4
    v_cmp_eq_u32 vcc, 0, v5
    s_nop 1
    v_cndmask_b32 v124, v124, v6, vcc
    v_mov_b32 v6, 32
    v_mov_b32 v7, 64
    v_cndmask_b32 v125, v7, v6, vcc
    v_lshlrev_b32 v126, 1, v125
    s_nop 1
K1_KG_A:
    v_add_u32 v127, v126, v125
    v_add_u32 v125, v124, v125
    v_add_u32 v126, v124, v126
    v_add_u32 v127, v124, v127
    v_lshlrev_b32 v124, 1, v124
    v_lshlrev_b32 v125, 1, v125
    v_lshlrev_b32 v126, 1, v126
    v_lshlrev_b32 v127, 1, v127
    s_waitcnt lgkmcnt(0)
    s_and_b32 s43, s3, 1
    s_lshl_b32 s43, s43, 4
    s_lshr_b32 s39, s39, s43
    s_lshl_b32 s39, s39, 16
    v_mov_b32 v14, s39
    v_mul_f32 v14, 0x3fb8aa3b, v14
    v_exp_f32 v14, v14
    s_nop 0
    v_cvt_pk_bf16_f32 v14, v14, v14
    v_lshlrev_b32 v14, 16, v14
    s_waitcnt vmcnt(0)
    v_lshlrev_b32 v8, 16, v8
    v_lshlrev_b32 v9, 16, v9
    v_lshlrev_b32 v10, 16, v10
    v_lshlrev_b32 v11, 16, v11
    v_lshlrev_b32 v12, 16, v12
    v_lshlrev_b32 v13, 16, v13
    v_mul_f32 v8, v8, v14
    v_mul_f32 v9, v9, v14
    v_mul_f32 v10, v10, v14
    v_mul_f32 v11, v11, v14
    v_mul_f32 v8, 0x3fb8aa3b, v8
    v_mul_f32 v9, 0x3e22f983, v9
    v_pk_mul_f32 v[16:17], v[12:13], v[10:11] op_sel:[0,0] op_sel_hi:[0,1]
    v_pk_fma_f32 v[16:17], v[12:13], v[10:11], v[16:17] op_sel:[1,1,0] op_sel_hi:[1,0,1] neg_lo:[1,0,0]
    v_mul_f32 v16, 1024.0, v16
    v_mul_f32 v17, 1024.0, v17
    v_lshlrev_b32 v3, 2, v1
    s_cmp_ge_u32 s38, 128
    s_nop 0
    s_cbranch_scc1 K1_KG_H1
    v_mul_f32 v4, 8.0, v8
    v_mul_f32 v5, 8.0, v9
    v_exp_f32 v4, v4
    v_fract_f32 v5, v5
    v_cos_f32 v6, v5
    v_sin_f32 v7, v5
    v_mul_f32 v18, v4, v6
    v_mul_f32 v19, v4, v7
    v_mul_f32 v4, 1.0, v8
    v_mul_f32 v5, 1.0, v9
    v_exp_f32 v4, v4
    v_fract_f32 v5, v5
    v_cos_f32 v6, v5
    v_sin_f32 v7, v5
    v_mul_f32 v20, v4, v6
    v_mul_f32 v21, v4, v7
    v_mul_f32 v4, 256.0, v8
    v_mul_f32 v5, 256.0, v9
    v_exp_f32 v4, v4
    v_fract_f32 v5, v5
    v_cos_f32 v6, v5
    v_sin_f32 v7, v5
    v_mul_f32 v22, v4, v6
    v_mul_f32 v23, v4, v7
    v_mov_b32 v24, 1.0
    v_mov_b32 v25, 0
    v_cvt_pk_f16_f32 v2, v24, -v25
    ds_write_b32 v3, v2 offset:16896
    v_cvt_pk_f16_f32 v2, v18, -v19
    ds_write_b32 v3, v2 offset:17424
    v_pk_mul_f32 v[24:25], v[18:19], v[18:19] op_sel:[0,0] op_sel_hi:[0,1]
    v_pk_fma_f32 v[24:25], v[18:19], v[18:19], v[24:25] op_sel:[1,1,0] op_sel_hi:[1,0,1] neg_lo:[1,0,0]
    v_cvt_pk_f16_f32 v2, v24, -v25
    ds_write_b32 v3, v2 offset:17952
    v_pk_mul_f32 v[26:27], v[24:25], v[18:19] op_sel:[0,0] op_sel_hi:[0,1]
    v_pk_fma_f32 v[26:27], v[24:25], v[18:19], v[26:27] op_sel:[1,1,0] op_sel_hi:[1,0,1] neg_lo:[1,0,0]
    v_cvt_pk_f16_f32 v2, v26, -v27
    ds_write_b32 v3, v2 offset:18480
    v_pk_mul_f32 v[24:25], v[26:27], v[18:19] op_sel:[0,0] op_sel_hi:[0,1]
    v_pk_fma_f32 v[24:25], v[26:27], v[18:19], v[24:25] op_sel:[1,1,0] op_sel_hi:[1,0,1] neg_lo:[1,0,0]
    v_cvt_pk_f16_f32 v2, v24, -v25
    ds_write_b32 v3, v2 offset:19008
    v_pk_mul_f32 v[26:27], v[24:25], v[18:19] op_sel:[0,0] op_sel_hi:[0,1]
    v_pk_fma_f32 v[26:27], v[24:25], v[18:19], v[26:27] op_sel:[1,1,0] op_sel_hi:[1,0,1] neg_lo:[1,0,0]
    v_cvt_pk_f16_f32 v2, v26, -v27
    ds_write_b32 v3, v2 offset:19536
    v_pk_mul_f32 v[24:25], v[26:27], v[18:19] op_sel:[0,0] op_sel_hi:[0,1]
    v_pk_fma_f32 v[24:25], v[26:27], v[18:19], v[24:25] op_sel:[1,1,0] op_sel_hi:[1,0,1] neg_lo:[1,0,0]
    v_cvt_pk_f16_f32 v2, v24, -v25
    ds_write_b32 v3, v2 offset:20064
    v_pk_mul_f32 v[26:27], v[24:25], v[18:19] op_sel:[0,0] op_sel_hi:[0,1]
    v_pk_fma_f32 v[26:27], v[24:25], v[18:19], v[26:27] op_sel:[1,1,0] op_sel_hi:[1,0,1] neg_lo:[1,0,0]
    v_cvt_pk_f16_f32 v2, v26, -v27
    ds_write_b32 v3, v2 offset:20592
    v_pk_mul_f32 v[24:25], v[26:27], v[18:19] op_sel:[0,0] op_sel_hi:[0,1]
    v_pk_fma_f32 v[24:25], v[26:27], v[18:19], v[24:25] op_sel:[1,1,0] op_sel_hi:[1,0,1] neg_lo:[1,0,0]
    v_cvt_pk_f16_f32 v2, v24, -v25
    ds_write_b32 v3, v2 offset:21120
    v_pk_mul_f32 v[26:27], v[24:25], v[18:19] op_sel:[0,0] op_sel_hi:[0,1]
    v_pk_fma_f32 v[26:27], v[24:25], v[18:19], v[26:27] op_sel:[1,1,0] op_sel_hi:[1,0,1] neg_lo:[1,0,0]
    v_cvt_pk_f16_f32 v2, v26, -v27
    ds_write_b32 v3, v2 offset:21648
    v_pk_mul_f32 v[24:25], v[26:27], v[18:19] op_sel:[0,0] op_sel_hi:[0,1]
    v_pk_fma_f32 v[24:25], v[26:27], v[18:19], v[24:25] op_sel:[1,1,0] op_sel_hi:[1,0,1] neg_lo:[1,0,0]
    v_cvt_pk_f16_f32 v2, v24, -v25
    ds_write_b32 v3, v2 offset:22176
    v_pk_mul_f32 v[26:27], v[24:25], v[18:19] op_sel:[0,0] op_sel_hi:[0,1]
    v_pk_fma_f32 v[26:27], v[24:25], v[18:19], v[26:27] op_sel:[1,1,0] op_sel_hi:[1,0,1] neg_lo:[1,0,0]
    v_cvt_pk_f16_f32 v2, v26, -v27
    ds_write_b32 v3, v2 offset:22704
    v_pk_mul_f32 v[24:25], v[26:27], v[18:19] op_sel:[0,0] op_sel_hi:[0,1]
    v_pk_fma_f32 v[24:25], v[26:27], v[18:19], v[24:25] op_sel:[1,1,0] op_sel_hi:[1,0,1] neg_lo:[1,0,0]
    v_cvt_pk_f16_f32 v2, v24, -v25
    ds_write_b32 v3, v2 offset:23232
    v_pk_mul_f32 v[26:27], v[24:25], v[18:19] op_sel:[0,0] op_sel_hi:[0,1]
    v_pk_fma_f32 v[26:27], v[24:25], v[18:19], v[26:27] op_sel:[1,1,0] op_sel_hi:[1,0,1] neg_lo:[1,0,0]
    v_cvt_pk_f16_f32 v2, v26, -v27
    ds_write_b32 v3, v2 offset:23760
    v_pk_mul_f32 v[24:25], v[26:27], v[18:19] op_sel:[0,0] op_sel_hi:[0,1]
    v_pk_fma_f32 v[24:25], v[26:27], v[18:19], v[24:25] op_sel:[1,1,0] op_sel_hi:[1,0,1] neg_lo:[1,0,0]
    v_cvt_pk_f16_f32 v2, v24, -v25
    ds_write_b32 v3, v2 offset:24288
    v_pk_mul_f32 v[26:27], v[24:25], v[18:19] op_sel:[0,0] op_sel_hi:[0,1]
    v_pk_fma_f32 v[26:27], v[24:25], v[18:19], v[26:27] op_sel:[1,1,0] op_sel_hi:[1,0,1] neg_lo:[1,0,0]
    v_cvt_pk_f16_f32 v2, v26, -v27
    ds_write_b32 v3, v2 offset:24816
    v_cvt_pk_f16_f32 v2, v16, v17
    ds_write_b32 v3, v2 offset:0
    v_pk_mul_f32 v[28:29], v[16:17], v[22:23] op_sel:[0,0] op_sel_hi:[0,1]
    v_pk_fma_f32 v[28:29], v[16:17], v[22:23], v[28:29] op_sel:[1,1,0] op_sel_hi:[1,0,1] neg_lo:[1,0,0]
    v_cvt_pk_f16_f32 v2, v28, v29
    ds_write_b32 v3, v2 offset:4224
    v_pk_mul_f32 v[24:25], v[16:17], v[20:21] op_sel:[0,0] op_sel_hi:[0,1]
    v_pk_fma_f32 v[24:25], v[16:17], v[20:21], v[24:25] op_sel:[1,1,0] op_sel_hi:[1,0,1] neg_lo:[1,0,0]
    v_cvt_pk_f16_f32 v2, v24, v25
    ds_write_b32 v3, v2 offset:528
    v_pk_mul_f32 v[26:27], v[24:25], v[20:21] op_sel:[0,0] op_sel_hi:[0,1]
    v_pk_fma_f32 v[26:27], v[24:25], v[20:21], v[26:27] op_sel:[1,1,0] op_sel_hi:[1,0,1] neg_lo:[1,0,0]
    v_cvt_pk_f16_f32 v2, v26, v27
    ds_write_b32 v3, v2 offset:1056
    v_pk_mul_f32 v[28:29], v[26:27], v[22:23] op_sel:[0,0] op_sel_hi:[0,1]
    v_pk_fma_f32 v[28:29], v[26:27], v[22:23], v[28:29] op_sel:[1,1,0] op_sel_hi:[1,0,1] neg_lo:[1,0,0]
    v_cvt_pk_f16_f32 v2, v28, v29
    ds_write_b32 v3, v2 offset:4752
    v_pk_mul_f32 v[24:25], v[26:27], v[20:21] op_sel:[0,0] op_sel_hi:[0,1]
    v_pk_fma_f32 v[24:25], v[26:27], v[20:21], v[24:25] op_sel:[1,1,0] op_sel_hi:[1,0,1] neg_lo:[1,0,0]
    v_cvt_pk_f16_f32 v2, v24, v25
    ds_write_b32 v3, v2 offset:1584
    v_pk_mul_f32 v[26:27], v[24:25], v[20:21] op_sel:[0,0] op_sel_hi:[0,1]
    v_pk_fma_f32 v[26:27], v[24:25], v[20:21], v[26:27] op_sel:[1,1,0] op_sel_hi:[1,0,1] neg_lo:[1,0,0]
    v_cvt_pk_f16_f32 v2, v26, v27
    ds_write_b32 v3, v2 offset:2112
    v_pk_mul_f32 v[28:29], v[26:27], v[22:23] op_sel:[0,0] op_sel_hi:[0,1]
    v_pk_fma_f32 v[28:29], v[26:27], v[22:23], v[28:29] op_sel:[1,1,0] op_sel_hi:[1,0,1] neg_lo:[1,0,0]
    v_cvt_pk_f16_f32 v2, v28, v29
    ds_write_b32 v3, v2 offset:5280
    v_pk_mul_f32 v[24:25], v[26:27], v[20:21] op_sel:[0,0] op_sel_hi:[0,1]
    v_pk_fma_f32 v[24:25], v[26:27], v[20:21], v[24:25] op_sel:[1,1,0] op_sel_hi:[1,0,1] neg_lo:[1,0,0]
    v_cvt_pk_f16_f32 v2, v24, v25
    ds_write_b32 v3, v2 offset:2640
    v_pk_mul_f32 v[26:27], v[24:25], v[20:21] op_sel:[0,0] op_sel_hi:[0,1]
    v_pk_fma_f32 v[26:27], v[24:25], v[20:21], v[26:27] op_sel:[1,1,0] op_sel_hi:[1,0,1] neg_lo:[1,0,0]
    v_cvt_pk_f16_f32 v2, v26, v27
    ds_write_b32 v3, v2 offset:3168
    v_pk_mul_f32 v[28:29], v[26:27], v[22:23] op_sel:[0,0] op_sel_hi:[0,1]
    v_pk_fma_f32 v[28:29], v[26:27], v[22:23], v[28:29] op_sel:[1,1,0] op_sel_hi:[1,0,1] neg_lo:[1,0,0]
    v_cvt_pk_f16_f32 v2, v28, v29
    ds_write_b32 v3, v2 offset:5808
    v_pk_mul_f32 v[24:25], v[26:27], v[20:21] op_sel:[0,0] op_sel_hi:[0,1]
    v_pk_fma_f32 v[24:25], v[26:27], v[20:21], v[24:25] op_sel:[1,1,0] op_sel_hi:[1,0,1] neg_lo:[1,0,0]
    v_cvt_pk_f16_f32 v2, v24, v25
    ds_write_b32 v3, v2 offset:3696
    s_nop 0
    s_branch K1_KG_B
K1_KG_H1:
    v_mul_f32 v4, 8.0, v8
    v_mul_f32 v5, 8.0, v9
    v_exp_f32 v4, v4
    v_fract_f32 v5, v5
    v_cos_f32 v6, v5
    v_sin_f32 v7, v5
    v_mul_f32 v18, v4, v6
    v_mul_f32 v19, v4, v7
    v_mul_f32 v4, 128.0, v8
    v_mul_f32 v5, 128.0, v9
    v_exp_f32 v4, v4
    v_fract_f32 v5, v5
    v_cos_f32 v6, v5
    v_sin_f32 v7, v5
    v_mul_f32 v24, v4, v6
    v_mul_f32 v25, v4, v7
    v_mul_f32 v4, 4.0, v8
    v_mul_f32 v5, 4.0, v9
    v_exp_f32 v4, v4
    v_fract_f32 v5, v5
    v_cos_f32 v6, v5
    v_sin_f32 v7, v5
    v_mul_f32 v20, v4, v6
    v_mul_f32 v21, v4, v7
    v_pk_mul_f32 v[22:23], v[24:25], v[24:25] op_sel:[0,0] op_sel_hi:[0,1]
    v_pk_fma_f32 v[22:23], v[24:25], v[24:25], v[22:23] op_sel:[1,1,0] op_sel_hi:[1,0,1] neg_lo:[1,0,0]
    v_pk_mul_f32 v[28:29], v[22:23], v[22:23] op_sel:[0,0] op_sel_hi:[0,1]
    v_pk_fma_f32 v[28:29], v[22:23], v[22:23], v[28:29] op_sel:[1,1,0] op_sel_hi:[1,0,1] neg_lo:[1,0,0]
    v_pk_mul_f32 v[30:31], v[28:29], v[28:29] op_sel:[0,0] op_sel_hi:[0,1]
    v_pk_fma_f32 v[30:31], v[28:29], v[28:29], v[30:31] op_sel:[1,1,0] op_sel_hi:[1,0,1] neg_lo:[1,0,0]
    v_cvt_pk_f16_f32 v2, v24, -v25
    ds_write_b32 v3, v2 offset:25344
    v_pk_mul_f32 v[26:27], v[24:25], v[18:19] op_sel:[0,0] op_sel_hi:[0,1]
    v_pk_fma_f32 v[26:27], v[24:25], v[18:19], v[26:27] op_sel:[1,1,0] op_sel_hi:[1,0,1] neg_lo:[1,0,0]
    v_cvt_pk_f16_f32 v2, v26, -v27
    ds_write_b32 v3, v2 offset:25872
    v_pk_mul_f32 v[24:25], v[26:27], v[18:19] op_sel:[0,0] op_sel_hi:[0,1]
    v_pk_fma_f32 v[24:25], v[26:27], v[18:19], v[24:25] op_sel:[1,1,0] op_sel_hi:[1,0,1] neg_lo:[1,0,0]
    v_cvt_pk_f16_f32 v2, v24, -v25
    ds_write_b32 v3, v2 offset:26400
    v_pk_mul_f32 v[26:27], v[24:25], v[18:19] op_sel:[0,0] op_sel_hi:[0,1]
    v_pk_fma_f32 v[26:27], v[24:25], v[18:19], v[26:27] op_sel:[1,1,0] op_sel_hi:[1,0,1] neg_lo:[1,0,0]
    v_cvt_pk_f16_f32 v2, v26, -v27
    ds_write_b32 v3, v2 offset:26928
    v_pk_mul_f32 v[24:25], v[26:27], v[18:19] op_sel:[0,0] op_sel_hi:[0,1]
    v_pk_fma_f32 v[24:25], v[26:27], v[18:19], v[24:25] op_sel:[1,1,0] op_sel_hi:[1,0,1] neg_lo:[1,0,0]
    v_cvt_pk_f16_f32 v2, v24, -v25
    ds_write_b32 v3, v2 offset:27456
    v_pk_mul_f32 v[26:27], v[24:25], v[18:19] op_sel:[0,0] op_sel_hi:[0,1]
    v_pk_fma_f32 v[26:27], v[24:25], v[18:19], v[26:27] op_sel:[1,1,0] op_sel_hi:[1,0,1] neg_lo:[1,0,0]
    v_cvt_pk_f16_f32 v2, v26, -v27
    ds_write_b32 v3, v2 offset:27984
    v_pk_mul_f32 v[24:25], v[26:27], v[18:19] op_sel:[0,0] op_sel_hi:[0,1]
    v_pk_fma_f32 v[24:25], v[26:27], v[18:19], v[24:25] op_sel:[1,1,0] op_sel_hi:[1,0,1] neg_lo:[1,0,0]
    v_cvt_pk_f16_f32 v2, v24, -v25
    ds_write_b32 v3, v2 offset:28512
    v_pk_mul_f32 v[26:27], v[24:25], v[18:19] op_sel:[0,0] op_sel_hi:[0,1]
    v_pk_fma_f32 v[26:27], v[24:25], v[18:19], v[26:27] op_sel:[1,1,0] op_sel_hi:[1,0,1] neg_lo:[1,0,0]
    v_cvt_pk_f16_f32 v2, v26, -v27
    ds_write_b32 v3, v2 offset:29040
    v_pk_mul_f32 v[24:25], v[26:27], v[18:19] op_sel:[0,0] op_sel_hi:[0,1]
    v_pk_fma_f32 v[24:25], v[26:27], v[18:19], v[24:25] op_sel:[1,1,0] op_sel_hi:[1,0,1] neg_lo:[1,0,0]
    v_cvt_pk_f16_f32 v2, v24, -v25
    ds_write_b32 v3, v2 offset:29568
    v_pk_mul_f32 v[26:27], v[24:25], v[18:19] op_sel:[0,0] op_sel_hi:[0,1]
    v_pk_fma_f32 v[26:27], v[24:25], v[18:19], v[26:27] op_sel:[1,1,0] op_sel_hi:[1,0,1] neg_lo:[1,0,0]
    v_cvt_pk_f16_f32 v2, v26, -v27
    ds_write_b32 v3, v2 offset:30096
    v_pk_mul_f32 v[24:25], v[26:27], v[18:19] op_sel:[0,0] op_sel_hi:[0,1]
    v_pk_fma_f32 v[24:25], v[26:27], v[18:19], v[24:25] op_sel:[1,1,0] op_sel_hi:[1,0,1] neg_lo:[1,0,0]
    v_cvt_pk_f16_f32 v2, v24, -v25
    ds_write_b32 v3, v2 offset:30624
    v_pk_mul_f32 v[26:27], v[24:25], v[18:19] op_sel:[0,0] op_sel_hi:[0,1]
    v_pk_fma_f32 v[26:27], v[24:25], v[18:19], v[26:27] op_sel:[1,1,0] op_sel_hi:[1,0,1] neg_lo:[1,0,0]
    v_cvt_pk_f16_f32 v2, v26, -v27
    ds_write_b32 v3, v2 offset:31152
    v_pk_mul_f32 v[24:25], v[26:27], v[18:19] op_sel:[0,0] op_sel_hi:[0,1]
    v_pk_fma_f32 v[24:25], v[26:27], v[18:19], v[24:25] op_sel:[1,1,0] op_sel_hi:[1,0,1] neg_lo:[1,0,0]
    v_cvt_pk_f16_f32 v2, v24, -v25
    ds_write_b32 v3, v2 offset:31680
    v_pk_mul_f32 v[26:27], v[24:25], v[18:19] op_sel:[0,0] op_sel_hi:[0,1]
    v_pk_fma_f32 v[26:27], v[24:25], v[18:19], v[26:27] op_sel:[1,1,0] op_sel_hi:[1,0,1] neg_lo:[1,0,0]
    v_cvt_pk_f16_f32 v2, v26, -v27
    ds_write_b32 v3, v2 offset:32208
    v_pk_mul_f32 v[24:25], v[26:27], v[18:19] op_sel:[0,0] op_sel_hi:[0,1]
    v_pk_fma_f32 v[24:25], v[26:27], v[18:19], v[24:25] op_sel:[1,1,0] op_sel_hi:[1,0,1] neg_lo:[1,0,0]
    v_cvt_pk_f16_f32 v2, v24, -v25
    ds_write_b32 v3, v2 offset:32736
    v_pk_mul_f32 v[26:27], v[24:25], v[18:19] op_sel:[0,0] op_sel_hi:[0,1]
    v_pk_fma_f32 v[26:27], v[24:25], v[18:19], v[26:27] op_sel:[1,1,0] op_sel_hi:[1,0,1] neg_lo:[1,0,0]
    v_cvt_pk_f16_f32 v2, v26, -v27
    ds_write_b32 v3, v2 offset:33264
    v_pk_mul_f32 v[24:25], v[16:17], v[28:29] op_sel:[0,0] op_sel_hi:[0,1]
    v_pk_fma_f32 v[24:25], v[16:17], v[28:29], v[24:25] op_sel:[1,1,0] op_sel_hi:[1,0,1] neg_lo:[1,0,0]
    v_cvt_pk_f16_f32 v2, v24, v25
    ds_write_b32 v3, v2 offset:6336
    v_pk_mul_f32 v[26:27], v[24:25], v[20:21] op_sel:[0,0] op_sel_hi:[0,1]
    v_pk_fma_f32 v[26:27], v[24:25], v[20:21], v[26:27] op_sel:[1,1,0] op_sel_hi:[1,0,1] neg_lo:[1,0,0]
    v_cvt_pk_f16_f32 v2, v26, v27
    ds_write_b32 v3, v2 offset:6864
    v_pk_mul_f32 v[26:27], v[24:25], v[22:23] op_sel:[0,0] op_sel_hi:[0,1]
    v_pk_fma_f32 v[26:27], v[24:25], v[22:23], v[26:27] op_sel:[1,1,0] op_sel_hi:[1,0,1] neg_lo:[1,0,0]
    v_cvt_pk_f16_f32 v2, v26, v27
    ds_write_b32 v3, v2 offset:7392
    v_pk_mul_f32 v[24:25], v[26:27], v[20:21] op_sel:[0,0] op_sel_hi:[0,1]
    v_pk_fma_f32 v[24:25], v[26:27], v[20:21], v[24:25] op_sel:[1,1,0] op_sel_hi:[1,0,1] neg_lo:[1,0,0]
    v_cvt_pk_f16_f32 v2, v24, v25
    ds_write_b32 v3, v2 offset:7920
    v_pk_mul_f32 v[24:25], v[16:17], v[30:31] op_sel:[0,0] op_sel_hi:[0,1]
    v_pk_fma_f32 v[24:25], v[16:17], v[30:31], v[24:25] op_sel:[1,1,0] op_sel_hi:[1,0,1] neg_lo:[1,0,0]
    v_cvt_pk_f16_f32 v2, v24, v25
    ds_write_b32 v3, v2 offset:8448
    v_pk_mul_f32 v[26:27], v[24:25], v[22:23] op_sel:[0,0] op_sel_hi:[0,1]
    v_pk_fma_f32 v[26:27], v[24:25], v[22:23], v[26:27] op_sel:[1,1,0] op_sel_hi:[1,0,1] neg_lo:[1,0,0]
    v_cvt_pk_f16_f32 v2, v26, v27
    ds_write_b32 v3, v2 offset:8976
    v_pk_mul_f32 v[24:25], v[26:27], v[22:23] op_sel:[0,0] op_sel_hi:[0,1]
    v_pk_fma_f32 v[24:25], v[26:27], v[22:23], v[24:25] op_sel:[1,1,0] op_sel_hi:[1,0,1] neg_lo:[1,0,0]
    v_cvt_pk_f16_f32 v2, v24, v25
    ds_write_b32 v3, v2 offset:9504
    v_pk_mul_f32 v[26:27], v[24:25], v[22:23] op_sel:[0,0] op_sel_hi:[0,1]
    v_pk_fma_f32 v[26:27], v[24:25], v[22:23], v[26:27] op_sel:[1,1,0] op_sel_hi:[1,0,1] neg_lo:[1,0,0]
    v_cvt_pk_f16_f32 v2, v26, v27
    ds_write_b32 v3, v2 offset:10032
    v_pk_mul_f32 v[24:25], v[26:27], v[22:23] op_sel:[0,0] op_sel_hi:[0,1]
    v_pk_fma_f32 v[24:25], v[26:27], v[22:23], v[24:25] op_sel:[1,1,0] op_sel_hi:[1,0,1] neg_lo:[1,0,0]
    v_cvt_pk_f16_f32 v2, v24, v25
    ds_write_b32 v3, v2 offset:10560
    s_nop 0
K1_KG_B:
    v_and_b32 v4, 15, v0
    v_bfe_u32 v5, v0, 4, 2
    s_lshl_b32 s43, s42, 4
    v_add_u32 v6, s43, v4
    v_mul_u32_u24 v6, 528, v6
    v_lshl_add_u32 v6, v5, 4, v6
    s_lshl_b32 s43, s41, 4
    v_add_u32 v7, s43, v4
    v_mul_u32_u24 v7, 528, v7
    v_lshl_add_u32 v7, v5, 4, v7
    s_waitcnt lgkmcnt(0)
    s_barrier
    ds_read_b128 v[32:35], v6 offset:0
    ds_read_b128 v[64:67], v7 offset:16896
    ds_read_b128 v[36:39], v6 offset:64
    ds_read_b128 v[68:71], v7 offset:16960
    ds_read_b128 v[40:43], v6 offset:128
    ds_read_b128 v[72:75], v7 offset:17024
    ds_read_b128 v[44:47], v6 offset:192
    ds_read_b128 v[76:79], v7 offset:17088
    ds_read_b128 v[48:51], v6 offset:256
    ds_read_b128 v[80:83], v7 offset:17152
    ds_read_b128 v[52:55], v6 offset:320
    ds_read_b128 v[84:87], v7 offset:17216
    ds_read_b128 v[56:59], v6 offset:384
    ds_read_b128 v[88:91], v7 offset:17280
    ds_read_b128 v[60:63], v6 offset:448
    ds_read_b128 v[92:95], v7 offset:17344
    s_waitcnt lgkmcnt(14)
    v_mfma_f32_16x16x32_f16 v[8:11], v[32:35], v[64:67], 0
    s_waitcnt lgkmcnt(12)
    v_mfma_f32_16x16x32_f16 v[8:11], v[36:39], v[68:71], v[8:11]
    s_waitcnt lgkmcnt(10)
    v_mfma_f32_16x16x32_f16 v[8:11], v[40:43], v[72:75], v[8:11]
    s_waitcnt lgkmcnt(8)
    v_mfma_f32_16x16x32_f16 v[8:11], v[44:47], v[76:79], v[8:11]
    s_waitcnt lgkmcnt(6)
    v_mfma_f32_16x16x32_f16 v[8:11], v[48:51], v[80:83], v[8:11]
    s_waitcnt lgkmcnt(4)
    v_mfma_f32_16x16x32_f16 v[8:11], v[52:55], v[84:87], v[8:11]
    s_waitcnt lgkmcnt(2)
    v_mfma_f32_16x16x32_f16 v[8:11], v[56:59], v[88:91], v[8:11]
    s_waitcnt lgkmcnt(0)
    v_mfma_f32_16x16x32_f16 v[8:11], v[60:63], v[92:95], v[8:11]
    s_nop 7
    v_cvt_pk_f16_f32 v12, v8, v9
    v_cvt_pk_f16_f32 v13, v10, v11
    ds_write_b16 v124, v12 offset:33792
    ds_write_b16_d16_hi v125, v12 offset:33792
    ds_write_b16 v126, v13 offset:33792
    ds_write_b16_d16_hi v127, v13 offset:33792
    s_waitcnt lgkmcnt(0)
    s_barrier
    ds_read_u16 v24, v100 offset:33792
    ds_read_u16 v25, v101 offset:33792
    ds_read_u16 v26, v102 offset:33792
    ds_read_u16 v27, v103 offset:33792
    ds_read_u16 v28, v104 offset:33792
    ds_read_u16 v29, v105 offset:33792
    ds_read_u16 v30, v106 offset:33792
    ds_read_u16 v31, v107 offset:33792
    ds_read_u16 v32, v108 offset:33792
    v_lshlrev_b32 v2, 4, v0
    s_mul_i32 s36, s3, 8320
    s_add_u32 s37, s36, 4096
    v_cmp_gt_u32 vcc, 255, v0
    s_waitcnt lgkmcnt(0)
    s_nop 0
    v_cndmask_b32 v32, 0, v32, vcc
    v_lshl_or_b32 v16, v25, 16, v24
    v_lshl_or_b32 v17, v27, 16, v26
    v_lshl_or_b32 v18, v29, 16, v28
    v_lshl_or_b32 v19, v31, 16, v30
    v_lshl_or_b32 v20, v26, 16, v25
    v_lshl_or_b32 v21, v28, 16, v27
    v_lshl_or_b32 v22, v30, 16, v29
    v_lshl_or_b32 v23, v32, 16, v31
    buffer_store_dwordx4 v[16:19], v2, s[32:35], s36 offen
    buffer_store_dwordx4 v[20:23], v2, s[32:35], s37 offen
    s_nop 1
K1_END:
    s_endpgm
.text
.globl k2_kernel
.p2align 8
.type k2_kernel,@function
k2_kernel:

    s_cmp_ge_u32 s2, 576
    s_cbranch_scc1 K2_END
    s_load_dwordx2 s[4:5], s[0:1], 136
    s_load_dwordx2 s[24:25], s[0:1], 64
    v_readfirstlane_b32 s38, v0
    s_lshr_b32 s38, s38, 6
    v_and_b32 v1, 15, v0
    v_bfe_u32 v2, v0, 4, 2
    s_and_b32 s36, s2, 7
    s_mul_i32 s36, s36, 72
    s_lshr_b32 s37, s2, 3
    s_add_u32 s3, s36, s37
    s_and_b32 s37, s3, -2
    s_lshl_b32 s37, s37, 1
    s_lshl_b32 s39, s3, 2
    s_waitcnt lgkmcnt(0)
    s_load_dword s40, s[24:25], s37
    s_cmp_ge_u32 s3, 288
    s_cselect_b32 s52, 8, 0
    s_cselect_b32 s53, 288, 0
    s_sub_u32 s53, s3, s53
    s_add_u32 s52, s52, 80
    s_load_dwordx2 s[56:57], s[0:1], s52
    s_mul_i32 s53, s53, 18432
    v_lshlrev_b32 v154, 4, v0
    v_add_u32 v154, s53, v154
    s_add_u32 s8, s4, 0x4000000
    s_addc_u32 s9, s5, 0
    s_mov_b32 s10, 0x492000
    s_mov_b32 s11, 0x20000
    s_add_u32 s12, s4, 0x280000
    s_addc_u32 s13, s5, 0
    s_mov_b32 s14, 0x488000
    s_mov_b32 s15, 0x20000
    s_add_u32 s16, s4, 0x720000
    s_addc_u32 s17, s5, 0
    s_mov_b32 s18, 0x252000
    s_mov_b32 s19, 0x20000
    s_add_u32 s20, s4, s39
    s_addc_u32 s21, s5, 0
    s_load_dword s41, s[20:21], 0
    s_load_dword s42, s[20:21], 2304
    s_load_dword s43, s[20:21], 4608
    v_lshrrev_b32 v3, 1, v2
    v_lshl_add_u32 v3, v1, 1, v3
    v_mul_u32_u24 v3, 18560, v3
    v_and_b32 v4, 1, v2
    v_lshl_add_u32 v3, v4, 4, v3
    s_mul_i32 s44, s38, 1187840
    s_lshl_b32 s45, s3, 5
    s_add_u32 s44, s44, s45
    s_add_u32 s45, s44, 593920
    buffer_load_dwordx4 v[8:11], v3, s[12:15], s44 offen
    buffer_load_dwordx4 v[12:15], v3, s[12:15], s45 offen
    v_and_b32 v4, 63, v0
    v_lshlrev_b32 v4, 4, v4
    s_mul_i32 s46, s3, 8320
    s_lshl_b32 s47, s38, 10
    s_add_u32 s46, s46, s47
    s_add_u32 m0, s47, 37376
    s_nop 0
    buffer_load_dwordx4 v4, s[8:11], s46 offen lds
    s_add_u32 s46, s46, 4096
    s_add_u32 m0, s47, 41536
    s_nop 0
    buffer_load_dwordx4 v4, s[8:11], s46 offen lds
    v_lshlrev_b32 v152, 3, v2
    v_sub_u32 v152, v152, v1
    v_add_u32 v152, 15, v152
    v_and_b32 v153, 1, v152
    v_and_b32 v152, -2, v152
    v_lshlrev_b32 v152, 1, v152
    v_mul_u32_u24 v153, 4160, v153
    v_add_u32 v152, v152, v153
    v_add_u32 v152, 37376, v152
    s_sub_u32 s47, 7, s38
    s_lshl_b32 s47, s47, 9
    v_add_u32 v153, s47, v152
    s_lshl_b32 s48, s38, 9
    v_add_u32 v152, s48, v152
    v_mov_b32 v16, 0
    v_mov_b32 v17, 0
    v_mov_b32 v18, 0
    v_mov_b32 v19, 0
    v_lshlrev_b32 v5, 4, v0
    v_cmp_gt_u32 vcc, 30, v0
    s_and_saveexec_b64 s[50:51], vcc
    s_nop 3
    s_cbranch_execz K2_Z
    ds_write_b128 v5, v[16:19]
    v_cmp_gt_u32 vcc, 4, v0
    s_and_b64 exec, exec, vcc
    ds_write_b128 v5, v[16:19] offset:41472
    ds_write_b128 v5, v[16:19] offset:45632
    s_nop 1
K2_Z:
    s_mov_b64 exec, s[50:51]
    v_mov_b32 v96, 0
    v_mov_b32 v97, 0
    v_mov_b32 v98, 0
    v_mov_b32 v99, 0
    v_mov_b32 v100, 0
    v_mov_b32 v101, 0
    v_mov_b32 v102, 0
    v_mov_b32 v103, 0
    v_mov_b32 v104, 0
    v_mov_b32 v105, 0
    v_mov_b32 v106, 0
    v_mov_b32 v107, 0
    v_mov_b32 v108, 0
    v_mov_b32 v109, 0
    v_mov_b32 v110, 0
    v_mov_b32 v111, 0
    v_mov_b32 v112, 0
    v_mov_b32 v113, 0
    v_mov_b32 v114, 0
    v_mov_b32 v115, 0
    v_mov_b32 v116, 0
    v_mov_b32 v117, 0
    v_mov_b32 v118, 0
    v_mov_b32 v119, 0
    v_mov_b32 v120, 0
    v_mov_b32 v121, 0
    v_mov_b32 v122, 0
    v_mov_b32 v123, 0
    v_mov_b32 v124, 0
    v_mov_b32 v125, 0
    v_mov_b32 v126, 0
    v_mov_b32 v127, 0
    v_lshlrev_b32 v5, 5, v1
    v_lshl_add_u32 v5, v2, 3, v5
    s_lshl_b32 s49, s38, 10
    v_add_u32 v5, s49, v5
    v_lshlrev_b32 v6, 5, v1
    v_lshl_add_u32 v6, v2, 4, v6
    s_waitcnt lgkmcnt(0)
    s_and_b32 s45, s3, 1
    s_lshl_b32 s45, s45, 4
    s_lshr_b32 s40, s40, s45
    s_lshl_b32 s40, s40, 16
    v_mov_b32 v7, s42
    v_add_f32 v7, 1.0, v7
    v_cvt_pk_bf16_f32 v7, v7, v7
    v_lshlrev_b32 v7, 16, v7
    s_waitcnt vmcnt(2)
    v_lshlrev_b32 v16, 16, v8
    v_lshlrev_b32 v17, 16, v9
    v_lshlrev_b32 v18, 16, v10
    v_lshlrev_b32 v19, 16, v11
    v_lshlrev_b32 v20, 16, v12
    v_lshlrev_b32 v21, 16, v13
    v_lshlrev_b32 v22, 16, v14
    v_lshlrev_b32 v23, 16, v15
    v_mul_f32 v16, v16, v7
    v_mul_f32 v17, v17, v7
    v_mul_f32 v18, v18, v7
    v_mul_f32 v19, v19, v7
    v_mul_f32 v20, v20, v7
    v_mul_f32 v21, v21, v7
    v_mul_f32 v22, v22, v7
    v_mul_f32 v23, v23, v7
    v_cvt_pk_bf16_f32 v28, v16, v17
    v_cvt_pk_bf16_f32 v29, v18, v19
    v_cvt_pk_bf16_f32 v30, v20, v21
    v_cvt_pk_bf16_f32 v31, v22, v23
    v_lshlrev_b32 v16, 16, v28
    v_and_b32 v17, 0xffff0000, v28
    v_lshlrev_b32 v18, 16, v29
    v_and_b32 v19, 0xffff0000, v29
    v_lshlrev_b32 v20, 16, v30
    v_and_b32 v21, 0xffff0000, v30
    v_lshlrev_b32 v22, 16, v31
    v_and_b32 v23, 0xffff0000, v31
    v_add_f32 v16, s41, v16
    v_add_f32 v17, s41, v17
    v_add_f32 v18, s41, v18
    v_add_f32 v19, s41, v19
    v_add_f32 v20, s41, v20
    v_add_f32 v21, s41, v21
    v_add_f32 v22, s41, v22
    v_add_f32 v23, s41, v23
    v_cvt_pk_bf16_f32 v28, v16, v17
    v_cvt_pk_bf16_f32 v29, v18, v19
    v_cvt_pk_bf16_f32 v30, v20, v21
    v_cvt_pk_bf16_f32 v31, v22, v23
    v_lshlrev_b32 v16, 16, v28
    v_and_b32 v17, 0xffff0000, v28
    v_lshlrev_b32 v18, 16, v29
    v_and_b32 v19, 0xffff0000, v29
    v_lshlrev_b32 v20, 16, v30
    v_and_b32 v21, 0xffff0000, v30
    v_lshlrev_b32 v22, 16, v31
    v_and_b32 v23, 0xffff0000, v31
    v_cvt_pk_f16_f32 v28, v16, v17
    v_cvt_pk_f16_f32 v29, v18, v19
    v_cvt_pk_f16_f32 v30, v20, v21
    v_cvt_pk_f16_f32 v31, v22, v23
    ds_write_b64 v5, v[28:29] offset:480
    ds_write_b64 v5, v[30:31] offset:992
    v_mul_f32 v16, s40, v16
    v_mul_f32 v17, s40, v17
    v_mul_f32 v18, s40, v18
    v_mul_f32 v19, s40, v19
    v_mul_f32 v20, s40, v20
    v_mul_f32 v21, s40, v21
    v_mul_f32 v22, s40, v22
    v_mul_f32 v23, s40, v23
    v_cvt_pk_bf16_f32 v24, v16, v17
    v_cvt_pk_bf16_f32 v25, v18, v19
    v_cvt_pk_bf16_f32 v26, v20, v21
    v_cvt_pk_bf16_f32 v27, v22, v23
    s_waitcnt vmcnt(0) lgkmcnt(0)
    s_barrier
    s_mov_b32 s58, 5308416
    s_mov_b32 s59, 0x20000
    s_mov_b32 s60, 0
    buffer_load_dwordx4 v[156:159], v154, s[56:59], s60 offen
    s_mov_b32 s60, 4096
    buffer_load_dwordx4 v[156:159], v154, s[56:59], s60 offen
    s_mov_b32 s60, 8192
    buffer_load_dwordx4 v[156:159], v154, s[56:59], s60 offen
    s_mov_b32 s60, 12288
    buffer_load_dwordx4 v[156:159], v154, s[56:59], s60 offen
    s_mov_b32 s60, 16384
    s_cmp_ge_u32 s38, 2
    s_cbranch_scc1 K2_PFS
    buffer_load_dwordx4 v[156:159], v154, s[56:59], s60 offen
K2_PFS:
    ds_read2_b32 v[32:33], v153 offset0:0 offset1:1
    ds_read2_b32 v[34:35], v153 offset0:2 offset1:3
    ds_read2_b32 v[36:37], v153 offset0:16 offset1:17
    ds_read2_b32 v[38:39], v153 offset0:18 offset1:19
    ds_read2_b32 v[40:41], v153 offset0:32 offset1:33
    ds_read2_b32 v[42:43], v153 offset0:34 offset1:35
    ds_read2_b32 v[44:45], v153 offset0:48 offset1:49
    ds_read2_b32 v[46:47], v153 offset0:50 offset1:51
    ds_read2_b32 v[48:49], v153 offset0:64 offset1:65
    ds_read2_b32 v[50:51], v153 offset0:66 offset1:67
    ds_read2_b32 v[52:53], v153 offset0:80 offset1:81
    ds_read2_b32 v[54:55], v153 offset0:82 offset1:83
    ds_read2_b32 v[56:57], v153 offset0:96 offset1:97
    ds_read2_b32 v[58:59], v153 offset0:98 offset1:99
    ds_read2_b32 v[60:61], v153 offset0:112 offset1:113
    ds_read2_b32 v[62:63], v153 offset0:114 offset1:115
    ds_read2_b32 v[64:65], v152 offset0:0 offset1:1
    ds_read2_b32 v[66:67], v152 offset0:2 offset1:3
    ds_read2_b32 v[68:69], v152 offset0:16 offset1:17
    ds_read2_b32 v[70:71], v152 offset0:18 offset1:19
    ds_read2_b32 v[72:73], v152 offset0:32 offset1:33
    ds_read2_b32 v[74:75], v152 offset0:34 offset1:35
    ds_read2_b32 v[76:77], v152 offset0:48 offset1:49
    ds_read2_b32 v[78:79], v152 offset0:50 offset1:51
    ds_read2_b32 v[80:81], v152 offset0:64 offset1:65
    ds_read2_b32 v[82:83], v152 offset0:66 offset1:67
    ds_read2_b32 v[84:85], v152 offset0:80 offset1:81
    ds_read2_b32 v[86:87], v152 offset0:82 offset1:83
    ds_read2_b32 v[88:89], v152 offset0:96 offset1:97
    ds_read2_b32 v[90:91], v152 offset0:98 offset1:99
    ds_read2_b32 v[92:93], v152 offset0:112 offset1:113
    ds_read2_b32 v[94:95], v152 offset0:114 offset1:115
    s_waitcnt lgkmcnt(0)
    s_cmp_eq_u32 s38, 1
    s_cbranch_scc1 K2_W1
    s_cmp_eq_u32 s38, 2
    s_cbranch_scc1 K2_W2
    s_cmp_eq_u32 s38, 3
    s_cbranch_scc1 K2_W3
    ds_read_b128 v[128:131], v6 offset:0
    ds_read_b128 v[132:135], v6 offset:64
    ds_read_b128 v[136:139], v6 offset:128
    ds_read_b128 v[140:143], v6 offset:192
    ds_read_b128 v[144:147], v6 offset:256
    ds_read_b128 v[148:151], v6 offset:320
    s_waitcnt lgkmcnt(5)
    v_mfma_f32_16x16x32_f16 v[96:99], v[32:35], v[128:131], v[96:99]
    v_mfma_f32_16x16x32_f16 v[124:127], v[64:67], v[128:131], v[124:127]
    ds_read_b128 v[128:131], v6 offset:384
    s_waitcnt lgkmcnt(5)
    v_mfma_f32_16x16x32_f16 v[96:99], v[36:39], v[132:135], v[96:99]
    v_mfma_f32_16x16x32_f16 v[124:127], v[68:71], v[132:135], v[124:127]
    ds_read_b128 v[132:135], v6 offset:448
    s_waitcnt lgkmcnt(5)
    v_mfma_f32_16x16x32_f16 v[96:99], v[40:43], v[136:139], v[96:99]
    v_mfma_f32_16x16x32_f16 v[124:127], v[72:75], v[136:139], v[124:127]
    ds_read_b128 v[136:139], v6 offset:512
    s_waitcnt lgkmcnt(5)
    v_mfma_f32_16x16x32_f16 v[96:99], v[44:47], v[140:143], v[96:99]
    v_mfma_f32_16x16x32_f16 v[124:127], v[76:79], v[140:143], v[124:127]
    ds_read_b128 v[140:143], v6 offset:576
    s_waitcnt lgkmcnt(5)
    v_mfma_f32_16x16x32_f16 v[96:99], v[48:51], v[144:147], v[96:99]
    v_mfma_f32_16x16x32_f16 v[124:127], v[80:83], v[144:147], v[124:127]
    ds_read_b128 v[144:147], v6 offset:640
    s_waitcnt lgkmcnt(5)
    v_mfma_f32_16x16x32_f16 v[96:99], v[52:55], v[148:151], v[96:99]
    v_mfma_f32_16x16x32_f16 v[124:127], v[84:87], v[148:151], v[124:127]
    ds_read_b128 v[148:151], v6 offset:704
    s_waitcnt lgkmcnt(5)
    v_mfma_f32_16x16x32_f16 v[96:99], v[56:59], v[128:131], v[96:99]
    v_mfma_f32_16x16x32_f16 v[124:127], v[88:91], v[128:131], v[124:127]
    ds_read_b128 v[128:131], v6 offset:768
    s_waitcnt lgkmcnt(5)
    v_mfma_f32_16x16x32_f16 v[96:99], v[60:63], v[132:135], v[96:99]
    v_mfma_f32_16x16x32_f16 v[124:127], v[92:95], v[132:135], v[124:127]
    ds_read_b128 v[132:135], v6 offset:832
    s_waitcnt lgkmcnt(5)
    v_mfma_f32_16x16x32_f16 v[100:103], v[32:35], v[136:139], v[100:103]
    ds_read_b128 v[136:139], v6 offset:896
    s_waitcnt lgkmcnt(5)
    v_mfma_f32_16x16x32_f16 v[100:103], v[36:39], v[140:143], v[100:103]
    ds_read_b128 v[140:143], v6 offset:960
    s_waitcnt lgkmcnt(5)
    v_mfma_f32_16x16x32_f16 v[100:103], v[40:43], v[144:147], v[100:103]
    ds_read_b128 v[144:147], v6 offset:1024
    s_waitcnt lgkmcnt(5)
    v_mfma_f32_16x16x32_f16 v[100:103], v[44:47], v[148:151], v[100:103]
    ds_read_b128 v[148:151], v6 offset:1088
    s_waitcnt lgkmcnt(5)
    v_mfma_f32_16x16x32_f16 v[100:103], v[48:51], v[128:131], v[100:103]
    ds_read_b128 v[128:131], v6 offset:1152
    s_waitcnt lgkmcnt(5)
    v_mfma_f32_16x16x32_f16 v[100:103], v[52:55], v[132:135], v[100:103]
    ds_read_b128 v[132:135], v6 offset:1216
    s_waitcnt lgkmcnt(5)
    v_mfma_f32_16x16x32_f16 v[100:103], v[56:59], v[136:139], v[100:103]
    ds_read_b128 v[136:139], v6 offset:1280
    s_waitcnt lgkmcnt(5)
    v_mfma_f32_16x16x32_f16 v[100:103], v[60:63], v[140:143], v[100:103]
    ds_read_b128 v[140:143], v6 offset:1344
    s_waitcnt lgkmcnt(5)
    v_mfma_f32_16x16x32_f16 v[104:107], v[32:35], v[144:147], v[104:107]
    ds_read_b128 v[144:147], v6 offset:1408
    s_waitcnt lgkmcnt(5)
    v_mfma_f32_16x16x32_f16 v[104:107], v[36:39], v[148:151], v[104:107]
    ds_read_b128 v[148:151], v6 offset:1472
    s_waitcnt lgkmcnt(5)
    v_mfma_f32_16x16x32_f16 v[104:107], v[40:43], v[128:131], v[104:107]
    ds_read_b128 v[128:131], v6 offset:1536
    s_waitcnt lgkmcnt(5)
    v_mfma_f32_16x16x32_f16 v[104:107], v[44:47], v[132:135], v[104:107]
    ds_read_b128 v[132:135], v6 offset:1600
    s_waitcnt lgkmcnt(5)
    v_mfma_f32_16x16x32_f16 v[104:107], v[48:51], v[136:139], v[104:107]
    ds_read_b128 v[136:139], v6 offset:1664
    s_waitcnt lgkmcnt(5)
    v_mfma_f32_16x16x32_f16 v[104:107], v[52:55], v[140:143], v[104:107]
    ds_read_b128 v[140:143], v6 offset:1728
    s_waitcnt lgkmcnt(5)
    v_mfma_f32_16x16x32_f16 v[104:107], v[56:59], v[144:147], v[104:107]
    ds_read_b128 v[144:147], v6 offset:1792
    s_waitcnt lgkmcnt(5)
    v_mfma_f32_16x16x32_f16 v[104:107], v[60:63], v[148:151], v[104:107]
    ds_read_b128 v[148:151], v6 offset:1856
    s_waitcnt lgkmcnt(5)
    v_mfma_f32_16x16x32_f16 v[108:111], v[32:35], v[128:131], v[108:111]
    ds_read_b128 v[128:131], v6 offset:1920
    s_waitcnt lgkmcnt(5)
    v_mfma_f32_16x16x32_f16 v[108:111], v[36:39], v[132:135], v[108:111]
    ds_read_b128 v[132:135], v6 offset:1984
    s_waitcnt lgkmcnt(5)
    v_mfma_f32_16x16x32_f16 v[108:111], v[40:43], v[136:139], v[108:111]
    ds_read_b128 v[136:139], v6 offset:2048
    s_waitcnt lgkmcnt(5)
    v_mfma_f32_16x16x32_f16 v[108:111], v[44:47], v[140:143], v[108:111]
    ds_read_b128 v[140:143], v6 offset:2112
    s_waitcnt lgkmcnt(5)
    v_mfma_f32_16x16x32_f16 v[108:111], v[48:51], v[144:147], v[108:111]
    ds_read_b128 v[144:147], v6 offset:2176
    s_waitcnt lgkmcnt(5)
    v_mfma_f32_16x16x32_f16 v[108:111], v[52:55], v[148:151], v[108:111]
    ds_read_b128 v[148:151], v6 offset:2240
    s_waitcnt lgkmcnt(5)
    v_mfma_f32_16x16x32_f16 v[108:111], v[56:59], v[128:131], v[108:111]
    ds_read_b128 v[128:131], v6 offset:2304
    s_waitcnt lgkmcnt(5)
    v_mfma_f32_16x16x32_f16 v[108:111], v[60:63], v[132:135], v[108:111]
    ds_read_b128 v[132:135], v6 offset:2368
    s_waitcnt lgkmcnt(5)
    v_mfma_f32_16x16x32_f16 v[112:115], v[32:35], v[136:139], v[112:115]
    ds_read_b128 v[136:139], v6 offset:2432
    s_waitcnt lgkmcnt(5)
    v_mfma_f32_16x16x32_f16 v[112:115], v[36:39], v[140:143], v[112:115]
    ds_read_b128 v[140:143], v6 offset:2496
    s_waitcnt lgkmcnt(5)
    v_mfma_f32_16x16x32_f16 v[112:115], v[40:43], v[144:147], v[112:115]
    ds_read_b128 v[144:147], v6 offset:2560
    s_waitcnt lgkmcnt(5)
    v_mfma_f32_16x16x32_f16 v[112:115], v[44:47], v[148:151], v[112:115]
    ds_read_b128 v[148:151], v6 offset:2624
    s_waitcnt lgkmcnt(5)
    v_mfma_f32_16x16x32_f16 v[112:115], v[48:51], v[128:131], v[112:115]
    ds_read_b128 v[128:131], v6 offset:2688
    s_waitcnt lgkmcnt(5)
    v_mfma_f32_16x16x32_f16 v[112:115], v[52:55], v[132:135], v[112:115]
    ds_read_b128 v[132:135], v6 offset:2752
    s_waitcnt lgkmcnt(5)
    v_mfma_f32_16x16x32_f16 v[112:115], v[56:59], v[136:139], v[112:115]
    ds_read_b128 v[136:139], v6 offset:2816
    s_waitcnt lgkmcnt(5)
    v_mfma_f32_16x16x32_f16 v[112:115], v[60:63], v[140:143], v[112:115]
    ds_read_b128 v[140:143], v6 offset:2880
    s_waitcnt lgkmcnt(5)
    v_mfma_f32_16x16x32_f16 v[116:119], v[32:35], v[144:147], v[116:119]
    ds_read_b128 v[144:147], v6 offset:2944
    s_waitcnt lgkmcnt(5)
    v_mfma_f32_16x16x32_f16 v[116:119], v[36:39], v[148:151], v[116:119]
    ds_read_b128 v[148:151], v6 offset:3008
    s_waitcnt lgkmcnt(5)
    v_mfma_f32_16x16x32_f16 v[116:119], v[40:43], v[128:131], v[116:119]
    ds_read_b128 v[128:131], v6 offset:3072
    s_waitcnt lgkmcnt(5)
    v_mfma_f32_16x16x32_f16 v[116:119], v[44:47], v[132:135], v[116:119]
    ds_read_b128 v[132:135], v6 offset:3136
    s_waitcnt lgkmcnt(5)
    v_mfma_f32_16x16x32_f16 v[116:119], v[48:51], v[136:139], v[116:119]
    ds_read_b128 v[136:139], v6 offset:3200
    s_waitcnt lgkmcnt(5)
    v_mfma_f32_16x16x32_f16 v[116:119], v[52:55], v[140:143], v[116:119]
    ds_read_b128 v[140:143], v6 offset:3264
    s_waitcnt lgkmcnt(5)
    v_mfma_f32_16x16x32_f16 v[116:119], v[56:59], v[144:147], v[116:119]
    ds_read_b128 v[144:147], v6 offset:3328
    s_waitcnt lgkmcnt(5)
    v_mfma_f32_16x16x32_f16 v[116:119], v[60:63], v[148:151], v[116:119]
    ds_read_b128 v[148:151], v6 offset:3392
    s_waitcnt lgkmcnt(5)
    v_mfma_f32_16x16x32_f16 v[120:123], v[32:35], v[128:131], v[120:123]
    ds_read_b128 v[128:131], v6 offset:3456
    s_waitcnt lgkmcnt(5)
    v_mfma_f32_16x16x32_f16 v[120:123], v[36:39], v[132:135], v[120:123]
    ds_read_b128 v[132:135], v6 offset:3520
    s_waitcnt lgkmcnt(5)
    v_mfma_f32_16x16x32_f16 v[120:123], v[40:43], v[136:139], v[120:123]
    ds_read_b128 v[136:139], v6 offset:3584
    s_waitcnt lgkmcnt(5)
    v_mfma_f32_16x16x32_f16 v[120:123], v[44:47], v[140:143], v[120:123]
    ds_read_b128 v[140:143], v6 offset:3648
    s_waitcnt lgkmcnt(5)
    v_mfma_f32_16x16x32_f16 v[120:123], v[48:51], v[144:147], v[120:123]
    ds_read_b128 v[144:147], v6 offset:3712
    s_waitcnt lgkmcnt(5)
    v_mfma_f32_16x16x32_f16 v[120:123], v[52:55], v[148:151], v[120:123]
    ds_read_b128 v[148:151], v6 offset:3776
    s_waitcnt lgkmcnt(5)
    v_mfma_f32_16x16x32_f16 v[120:123], v[56:59], v[128:131], v[120:123]
    ds_read_b128 v[128:131], v6 offset:3840
    s_waitcnt lgkmcnt(5)
    v_mfma_f32_16x16x32_f16 v[120:123], v[60:63], v[132:135], v[120:123]
    ds_read_b128 v[132:135], v6 offset:3904
    s_waitcnt lgkmcnt(5)
    v_mfma_f32_16x16x32_f16 v[124:127], v[32:35], v[136:139], v[124:127]
    ds_read_b128 v[136:139], v6 offset:3968
    s_waitcnt lgkmcnt(5)
    v_mfma_f32_16x16x32_f16 v[124:127], v[36:39], v[140:143], v[124:127]
    ds_read_b128 v[140:143], v6 offset:4032
    s_waitcnt lgkmcnt(5)
    v_mfma_f32_16x16x32_f16 v[124:127], v[40:43], v[144:147], v[124:127]
    s_waitcnt lgkmcnt(4)
    v_mfma_f32_16x16x32_f16 v[124:127], v[44:47], v[148:151], v[124:127]
    s_waitcnt lgkmcnt(3)
    v_mfma_f32_16x16x32_f16 v[124:127], v[48:51], v[128:131], v[124:127]
    s_waitcnt lgkmcnt(2)
    v_mfma_f32_16x16x32_f16 v[124:127], v[52:55], v[132:135], v[124:127]
    s_waitcnt lgkmcnt(1)
    v_mfma_f32_16x16x32_f16 v[124:127], v[56:59], v[136:139], v[124:127]
    s_waitcnt lgkmcnt(0)
    v_mfma_f32_16x16x32_f16 v[124:127], v[60:63], v[140:143], v[124:127]
    s_nop 7
    s_branch K2_RED
K2_W1:
    ds_read_b128 v[128:131], v6 offset:0
    ds_read_b128 v[132:135], v6 offset:64
    ds_read_b128 v[136:139], v6 offset:128
    ds_read_b128 v[140:143], v6 offset:192
    ds_read_b128 v[144:147], v6 offset:256
    ds_read_b128 v[148:151], v6 offset:320
    s_waitcnt lgkmcnt(5)
    v_mfma_f32_16x16x32_f16 v[100:103], v[32:35], v[128:131], v[100:103]
    v_mfma_f32_16x16x32_f16 v[120:123], v[64:67], v[128:131], v[120:123]
    ds_read_b128 v[128:131], v6 offset:384
    s_waitcnt lgkmcnt(5)
    v_mfma_f32_16x16x32_f16 v[100:103], v[36:39], v[132:135], v[100:103]
    v_mfma_f32_16x16x32_f16 v[120:123], v[68:71], v[132:135], v[120:123]
    ds_read_b128 v[132:135], v6 offset:448
    s_waitcnt lgkmcnt(5)
    v_mfma_f32_16x16x32_f16 v[100:103], v[40:43], v[136:139], v[100:103]
    v_mfma_f32_16x16x32_f16 v[120:123], v[72:75], v[136:139], v[120:123]
    ds_read_b128 v[136:139], v6 offset:512
    s_waitcnt lgkmcnt(5)
    v_mfma_f32_16x16x32_f16 v[100:103], v[44:47], v[140:143], v[100:103]
    v_mfma_f32_16x16x32_f16 v[120:123], v[76:79], v[140:143], v[120:123]
    ds_read_b128 v[140:143], v6 offset:576
    s_waitcnt lgkmcnt(5)
    v_mfma_f32_16x16x32_f16 v[100:103], v[48:51], v[144:147], v[100:103]
    v_mfma_f32_16x16x32_f16 v[120:123], v[80:83], v[144:147], v[120:123]
    ds_read_b128 v[144:147], v6 offset:640
    s_waitcnt lgkmcnt(5)
    v_mfma_f32_16x16x32_f16 v[100:103], v[52:55], v[148:151], v[100:103]
    v_mfma_f32_16x16x32_f16 v[120:123], v[84:87], v[148:151], v[120:123]
    ds_read_b128 v[148:151], v6 offset:704
    s_waitcnt lgkmcnt(5)
    v_mfma_f32_16x16x32_f16 v[100:103], v[56:59], v[128:131], v[100:103]
    v_mfma_f32_16x16x32_f16 v[120:123], v[88:91], v[128:131], v[120:123]
    ds_read_b128 v[128:131], v6 offset:768
    s_waitcnt lgkmcnt(5)
    v_mfma_f32_16x16x32_f16 v[100:103], v[60:63], v[132:135], v[100:103]
    v_mfma_f32_16x16x32_f16 v[120:123], v[92:95], v[132:135], v[120:123]
    ds_read_b128 v[132:135], v6 offset:832
    s_waitcnt lgkmcnt(5)
    v_mfma_f32_16x16x32_f16 v[104:107], v[32:35], v[136:139], v[104:107]
    v_mfma_f32_16x16x32_f16 v[124:127], v[64:67], v[136:139], v[124:127]
    ds_read_b128 v[136:139], v6 offset:896
    s_waitcnt lgkmcnt(5)
    v_mfma_f32_16x16x32_f16 v[104:107], v[36:39], v[140:143], v[104:107]
    v_mfma_f32_16x16x32_f16 v[124:127], v[68:71], v[140:143], v[124:127]
    ds_read_b128 v[140:143], v6 offset:960
    s_waitcnt lgkmcnt(5)
    v_mfma_f32_16x16x32_f16 v[104:107], v[40:43], v[144:147], v[104:107]
    v_mfma_f32_16x16x32_f16 v[124:127], v[72:75], v[144:147], v[124:127]
    ds_read_b128 v[144:147], v6 offset:1024
    s_waitcnt lgkmcnt(5)
    v_mfma_f32_16x16x32_f16 v[104:107], v[44:47], v[148:151], v[104:107]
    v_mfma_f32_16x16x32_f16 v[124:127], v[76:79], v[148:151], v[124:127]
    ds_read_b128 v[148:151], v6 offset:1088
    s_waitcnt lgkmcnt(5)
    v_mfma_f32_16x16x32_f16 v[104:107], v[48:51], v[128:131], v[104:107]
    v_mfma_f32_16x16x32_f16 v[124:127], v[80:83], v[128:131], v[124:127]
    ds_read_b128 v[128:131], v6 offset:1152
    s_waitcnt lgkmcnt(5)
    v_mfma_f32_16x16x32_f16 v[104:107], v[52:55], v[132:135], v[104:107]
    v_mfma_f32_16x16x32_f16 v[124:127], v[84:87], v[132:135], v[124:127]
    ds_read_b128 v[132:135], v6 offset:1216
    s_waitcnt lgkmcnt(5)
    v_mfma_f32_16x16x32_f16 v[104:107], v[56:59], v[136:139], v[104:107]
    v_mfma_f32_16x16x32_f16 v[124:127], v[88:91], v[136:139], v[124:127]
    ds_read_b128 v[136:139], v6 offset:1280
    s_waitcnt lgkmcnt(5)
    v_mfma_f32_16x16x32_f16 v[104:107], v[60:63], v[140:143], v[104:107]
    v_mfma_f32_16x16x32_f16 v[124:127], v[92:95], v[140:143], v[124:127]
    ds_read_b128 v[140:143], v6 offset:1344
    s_waitcnt lgkmcnt(5)
    v_mfma_f32_16x16x32_f16 v[108:111], v[32:35], v[144:147], v[108:111]
    ds_read_b128 v[144:147], v6 offset:1408
    s_waitcnt lgkmcnt(5)
    v_mfma_f32_16x16x32_f16 v[108:111], v[36:39], v[148:151], v[108:111]
    ds_read_b128 v[148:151], v6 offset:1472
    s_waitcnt lgkmcnt(5)
    v_mfma_f32_16x16x32_f16 v[108:111], v[40:43], v[128:131], v[108:111]
    ds_read_b128 v[128:131], v6 offset:1536
    s_waitcnt lgkmcnt(5)
    v_mfma_f32_16x16x32_f16 v[108:111], v[44:47], v[132:135], v[108:111]
    ds_read_b128 v[132:135], v6 offset:1600
    s_waitcnt lgkmcnt(5)
    v_mfma_f32_16x16x32_f16 v[108:111], v[48:51], v[136:139], v[108:111]
    ds_read_b128 v[136:139], v6 offset:1664
    s_waitcnt lgkmcnt(5)
    v_mfma_f32_16x16x32_f16 v[108:111], v[52:55], v[140:143], v[108:111]
    ds_read_b128 v[140:143], v6 offset:1728
    s_waitcnt lgkmcnt(5)
    v_mfma_f32_16x16x32_f16 v[108:111], v[56:59], v[144:147], v[108:111]
    ds_read_b128 v[144:147], v6 offset:1792
    s_waitcnt lgkmcnt(5)
    v_mfma_f32_16x16x32_f16 v[108:111], v[60:63], v[148:151], v[108:111]
    ds_read_b128 v[148:151], v6 offset:1856
    s_waitcnt lgkmcnt(5)
    v_mfma_f32_16x16x32_f16 v[112:115], v[32:35], v[128:131], v[112:115]
    ds_read_b128 v[128:131], v6 offset:1920
    s_waitcnt lgkmcnt(5)
    v_mfma_f32_16x16x32_f16 v[112:115], v[36:39], v[132:135], v[112:115]
    ds_read_b128 v[132:135], v6 offset:1984
    s_waitcnt lgkmcnt(5)
    v_mfma_f32_16x16x32_f16 v[112:115], v[40:43], v[136:139], v[112:115]
    ds_read_b128 v[136:139], v6 offset:2048
    s_waitcnt lgkmcnt(5)
    v_mfma_f32_16x16x32_f16 v[112:115], v[44:47], v[140:143], v[112:115]
    ds_read_b128 v[140:143], v6 offset:2112
    s_waitcnt lgkmcnt(5)
    v_mfma_f32_16x16x32_f16 v[112:115], v[48:51], v[144:147], v[112:115]
    ds_read_b128 v[144:147], v6 offset:2176
    s_waitcnt lgkmcnt(5)
    v_mfma_f32_16x16x32_f16 v[112:115], v[52:55], v[148:151], v[112:115]
    ds_read_b128 v[148:151], v6 offset:2240
    s_waitcnt lgkmcnt(5)
    v_mfma_f32_16x16x32_f16 v[112:115], v[56:59], v[128:131], v[112:115]
    ds_read_b128 v[128:131], v6 offset:2304
    s_waitcnt lgkmcnt(5)
    v_mfma_f32_16x16x32_f16 v[112:115], v[60:63], v[132:135], v[112:115]
    ds_read_b128 v[132:135], v6 offset:2368
    s_waitcnt lgkmcnt(5)
    v_mfma_f32_16x16x32_f16 v[116:119], v[32:35], v[136:139], v[116:119]
    ds_read_b128 v[136:139], v6 offset:2432
    s_waitcnt lgkmcnt(5)
    v_mfma_f32_16x16x32_f16 v[116:119], v[36:39], v[140:143], v[116:119]
    ds_read_b128 v[140:143], v6 offset:2496
    s_waitcnt lgkmcnt(5)
    v_mfma_f32_16x16x32_f16 v[116:119], v[40:43], v[144:147], v[116:119]
    ds_read_b128 v[144:147], v6 offset:2560
    s_waitcnt lgkmcnt(5)
    v_mfma_f32_16x16x32_f16 v[116:119], v[44:47], v[148:151], v[116:119]
    ds_read_b128 v[148:151], v6 offset:2624
    s_waitcnt lgkmcnt(5)
    v_mfma_f32_16x16x32_f16 v[116:119], v[48:51], v[128:131], v[116:119]
    ds_read_b128 v[128:131], v6 offset:2688
    s_waitcnt lgkmcnt(5)
    v_mfma_f32_16x16x32_f16 v[116:119], v[52:55], v[132:135], v[116:119]
    ds_read_b128 v[132:135], v6 offset:2752
    s_waitcnt lgkmcnt(5)
    v_mfma_f32_16x16x32_f16 v[116:119], v[56:59], v[136:139], v[116:119]
    ds_read_b128 v[136:139], v6 offset:2816
    s_waitcnt lgkmcnt(5)
    v_mfma_f32_16x16x32_f16 v[116:119], v[60:63], v[140:143], v[116:119]
    ds_read_b128 v[140:143], v6 offset:2880
    s_waitcnt lgkmcnt(5)
    v_mfma_f32_16x16x32_f16 v[120:123], v[32:35], v[144:147], v[120:123]
    ds_read_b128 v[144:147], v6 offset:2944
    s_waitcnt lgkmcnt(5)
    v_mfma_f32_16x16x32_f16 v[120:123], v[36:39], v[148:151], v[120:123]
    ds_read_b128 v[148:151], v6 offset:3008
    s_waitcnt lgkmcnt(5)
    v_mfma_f32_16x16x32_f16 v[120:123], v[40:43], v[128:131], v[120:123]
    ds_read_b128 v[128:131], v6 offset:3072
    s_waitcnt lgkmcnt(5)
    v_mfma_f32_16x16x32_f16 v[120:123], v[44:47], v[132:135], v[120:123]
    ds_read_b128 v[132:135], v6 offset:3136
    s_waitcnt lgkmcnt(5)
    v_mfma_f32_16x16x32_f16 v[120:123], v[48:51], v[136:139], v[120:123]
    ds_read_b128 v[136:139], v6 offset:3200
    s_waitcnt lgkmcnt(5)
    v_mfma_f32_16x16x32_f16 v[120:123], v[52:55], v[140:143], v[120:123]
    ds_read_b128 v[140:143], v6 offset:3264
    s_waitcnt lgkmcnt(5)
    v_mfma_f32_16x16x32_f16 v[120:123], v[56:59], v[144:147], v[120:123]
    ds_read_b128 v[144:147], v6 offset:3328
    s_waitcnt lgkmcnt(5)
    v_mfma_f32_16x16x32_f16 v[120:123], v[60:63], v[148:151], v[120:123]
    ds_read_b128 v[148:151], v6 offset:3392
    s_waitcnt lgkmcnt(5)
    v_mfma_f32_16x16x32_f16 v[124:127], v[32:35], v[128:131], v[124:127]
    ds_read_b128 v[128:131], v6 offset:3456
    s_waitcnt lgkmcnt(5)
    v_mfma_f32_16x16x32_f16 v[124:127], v[36:39], v[132:135], v[124:127]
    ds_read_b128 v[132:135], v6 offset:3520
    s_waitcnt lgkmcnt(5)
    v_mfma_f32_16x16x32_f16 v[124:127], v[40:43], v[136:139], v[124:127]
    s_waitcnt lgkmcnt(4)
    v_mfma_f32_16x16x32_f16 v[124:127], v[44:47], v[140:143], v[124:127]
    s_waitcnt lgkmcnt(3)
    v_mfma_f32_16x16x32_f16 v[124:127], v[48:51], v[144:147], v[124:127]
    s_waitcnt lgkmcnt(2)
    v_mfma_f32_16x16x32_f16 v[124:127], v[52:55], v[148:151], v[124:127]
    s_waitcnt lgkmcnt(1)
    v_mfma_f32_16x16x32_f16 v[124:127], v[56:59], v[128:131], v[124:127]
    s_waitcnt lgkmcnt(0)
    v_mfma_f32_16x16x32_f16 v[124:127], v[60:63], v[132:135], v[124:127]
    s_nop 7
    s_branch K2_RED
K2_W2:
    ds_read_b128 v[128:131], v6 offset:0
    ds_read_b128 v[132:135], v6 offset:64
    ds_read_b128 v[136:139], v6 offset:128
    ds_read_b128 v[140:143], v6 offset:192
    ds_read_b128 v[144:147], v6 offset:256
    ds_read_b128 v[148:151], v6 offset:320
    s_waitcnt lgkmcnt(5)
    v_mfma_f32_16x16x32_f16 v[104:107], v[32:35], v[128:131], v[104:107]
    v_mfma_f32_16x16x32_f16 v[116:119], v[64:67], v[128:131], v[116:119]
    ds_read_b128 v[128:131], v6 offset:384
    s_waitcnt lgkmcnt(5)
    v_mfma_f32_16x16x32_f16 v[104:107], v[36:39], v[132:135], v[104:107]
    v_mfma_f32_16x16x32_f16 v[116:119], v[68:71], v[132:135], v[116:119]
    ds_read_b128 v[132:135], v6 offset:448
    s_waitcnt lgkmcnt(5)
    v_mfma_f32_16x16x32_f16 v[104:107], v[40:43], v[136:139], v[104:107]
    v_mfma_f32_16x16x32_f16 v[116:119], v[72:75], v[136:139], v[116:119]
    ds_read_b128 v[136:139], v6 offset:512
    s_waitcnt lgkmcnt(5)
    v_mfma_f32_16x16x32_f16 v[104:107], v[44:47], v[140:143], v[104:107]
    v_mfma_f32_16x16x32_f16 v[116:119], v[76:79], v[140:143], v[116:119]
    ds_read_b128 v[140:143], v6 offset:576
    s_waitcnt lgkmcnt(5)
    v_mfma_f32_16x16x32_f16 v[104:107], v[48:51], v[144:147], v[104:107]
    v_mfma_f32_16x16x32_f16 v[116:119], v[80:83], v[144:147], v[116:119]
    ds_read_b128 v[144:147], v6 offset:640
    s_waitcnt lgkmcnt(5)
    v_mfma_f32_16x16x32_f16 v[104:107], v[52:55], v[148:151], v[104:107]
    v_mfma_f32_16x16x32_f16 v[116:119], v[84:87], v[148:151], v[116:119]
    ds_read_b128 v[148:151], v6 offset:704
    s_waitcnt lgkmcnt(5)
    v_mfma_f32_16x16x32_f16 v[104:107], v[56:59], v[128:131], v[104:107]
    v_mfma_f32_16x16x32_f16 v[116:119], v[88:91], v[128:131], v[116:119]
    ds_read_b128 v[128:131], v6 offset:768
    s_waitcnt lgkmcnt(5)
    v_mfma_f32_16x16x32_f16 v[104:107], v[60:63], v[132:135], v[104:107]
    v_mfma_f32_16x16x32_f16 v[116:119], v[92:95], v[132:135], v[116:119]
    ds_read_b128 v[132:135], v6 offset:832
    s_waitcnt lgkmcnt(5)
    v_mfma_f32_16x16x32_f16 v[108:111], v[32:35], v[136:139], v[108:111]
    v_mfma_f32_16x16x32_f16 v[120:123], v[64:67], v[136:139], v[120:123]
    ds_read_b128 v[136:139], v6 offset:896
    s_waitcnt lgkmcnt(5)
    v_mfma_f32_16x16x32_f16 v[108:111], v[36:39], v[140:143], v[108:111]
    v_mfma_f32_16x16x32_f16 v[120:123], v[68:71], v[140:143], v[120:123]
    ds_read_b128 v[140:143], v6 offset:960
    s_waitcnt lgkmcnt(5)
    v_mfma_f32_16x16x32_f16 v[108:111], v[40:43], v[144:147], v[108:111]
    v_mfma_f32_16x16x32_f16 v[120:123], v[72:75], v[144:147], v[120:123]
    ds_read_b128 v[144:147], v6 offset:1024
    s_waitcnt lgkmcnt(5)
    v_mfma_f32_16x16x32_f16 v[108:111], v[44:47], v[148:151], v[108:111]
    v_mfma_f32_16x16x32_f16 v[120:123], v[76:79], v[148:151], v[120:123]
    ds_read_b128 v[148:151], v6 offset:1088
    s_waitcnt lgkmcnt(5)
    v_mfma_f32_16x16x32_f16 v[108:111], v[48:51], v[128:131], v[108:111]
    v_mfma_f32_16x16x32_f16 v[120:123], v[80:83], v[128:131], v[120:123]
    ds_read_b128 v[128:131], v6 offset:1152
    s_waitcnt lgkmcnt(5)
    v_mfma_f32_16x16x32_f16 v[108:111], v[52:55], v[132:135], v[108:111]
    v_mfma_f32_16x16x32_f16 v[120:123], v[84:87], v[132:135], v[120:123]
    ds_read_b128 v[132:135], v6 offset:1216
    s_waitcnt lgkmcnt(5)
    v_mfma_f32_16x16x32_f16 v[108:111], v[56:59], v[136:139], v[108:111]
    v_mfma_f32_16x16x32_f16 v[120:123], v[88:91], v[136:139], v[120:123]
    ds_read_b128 v[136:139], v6 offset:1280
    s_waitcnt lgkmcnt(5)
    v_mfma_f32_16x16x32_f16 v[108:111], v[60:63], v[140:143], v[108:111]
    v_mfma_f32_16x16x32_f16 v[120:123], v[92:95], v[140:143], v[120:123]
    ds_read_b128 v[140:143], v6 offset:1344
    s_waitcnt lgkmcnt(5)
    v_mfma_f32_16x16x32_f16 v[112:115], v[32:35], v[144:147], v[112:115]
    v_mfma_f32_16x16x32_f16 v[124:127], v[64:67], v[144:147], v[124:127]
    ds_read_b128 v[144:147], v6 offset:1408
    s_waitcnt lgkmcnt(5)
    v_mfma_f32_16x16x32_f16 v[112:115], v[36:39], v[148:151], v[112:115]
    v_mfma_f32_16x16x32_f16 v[124:127], v[68:71], v[148:151], v[124:127]
    ds_read_b128 v[148:151], v6 offset:1472
    s_waitcnt lgkmcnt(5)
    v_mfma_f32_16x16x32_f16 v[112:115], v[40:43], v[128:131], v[112:115]
    v_mfma_f32_16x16x32_f16 v[124:127], v[72:75], v[128:131], v[124:127]
    ds_read_b128 v[128:131], v6 offset:1536
    s_waitcnt lgkmcnt(5)
    v_mfma_f32_16x16x32_f16 v[112:115], v[44:47], v[132:135], v[112:115]
    v_mfma_f32_16x16x32_f16 v[124:127], v[76:79], v[132:135], v[124:127]
    ds_read_b128 v[132:135], v6 offset:1600
    s_waitcnt lgkmcnt(5)
    v_mfma_f32_16x16x32_f16 v[112:115], v[48:51], v[136:139], v[112:115]
    v_mfma_f32_16x16x32_f16 v[124:127], v[80:83], v[136:139], v[124:127]
    ds_read_b128 v[136:139], v6 offset:1664
    s_waitcnt lgkmcnt(5)
    v_mfma_f32_16x16x32_f16 v[112:115], v[52:55], v[140:143], v[112:115]
    v_mfma_f32_16x16x32_f16 v[124:127], v[84:87], v[140:143], v[124:127]
    ds_read_b128 v[140:143], v6 offset:1728
    s_waitcnt lgkmcnt(5)
    v_mfma_f32_16x16x32_f16 v[112:115], v[56:59], v[144:147], v[112:115]
    v_mfma_f32_16x16x32_f16 v[124:127], v[88:91], v[144:147], v[124:127]
    ds_read_b128 v[144:147], v6 offset:1792
    s_waitcnt lgkmcnt(5)
    v_mfma_f32_16x16x32_f16 v[112:115], v[60:63], v[148:151], v[112:115]
    v_mfma_f32_16x16x32_f16 v[124:127], v[92:95], v[148:151], v[124:127]
    ds_read_b128 v[148:151], v6 offset:1856
    s_waitcnt lgkmcnt(5)
    v_mfma_f32_16x16x32_f16 v[116:119], v[32:35], v[128:131], v[116:119]
    ds_read_b128 v[128:131], v6 offset:1920
    s_waitcnt lgkmcnt(5)
    v_mfma_f32_16x16x32_f16 v[116:119], v[36:39], v[132:135], v[116:119]
    ds_read_b128 v[132:135], v6 offset:1984
    s_waitcnt lgkmcnt(5)
    v_mfma_f32_16x16x32_f16 v[116:119], v[40:43], v[136:139], v[116:119]
    ds_read_b128 v[136:139], v6 offset:2048
    s_waitcnt lgkmcnt(5)
    v_mfma_f32_16x16x32_f16 v[116:119], v[44:47], v[140:143], v[116:119]
    ds_read_b128 v[140:143], v6 offset:2112
    s_waitcnt lgkmcnt(5)
    v_mfma_f32_16x16x32_f16 v[116:119], v[48:51], v[144:147], v[116:119]
    ds_read_b128 v[144:147], v6 offset:2176
    s_waitcnt lgkmcnt(5)
    v_mfma_f32_16x16x32_f16 v[116:119], v[52:55], v[148:151], v[116:119]
    ds_read_b128 v[148:151], v6 offset:2240
    s_waitcnt lgkmcnt(5)
    v_mfma_f32_16x16x32_f16 v[116:119], v[56:59], v[128:131], v[116:119]
    ds_read_b128 v[128:131], v6 offset:2304
    s_waitcnt lgkmcnt(5)
    v_mfma_f32_16x16x32_f16 v[116:119], v[60:63], v[132:135], v[116:119]
    ds_read_b128 v[132:135], v6 offset:2368
    s_waitcnt lgkmcnt(5)
    v_mfma_f32_16x16x32_f16 v[120:123], v[32:35], v[136:139], v[120:123]
    ds_read_b128 v[136:139], v6 offset:2432
    s_waitcnt lgkmcnt(5)
    v_mfma_f32_16x16x32_f16 v[120:123], v[36:39], v[140:143], v[120:123]
    ds_read_b128 v[140:143], v6 offset:2496
    s_waitcnt lgkmcnt(5)
    v_mfma_f32_16x16x32_f16 v[120:123], v[40:43], v[144:147], v[120:123]
    ds_read_b128 v[144:147], v6 offset:2560
    s_waitcnt lgkmcnt(5)
    v_mfma_f32_16x16x32_f16 v[120:123], v[44:47], v[148:151], v[120:123]
    ds_read_b128 v[148:151], v6 offset:2624
    s_waitcnt lgkmcnt(5)
    v_mfma_f32_16x16x32_f16 v[120:123], v[48:51], v[128:131], v[120:123]
    ds_read_b128 v[128:131], v6 offset:2688
    s_waitcnt lgkmcnt(5)
    v_mfma_f32_16x16x32_f16 v[120:123], v[52:55], v[132:135], v[120:123]
    ds_read_b128 v[132:135], v6 offset:2752
    s_waitcnt lgkmcnt(5)
    v_mfma_f32_16x16x32_f16 v[120:123], v[56:59], v[136:139], v[120:123]
    ds_read_b128 v[136:139], v6 offset:2816
    s_waitcnt lgkmcnt(5)
    v_mfma_f32_16x16x32_f16 v[120:123], v[60:63], v[140:143], v[120:123]
    ds_read_b128 v[140:143], v6 offset:2880
    s_waitcnt lgkmcnt(5)
    v_mfma_f32_16x16x32_f16 v[124:127], v[32:35], v[144:147], v[124:127]
    ds_read_b128 v[144:147], v6 offset:2944
    s_waitcnt lgkmcnt(5)
    v_mfma_f32_16x16x32_f16 v[124:127], v[36:39], v[148:151], v[124:127]
    ds_read_b128 v[148:151], v6 offset:3008
    s_waitcnt lgkmcnt(5)
    v_mfma_f32_16x16x32_f16 v[124:127], v[40:43], v[128:131], v[124:127]
    s_waitcnt lgkmcnt(4)
    v_mfma_f32_16x16x32_f16 v[124:127], v[44:47], v[132:135], v[124:127]
    s_waitcnt lgkmcnt(3)
    v_mfma_f32_16x16x32_f16 v[124:127], v[48:51], v[136:139], v[124:127]
    s_waitcnt lgkmcnt(2)
    v_mfma_f32_16x16x32_f16 v[124:127], v[52:55], v[140:143], v[124:127]
    s_waitcnt lgkmcnt(1)
    v_mfma_f32_16x16x32_f16 v[124:127], v[56:59], v[144:147], v[124:127]
    s_waitcnt lgkmcnt(0)
    v_mfma_f32_16x16x32_f16 v[124:127], v[60:63], v[148:151], v[124:127]
    s_nop 7
    s_branch K2_RED
K2_W3:
    ds_read_b128 v[128:131], v6 offset:0
    ds_read_b128 v[132:135], v6 offset:64
    ds_read_b128 v[136:139], v6 offset:128
    ds_read_b128 v[140:143], v6 offset:192
    ds_read_b128 v[144:147], v6 offset:256
    ds_read_b128 v[148:151], v6 offset:320
    s_waitcnt lgkmcnt(5)
    v_mfma_f32_16x16x32_f16 v[108:111], v[32:35], v[128:131], v[108:111]
    v_mfma_f32_16x16x32_f16 v[112:115], v[64:67], v[128:131], v[112:115]
    ds_read_b128 v[128:131], v6 offset:384
    s_waitcnt lgkmcnt(5)
    v_mfma_f32_16x16x32_f16 v[108:111], v[36:39], v[132:135], v[108:111]
    v_mfma_f32_16x16x32_f16 v[112:115], v[68:71], v[132:135], v[112:115]
    ds_read_b128 v[132:135], v6 offset:448
    s_waitcnt lgkmcnt(5)
    v_mfma_f32_16x16x32_f16 v[108:111], v[40:43], v[136:139], v[108:111]
    v_mfma_f32_16x16x32_f16 v[112:115], v[72:75], v[136:139], v[112:115]
    ds_read_b128 v[136:139], v6 offset:512
    s_waitcnt lgkmcnt(5)
    v_mfma_f32_16x16x32_f16 v[108:111], v[44:47], v[140:143], v[108:111]
    v_mfma_f32_16x16x32_f16 v[112:115], v[76:79], v[140:143], v[112:115]
    ds_read_b128 v[140:143], v6 offset:576
    s_waitcnt lgkmcnt(5)
    v_mfma_f32_16x16x32_f16 v[108:111], v[48:51], v[144:147], v[108:111]
    v_mfma_f32_16x16x32_f16 v[112:115], v[80:83], v[144:147], v[112:115]
    ds_read_b128 v[144:147], v6 offset:640
    s_waitcnt lgkmcnt(5)
    v_mfma_f32_16x16x32_f16 v[108:111], v[52:55], v[148:151], v[108:111]
    v_mfma_f32_16x16x32_f16 v[112:115], v[84:87], v[148:151], v[112:115]
    ds_read_b128 v[148:151], v6 offset:704
    s_waitcnt lgkmcnt(5)
    v_mfma_f32_16x16x32_f16 v[108:111], v[56:59], v[128:131], v[108:111]
    v_mfma_f32_16x16x32_f16 v[112:115], v[88:91], v[128:131], v[112:115]
    ds_read_b128 v[128:131], v6 offset:768
    s_waitcnt lgkmcnt(5)
    v_mfma_f32_16x16x32_f16 v[108:111], v[60:63], v[132:135], v[108:111]
    v_mfma_f32_16x16x32_f16 v[112:115], v[92:95], v[132:135], v[112:115]
    ds_read_b128 v[132:135], v6 offset:832
    s_waitcnt lgkmcnt(5)
    v_mfma_f32_16x16x32_f16 v[112:115], v[32:35], v[136:139], v[112:115]
    v_mfma_f32_16x16x32_f16 v[116:119], v[64:67], v[136:139], v[116:119]
    ds_read_b128 v[136:139], v6 offset:896
    s_waitcnt lgkmcnt(5)
    v_mfma_f32_16x16x32_f16 v[112:115], v[36:39], v[140:143], v[112:115]
    v_mfma_f32_16x16x32_f16 v[116:119], v[68:71], v[140:143], v[116:119]
    ds_read_b128 v[140:143], v6 offset:960
    s_waitcnt lgkmcnt(5)
    v_mfma_f32_16x16x32_f16 v[112:115], v[40:43], v[144:147], v[112:115]
    v_mfma_f32_16x16x32_f16 v[116:119], v[72:75], v[144:147], v[116:119]
    ds_read_b128 v[144:147], v6 offset:1024
    s_waitcnt lgkmcnt(5)
    v_mfma_f32_16x16x32_f16 v[112:115], v[44:47], v[148:151], v[112:115]
    v_mfma_f32_16x16x32_f16 v[116:119], v[76:79], v[148:151], v[116:119]
    ds_read_b128 v[148:151], v6 offset:1088
    s_waitcnt lgkmcnt(5)
    v_mfma_f32_16x16x32_f16 v[112:115], v[48:51], v[128:131], v[112:115]
    v_mfma_f32_16x16x32_f16 v[116:119], v[80:83], v[128:131], v[116:119]
    ds_read_b128 v[128:131], v6 offset:1152
    s_waitcnt lgkmcnt(5)
    v_mfma_f32_16x16x32_f16 v[112:115], v[52:55], v[132:135], v[112:115]
    v_mfma_f32_16x16x32_f16 v[116:119], v[84:87], v[132:135], v[116:119]
    ds_read_b128 v[132:135], v6 offset:1216
    s_waitcnt lgkmcnt(5)
    v_mfma_f32_16x16x32_f16 v[112:115], v[56:59], v[136:139], v[112:115]
    v_mfma_f32_16x16x32_f16 v[116:119], v[88:91], v[136:139], v[116:119]
    ds_read_b128 v[136:139], v6 offset:1280
    s_waitcnt lgkmcnt(5)
    v_mfma_f32_16x16x32_f16 v[112:115], v[60:63], v[140:143], v[112:115]
    v_mfma_f32_16x16x32_f16 v[116:119], v[92:95], v[140:143], v[116:119]
    ds_read_b128 v[140:143], v6 offset:1344
    s_waitcnt lgkmcnt(5)
    v_mfma_f32_16x16x32_f16 v[116:119], v[32:35], v[144:147], v[116:119]
    v_mfma_f32_16x16x32_f16 v[120:123], v[64:67], v[144:147], v[120:123]
    ds_read_b128 v[144:147], v6 offset:1408
    s_waitcnt lgkmcnt(5)
    v_mfma_f32_16x16x32_f16 v[116:119], v[36:39], v[148:151], v[116:119]
    v_mfma_f32_16x16x32_f16 v[120:123], v[68:71], v[148:151], v[120:123]
    ds_read_b128 v[148:151], v6 offset:1472
    s_waitcnt lgkmcnt(5)
    v_mfma_f32_16x16x32_f16 v[116:119], v[40:43], v[128:131], v[116:119]
    v_mfma_f32_16x16x32_f16 v[120:123], v[72:75], v[128:131], v[120:123]
    ds_read_b128 v[128:131], v6 offset:1536
    s_waitcnt lgkmcnt(5)
    v_mfma_f32_16x16x32_f16 v[116:119], v[44:47], v[132:135], v[116:119]
    v_mfma_f32_16x16x32_f16 v[120:123], v[76:79], v[132:135], v[120:123]
    ds_read_b128 v[132:135], v6 offset:1600
    s_waitcnt lgkmcnt(5)
    v_mfma_f32_16x16x32_f16 v[116:119], v[48:51], v[136:139], v[116:119]
    v_mfma_f32_16x16x32_f16 v[120:123], v[80:83], v[136:139], v[120:123]
    ds_read_b128 v[136:139], v6 offset:1664
    s_waitcnt lgkmcnt(5)
    v_mfma_f32_16x16x32_f16 v[116:119], v[52:55], v[140:143], v[116:119]
    v_mfma_f32_16x16x32_f16 v[120:123], v[84:87], v[140:143], v[120:123]
    ds_read_b128 v[140:143], v6 offset:1728
    s_waitcnt lgkmcnt(5)
    v_mfma_f32_16x16x32_f16 v[116:119], v[56:59], v[144:147], v[116:119]
    v_mfma_f32_16x16x32_f16 v[120:123], v[88:91], v[144:147], v[120:123]
    ds_read_b128 v[144:147], v6 offset:1792
    s_waitcnt lgkmcnt(5)
    v_mfma_f32_16x16x32_f16 v[116:119], v[60:63], v[148:151], v[116:119]
    v_mfma_f32_16x16x32_f16 v[120:123], v[92:95], v[148:151], v[120:123]
    ds_read_b128 v[148:151], v6 offset:1856
    s_waitcnt lgkmcnt(5)
    v_mfma_f32_16x16x32_f16 v[120:123], v[32:35], v[128:131], v[120:123]
    v_mfma_f32_16x16x32_f16 v[124:127], v[64:67], v[128:131], v[124:127]
    ds_read_b128 v[128:131], v6 offset:1920
    s_waitcnt lgkmcnt(5)
    v_mfma_f32_16x16x32_f16 v[120:123], v[36:39], v[132:135], v[120:123]
    v_mfma_f32_16x16x32_f16 v[124:127], v[68:71], v[132:135], v[124:127]
    ds_read_b128 v[132:135], v6 offset:1984
    s_waitcnt lgkmcnt(5)
    v_mfma_f32_16x16x32_f16 v[120:123], v[40:43], v[136:139], v[120:123]
    v_mfma_f32_16x16x32_f16 v[124:127], v[72:75], v[136:139], v[124:127]
    ds_read_b128 v[136:139], v6 offset:2048
    s_waitcnt lgkmcnt(5)
    v_mfma_f32_16x16x32_f16 v[120:123], v[44:47], v[140:143], v[120:123]
    v_mfma_f32_16x16x32_f16 v[124:127], v[76:79], v[140:143], v[124:127]
    ds_read_b128 v[140:143], v6 offset:2112
    s_waitcnt lgkmcnt(5)
    v_mfma_f32_16x16x32_f16 v[120:123], v[48:51], v[144:147], v[120:123]
    v_mfma_f32_16x16x32_f16 v[124:127], v[80:83], v[144:147], v[124:127]
    ds_read_b128 v[144:147], v6 offset:2176
    s_waitcnt lgkmcnt(5)
    v_mfma_f32_16x16x32_f16 v[120:123], v[52:55], v[148:151], v[120:123]
    v_mfma_f32_16x16x32_f16 v[124:127], v[84:87], v[148:151], v[124:127]
    ds_read_b128 v[148:151], v6 offset:2240
    s_waitcnt lgkmcnt(5)
    v_mfma_f32_16x16x32_f16 v[120:123], v[56:59], v[128:131], v[120:123]
    v_mfma_f32_16x16x32_f16 v[124:127], v[88:91], v[128:131], v[124:127]
    ds_read_b128 v[128:131], v6 offset:2304
    s_waitcnt lgkmcnt(5)
    v_mfma_f32_16x16x32_f16 v[120:123], v[60:63], v[132:135], v[120:123]
    v_mfma_f32_16x16x32_f16 v[124:127], v[92:95], v[132:135], v[124:127]
    ds_read_b128 v[132:135], v6 offset:2368
    s_waitcnt lgkmcnt(5)
    v_mfma_f32_16x16x32_f16 v[124:127], v[32:35], v[136:139], v[124:127]
    ds_read_b128 v[136:139], v6 offset:2432
    s_waitcnt lgkmcnt(5)
    v_mfma_f32_16x16x32_f16 v[124:127], v[36:39], v[140:143], v[124:127]
    ds_read_b128 v[140:143], v6 offset:2496
    s_waitcnt lgkmcnt(5)
    v_mfma_f32_16x16x32_f16 v[124:127], v[40:43], v[144:147], v[124:127]
    s_waitcnt lgkmcnt(4)
    v_mfma_f32_16x16x32_f16 v[124:127], v[44:47], v[148:151], v[124:127]
    s_waitcnt lgkmcnt(3)
    v_mfma_f32_16x16x32_f16 v[124:127], v[48:51], v[128:131], v[124:127]
    s_waitcnt lgkmcnt(2)
    v_mfma_f32_16x16x32_f16 v[124:127], v[52:55], v[132:135], v[124:127]
    s_waitcnt lgkmcnt(1)
    v_mfma_f32_16x16x32_f16 v[124:127], v[56:59], v[136:139], v[124:127]
    s_waitcnt lgkmcnt(0)
    v_mfma_f32_16x16x32_f16 v[124:127], v[60:63], v[140:143], v[124:127]
    s_nop 7
K2_RED:
    v_and_b32 v4, 63, v0
    v_lshlrev_b32 v4, 4, v4
    s_lshl_b32 s49, s38, 13
    v_add_u32 v5, s49, v4
    ds_write_b128 v5, v[96:99] offset:4608
    ds_write_b128 v5, v[100:103] offset:5632
    ds_write_b128 v5, v[104:107] offset:6656
    ds_write_b128 v5, v[108:111] offset:7680
    ds_write_b128 v5, v[112:115] offset:8704
    ds_write_b128 v5, v[116:119] offset:9728
    ds_write_b128 v5, v[120:123] offset:10752
    ds_write_b128 v5, v[124:127] offset:11776
    s_lshl_b32 s49, s38, 11
    v_add_u32 v4, s49, v4
    s_waitcnt lgkmcnt(0)
    s_barrier
    ds_read_b128 v[32:35], v4 offset:4608
    ds_read_b128 v[36:39], v4 offset:12800
    ds_read_b128 v[40:43], v4 offset:20992
    ds_read_b128 v[44:47], v4 offset:29184
    ds_read_b128 v[48:51], v4 offset:5632
    ds_read_b128 v[52:55], v4 offset:13824
    ds_read_b128 v[56:59], v4 offset:22016
    ds_read_b128 v[60:63], v4 offset:30208
    v_lshlrev_b32 v5, 5, v1
    v_lshl_add_u32 v5, v2, 3, v5
    s_mul_i32 s46, s3, 4224
    s_lshl_b32 s49, s38, 10
    s_add_u32 s46, s46, s49
    s_waitcnt lgkmcnt(4)
    v_add_f32 v32, v32, v36
    v_add_f32 v40, v40, v44
    v_add_f32 v33, v33, v37
    v_add_f32 v41, v41, v45
    v_add_f32 v34, v34, v38
    v_add_f32 v42, v42, v46
    v_add_f32 v35, v35, v39
    v_add_f32 v43, v43, v47
    v_add_f32 v32, v32, v40
    v_add_f32 v33, v33, v41
    v_add_f32 v34, v34, v42
    v_add_f32 v35, v35, v43
    v_mul_f32 v32, 0x3a800000, v32
    v_mul_f32 v33, 0x3a800000, v33
    v_mul_f32 v34, 0x3a800000, v34
    v_mul_f32 v35, 0x3a800000, v35
    v_cvt_pk_bf16_f32 v36, v32, v33
    v_cvt_pk_bf16_f32 v37, v34, v35
    v_lshlrev_b32 v32, 16, v36
    v_and_b32 v33, 0xffff0000, v36
    v_lshlrev_b32 v34, 16, v37
    v_and_b32 v35, 0xffff0000, v37
    v_lshlrev_b32 v38, 16, v24
    v_and_b32 v39, 0xffff0000, v24
    v_lshlrev_b32 v40, 16, v25
    v_and_b32 v41, 0xffff0000, v25
    v_add_f32 v32, v32, v38
    v_add_f32 v33, v33, v39
    v_add_f32 v34, v34, v40
    v_add_f32 v35, v35, v41
    v_cvt_pk_bf16_f32 v36, v32, v33
    v_cvt_pk_bf16_f32 v37, v34, v35
    v_lshlrev_b32 v32, 16, v36
    v_and_b32 v33, 0xffff0000, v36
    v_lshlrev_b32 v34, 16, v37
    v_and_b32 v35, 0xffff0000, v37
    v_mul_f32 v32, s43, v32
    v_mul_f32 v33, s43, v33
    v_mul_f32 v34, s43, v34
    v_mul_f32 v35, s43, v35
    v_cvt_pk_bf16_f32 v36, v32, v33
    v_cvt_pk_bf16_f32 v37, v34, v35
    v_lshlrev_b32 v32, 16, v36
    v_and_b32 v33, 0xffff0000, v36
    v_lshlrev_b32 v34, 16, v37
    v_and_b32 v35, 0xffff0000, v37
    v_and_b32 v38, 0xffff0000, v8
    v_and_b32 v39, 0xffff0000, v9
    v_and_b32 v40, 0xffff0000, v10
    v_and_b32 v41, 0xffff0000, v11
    v_add_f32 v32, v32, v38
    v_add_f32 v33, v33, v39
    v_add_f32 v34, v34, v40
    v_add_f32 v35, v35, v41
    v_cvt_pk_bf16_f32 v36, v32, v33
    v_cvt_pk_bf16_f32 v37, v34, v35
    buffer_store_dwordx2 v[36:37], v5, s[16:19], s46 offen offset:0
    s_waitcnt lgkmcnt(0)
    v_add_f32 v48, v48, v52
    v_add_f32 v56, v56, v60
    v_add_f32 v49, v49, v53
    v_add_f32 v57, v57, v61
    v_add_f32 v50, v50, v54
    v_add_f32 v58, v58, v62
    v_add_f32 v51, v51, v55
    v_add_f32 v59, v59, v63
    v_add_f32 v48, v48, v56
    v_add_f32 v49, v49, v57
    v_add_f32 v50, v50, v58
    v_add_f32 v51, v51, v59
    v_mul_f32 v48, 0x3a800000, v48
    v_mul_f32 v49, 0x3a800000, v49
    v_mul_f32 v50, 0x3a800000, v50
    v_mul_f32 v51, 0x3a800000, v51
    v_cvt_pk_bf16_f32 v52, v48, v49
    v_cvt_pk_bf16_f32 v53, v50, v51
    v_lshlrev_b32 v48, 16, v52
    v_and_b32 v49, 0xffff0000, v52
    v_lshlrev_b32 v50, 16, v53
    v_and_b32 v51, 0xffff0000, v53
    v_lshlrev_b32 v54, 16, v26
    v_and_b32 v55, 0xffff0000, v26
    v_lshlrev_b32 v56, 16, v27
    v_and_b32 v57, 0xffff0000, v27
    v_add_f32 v48, v48, v54
    v_add_f32 v49, v49, v55
    v_add_f32 v50, v50, v56
    v_add_f32 v51, v51, v57
    v_cvt_pk_bf16_f32 v52, v48, v49
    v_cvt_pk_bf16_f32 v53, v50, v51
    v_lshlrev_b32 v48, 16, v52
    v_and_b32 v49, 0xffff0000, v52
    v_lshlrev_b32 v50, 16, v53
    v_and_b32 v51, 0xffff0000, v53
    v_mul_f32 v48, s43, v48
    v_mul_f32 v49, s43, v49
    v_mul_f32 v50, s43, v50
    v_mul_f32 v51, s43, v51
    v_cvt_pk_bf16_f32 v52, v48, v49
    v_cvt_pk_bf16_f32 v53, v50, v51
    v_lshlrev_b32 v48, 16, v52
    v_and_b32 v49, 0xffff0000, v52
    v_lshlrev_b32 v50, 16, v53
    v_and_b32 v51, 0xffff0000, v53
    v_and_b32 v54, 0xffff0000, v12
    v_and_b32 v55, 0xffff0000, v13
    v_and_b32 v56, 0xffff0000, v14
    v_and_b32 v57, 0xffff0000, v15
    v_add_f32 v48, v48, v54
    v_add_f32 v49, v49, v55
    v_add_f32 v50, v50, v56
    v_add_f32 v51, v51, v57
    v_cvt_pk_bf16_f32 v52, v48, v49
    v_cvt_pk_bf16_f32 v53, v50, v51
    buffer_store_dwordx2 v[52:53], v5, s[16:19], s46 offen offset:512
    s_nop 0
K2_END:
    s_endpgm
.text
.globl k34_kernel
.p2align 8
.type k34_kernel,@function
k34_kernel:

    s_cmp_ge_u32 s2, 256
    s_cbranch_scc1 K4_END
    s_and_b32 s36, s2, 7
    s_lshl_b32 s36, s36, 5
    s_lshr_b32 s37, s2, 3
    s_add_u32 s3, s36, s37
    s_load_dwordx2 s[4:5], s[0:1], 80
    s_load_dwordx2 s[8:9], s[0:1], 88
    s_load_dwordx2 s[12:13], s[0:1], 136
    s_load_dwordx2 s[24:25], s[0:1], 96
    v_mov_b32 v15, v0
    v_readfirstlane_b32 s39, v0
    s_lshr_b32 s39, s39, 6
    v_and_b32 v0, 63, v0
    v_lshrrev_b32 v11, 4, v0
    v_mul_u32_u24 v1, 9216, v11
    v_bfe_u32 v12, v0, 2, 2
    v_xor_b32 v12, v12, v11
    v_lshl_add_u32 v1, v12, 6, v1
    v_and_b32 v12, 3, v0
    v_lshl_add_u32 v1, v12, 4, v1
    v_bfe_u32 v12, v0, 2, 2
    v_lshrrev_b32 v13, 5, v0
    v_lshl_add_u32 v13, v13, 3, v12
    v_lshlrev_b32 v2, 8, v13
    v_xor_b32 v12, s39, v12
    v_lshl_add_u32 v2, v12, 6, v2
    v_bfe_u32 v12, v0, 4, 1
    v_lshl_add_u32 v2, v12, 5, v2
    v_and_b32 v12, 3, v0
    v_lshl_add_u32 v2, v12, 3, v2
    v_add_u32 v4, 110592, v2
    v_add_u32 v3, 73728, v2
    v_add_u32 v2, 36864, v2
    v_lshlrev_b32 v5, 4, v0
    v_add_u32 v6, 36864, v5
    v_add_u32 v7, 73728, v5
    v_add_u32 v8, 110592, v5
    v_bfe_u32 v12, v0, 4, 1
    v_lshlrev_b32 v10, 10, v12
    v_lshrrev_b32 v12, 5, v0
    v_lshl_add_u32 v10, v12, 8, v10
    v_and_b32 v12, 15, v0
    v_lshl_add_u32 v10, v12, 4, v10
    s_mul_i32 s36, s3, 9363
    s_lshr_b32 s36, s36, 16
    s_mul_i32 s37, s36, 7
    s_sub_u32 s37, s3, s37
    s_mul_i32 s38, s37, 9
    s_cmp_gt_u32 s37, 0
    s_addc_u32 s38, s38, 0
    s_and_b32 s54, s2, 7
    s_lshr_b32 s56, s2, 3
    s_lshr_b32 s55, s56, 2
    s_cmp_eq_u32 s55, 7
    s_cselect_b32 s57, 0, s55
    s_cselect_b32 s72, 9, 8
    s_cmp_eq_u32 s54, 7
    s_cselect_b32 s54, s57, s54
    s_cselect_b32 s55, s72, s55
    s_mul_i32 s57, s54, 9
    s_cmp_gt_u32 s54, 0
    s_addc_u32 s57, s57, s55
    s_lshl_b32 s55, s57, 2
    s_and_b32 s56, s56, 3
    s_add_u32 s55, s55, s56
    s_lshl_b32 s72, s54, 7
    s_cmp_ge_u32 s3, 252
    s_cselect_b32 s36, 0, s36
    s_cselect_b32 s37, 0, s37
    s_cselect_b32 s38, 0, s38
    s_lshl_b32 s40, s36, 8
    s_mul_i32 s41, s39, 147456
    s_add_u32 s40, s40, s41
    s_lshl_b32 s42, s39, 12
    s_mul_i32 s43, s38, 36864
    s_mul_i32 s44, s39, 9216
    s_add_u32 s43, s43, s44
    s_lshl_b32 s45, s36, 2
    s_add_u32 s45, s45, s39
    s_lshl_b32 s45, s45, 7
    s_lshl_b32 s46, s38, 1
    s_add_u32 s45, s45, s46
    s_lshl_b32 s45, s45, 10
    s_mov_b32 s47, 0xffff0000
    s_mov_b32 s48, 0xbfb8aa3b
    s_waitcnt lgkmcnt(0)
    s_mov_b32 s6, 0x510000
    s_mov_b32 s7, 0x20000
    s_mov_b32 s10, 0x510000
    s_mov_b32 s11, 0x20000
    s_add_u32 s16, s12, 0x980000
    s_addc_u32 s17, s13, 0
    s_mov_b32 s18, 0x240000
    s_mov_b32 s19, 0x20000
    s_add_u32 s20, s12, 0xe00000
    s_addc_u32 s21, s13, 0
    s_mov_b32 s22, 0x1200000
    s_mov_b32 s23, 0x20000
    s_mov_b32 s26, 0x510000
    s_mov_b32 s27, 0x20000
    s_mul_i32 s53, s3, 21504
    s_lshl_b32 s54, s39, 10
    s_add_u32 s53, s53, s54
    v_lshlrev_b32 v14, 4, v0
    v_add_u32 v14, s53, v14
    s_add_u32 s28, s12, 0x720000
    s_addc_u32 s29, s13, 0
    s_mov_b32 s30, 0x252000
    s_mov_b32 s31, 0x20000
    s_add_u32 s32, s12, 0x0
    s_addc_u32 s33, s13, 0
    s_mov_b32 s34, 0x3600
    s_mov_b32 s35, 0x20000
    s_add_u32 s64, s12, 0xbc0000
    s_addc_u32 s65, s13, 0
    s_mov_b32 s66, 0x240000
    s_mov_b32 s67, 0x20000
    s_add_u32 s68, s12, 0x14000
    s_addc_u32 s69, s13, 0
    s_mov_b32 s70, 0x1000
    s_mov_b32 s71, 0x20000
    s_lshl_b32 s57, s55, 4
    v_add_u32 v11, 0, v15
    v_mul_u32_u24 v11, 4224, v11
    v_add_u32 v12, 256, v15
    v_mul_u32_u24 v12, 4224, v12
    v_add_u32 v13, 512, v15
    v_mul_u32_u24 v13, 4224, v13
    buffer_load_dwordx4 v[16:19], v11, s[28:31], s57 offen
    buffer_load_dwordx4 v[20:23], v12, s[28:31], s57 offen
    buffer_load_dwordx4 v[24:27], v13, s[28:31], s57 offen
    s_add_u32 m0, s42, 36864
    s_add_u32 s49, s40, 0
    buffer_load_dwordx4 v1, s[4:7], s49 offen lds
    s_add_u32 m0, s42, 37888
    s_add_u32 s49, s40, 36864
    buffer_load_dwordx4 v1, s[4:7], s49 offen lds
    s_add_u32 m0, s42, 38912
    s_add_u32 s49, s40, 73728
    buffer_load_dwordx4 v1, s[4:7], s49 offen lds
    s_add_u32 m0, s42, 39936
    s_add_u32 s49, s40, 110592
    buffer_load_dwordx4 v1, s[4:7], s49 offen lds
    s_add_u32 m0, s42, 53248
    s_add_u32 s49, s40, 0
    buffer_load_dwordx4 v1, s[8:11], s49 offen lds
    s_add_u32 m0, s42, 54272
    s_add_u32 s49, s40, 36864
    buffer_load_dwordx4 v1, s[8:11], s49 offen lds
    s_add_u32 m0, s42, 55296
    s_add_u32 s49, s40, 73728
    buffer_load_dwordx4 v1, s[8:11], s49 offen lds
    s_add_u32 m0, s42, 56320
    s_add_u32 s49, s40, 110592
    buffer_load_dwordx4 v1, s[8:11], s49 offen lds
    s_add_u32 m0, s42, 73728
    s_add_u32 s49, s40, 589824
    buffer_load_dwordx4 v1, s[4:7], s49 offen lds
    s_add_u32 m0, s42, 74752
    s_add_u32 s49, s40, 626688
    buffer_load_dwordx4 v1, s[4:7], s49 offen lds
    s_add_u32 m0, s42, 75776
    s_add_u32 s49, s40, 663552
    buffer_load_dwordx4 v1, s[4:7], s49 offen lds
    s_add_u32 m0, s42, 76800
    s_add_u32 s49, s40, 700416
    buffer_load_dwordx4 v1, s[4:7], s49 offen lds
    s_add_u32 m0, s42, 90112
    s_add_u32 s49, s40, 589824
    buffer_load_dwordx4 v1, s[8:11], s49 offen lds
    s_add_u32 m0, s42, 91136
    s_add_u32 s49, s40, 626688
    buffer_load_dwordx4 v1, s[8:11], s49 offen lds
    s_add_u32 m0, s42, 92160
    s_add_u32 s49, s40, 663552
    buffer_load_dwordx4 v1, s[8:11], s49 offen lds
    s_add_u32 m0, s42, 93184
    s_add_u32 s49, s40, 700416
    buffer_load_dwordx4 v1, s[8:11], s49 offen lds
    s_add_u32 m0, s42, 110592
    s_add_u32 s49, s40, 1179648
    buffer_load_dwordx4 v1, s[4:7], s49 offen lds
    s_add_u32 m0, s42, 111616
    s_add_u32 s49, s40, 1216512
    buffer_load_dwordx4 v1, s[4:7], s49 offen lds
    s_add_u32 m0, s42, 112640
    s_add_u32 s49, s40, 1253376
    buffer_load_dwordx4 v1, s[4:7], s49 offen lds
    s_add_u32 m0, s42, 113664
    s_add_u32 s49, s40, 1290240
    buffer_load_dwordx4 v1, s[4:7], s49 offen lds
    s_add_u32 m0, s42, 126976
    s_add_u32 s49, s40, 1179648
    buffer_load_dwordx4 v1, s[8:11], s49 offen lds
    s_add_u32 m0, s42, 128000
    s_add_u32 s49, s40, 1216512
    buffer_load_dwordx4 v1, s[8:11], s49 offen lds
    s_add_u32 m0, s42, 129024
    s_add_u32 s49, s40, 1253376
    buffer_load_dwordx4 v1, s[8:11], s49 offen lds
    s_add_u32 m0, s42, 130048
    s_add_u32 s49, s40, 1290240
    buffer_load_dwordx4 v1, s[8:11], s49 offen lds
    v_lshrrev_b32 v172, 4, v15
    v_lshlrev_b32 v172, 1, v172
    v_bfe_u32 v11, v15, 1, 1
    v_add_u32 v172, v172, v11
    v_lshlrev_b32 v172, 3, v172
    v_bfe_u32 v11, v15, 2, 2
    v_add_u32 v172, v172, v11
    v_lshlrev_b32 v172, 4, v172
    v_and_b32 v11, 1, v15
    v_lshl_add_u32 v172, v11, 3, v172
    v_and_b32 v11, 7, v15
    v_lshrrev_b32 v12, 3, v15
    v_mul_u32_u24 v173, 1152, v11
    v_lshl_add_u32 v173, v12, 4, v173
    v_lshrrev_b32 v174, 1, v12
    v_lshlrev_b32 v174, 10, v174
    v_and_b32 v13, 1, v12
    v_lshl_add_u32 v174, v13, 9, v174
    v_lshl_add_u32 v174, v11, 4, v174
    v_lshlrev_b32 v175, 5, v12
    v_lshlrev_b32 v13, 2, v11
    s_lshl_b32 s58, s39, 5
    v_add_u32 v12, s58, v13
    v_lshlrev_b32 v11, 4, v15
    s_mul_i32 s58, s55, 9216
    s_lshr_b32 s59, s55, 2
    s_mul_i32 s59, s59, 36864
    s_and_b32 s60, s55, 3
    s_lshl_b32 s60, s60, 7
    s_add_u32 s59, s59, s60
    s_mov_b32 s61, 9216
    s_mov_b32 s62, 6912
    s_waitcnt vmcnt(24)
    ds_write_b128 v11, v[16:19]
    ds_write_b128 v11, v[20:23] offset:4096
    s_cmp_lg_u32 s39, 0
    s_cbranch_scc1 K34_NW3
    ds_write_b128 v11, v[24:27] offset:8192
K34_NW3:
    s_waitcnt vmcnt(16) lgkmcnt(0)
    s_barrier
    s_cmp_eq_u32 s39, 3
    s_cbranch_scc1 K34_AUX
    buffer_load_dwordx4 v[124:127], v175, s[32:35], s61 offen offset:0
    buffer_load_dwordx4 v[128:131], v175, s[32:35], s61 offen offset:16
    buffer_load_dwordx4 v[148:151], v175, s[32:35], s62 offen offset:0
    buffer_load_dwordx4 v[152:155], v175, s[32:35], s62 offen offset:16
    buffer_load_dwordx4 v[132:135], v175, s[32:35], s61 offen offset:768
    buffer_load_dwordx4 v[136:139], v175, s[32:35], s61 offen offset:784
    buffer_load_dwordx4 v[156:159], v175, s[32:35], s62 offen offset:768
    buffer_load_dwordx4 v[160:163], v175, s[32:35], s62 offen offset:784
    buffer_load_dwordx4 v[140:143], v175, s[32:35], s61 offen offset:1536
    buffer_load_dwordx4 v[144:147], v175, s[32:35], s61 offen offset:1552
    buffer_load_dwordx4 v[164:167], v175, s[32:35], s62 offen offset:1536
    buffer_load_dwordx4 v[168:171], v175, s[32:35], s62 offen offset:1552
    ds_read_b64_tr_b16 v[28:29], v172 offset:0
    ds_read_b64_tr_b16 v[30:31], v172 offset:64
    ds_read_b64_tr_b16 v[32:33], v172 offset:3072
    ds_read_b64_tr_b16 v[34:35], v172 offset:3136
    ds_read_b64_tr_b16 v[36:37], v172 offset:6144
    ds_read_b64_tr_b16 v[38:39], v172 offset:6208
    ds_read_b64_tr_b16 a[0:1], v2 offset:0
    ds_read_b64_tr_b16 a[2:3], v2 offset:1024
    ds_read_b64_tr_b16 a[4:5], v2 offset:16384
    ds_read_b64_tr_b16 a[6:7], v2 offset:17408
    ds_read_b64_tr_b16 a[8:9], v2 offset:4096
    ds_read_b64_tr_b16 a[10:11], v2 offset:5120
    ds_read_b64_tr_b16 a[12:13], v2 offset:20480
    ds_read_b64_tr_b16 a[14:15], v2 offset:21504
    ds_read_b64_tr_b16 a[16:17], v2 offset:8192
    ds_read_b64_tr_b16 a[18:19], v2 offset:9216
    ds_read_b64_tr_b16 a[20:21], v2 offset:24576
    ds_read_b64_tr_b16 a[22:23], v2 offset:25600
    ds_read_b64_tr_b16 a[24:25], v2 offset:12288
    ds_read_b64_tr_b16 a[26:27], v2 offset:13312
    ds_read_b64_tr_b16 a[28:29], v2 offset:28672
    ds_read_b64_tr_b16 a[30:31], v2 offset:29696
    s_waitcnt lgkmcnt(15)
    buffer_store_dwordx4 v[28:31], v173, s[64:67], s58 offen offset:0 sc1
    buffer_store_dwordx4 v[32:35], v173, s[64:67], s58 offen offset:384 sc1
    buffer_store_dwordx4 v[36:39], v173, s[64:67], s58 offen offset:768 sc1
    v_lshlrev_b32 v72, 16, v28
    v_and_b32 v73, 0xffff0000, v28
    v_lshlrev_b32 v74, 16, v29
    v_and_b32 v75, 0xffff0000, v29
    v_lshlrev_b32 v76, 16, v30
    v_and_b32 v77, 0xffff0000, v30
    v_lshlrev_b32 v78, 16, v31
    v_and_b32 v79, 0xffff0000, v31
    v_lshlrev_b32 v80, 16, v32
    v_and_b32 v81, 0xffff0000, v32
    v_lshlrev_b32 v82, 16, v33
    v_and_b32 v83, 0xffff0000, v33
    v_lshlrev_b32 v84, 16, v34
    v_and_b32 v85, 0xffff0000, v34
    v_lshlrev_b32 v86, 16, v35
    v_and_b32 v87, 0xffff0000, v35
    v_lshlrev_b32 v88, 16, v36
    v_and_b32 v89, 0xffff0000, v36
    v_lshlrev_b32 v90, 16, v37
    v_and_b32 v91, 0xffff0000, v37
    v_lshlrev_b32 v92, 16, v38
    v_and_b32 v93, 0xffff0000, v38
    v_lshlrev_b32 v94, 16, v39
    v_and_b32 v95, 0xffff0000, v39
    v_add_f32 v98, v72, v76
    v_add_f32 v99, v73, v77
    v_add_f32 v100, v74, v78
    v_add_f32 v101, v75, v79
    v_add_f32 v98, v98, v80
    v_add_f32 v99, v99, v81
    v_add_f32 v100, v100, v82
    v_add_f32 v101, v101, v83
    v_add_f32 v98, v98, v84
    v_add_f32 v99, v99, v85
    v_add_f32 v100, v100, v86
    v_add_f32 v101, v101, v87
    v_add_f32 v98, v98, v88
    v_add_f32 v99, v99, v89
    v_add_f32 v100, v100, v90
    v_add_f32 v101, v101, v91
    v_add_f32 v98, v98, v92
    v_add_f32 v99, v99, v93
    v_add_f32 v100, v100, v94
    v_add_f32 v101, v101, v95
    v_add_f32 v98, v98, v99
    v_add_f32 v100, v100, v101
    v_add_f32 v96, v98, v100
    s_nop 1
    v_add_f32_dpp v96, v96, v96 row_ror:8 row_mask:0xf bank_mask:0xf
    v_mov_b32 v97, v96
    s_nop 1
    v_permlane16_swap_b32 v96, v97
    v_add_f32 v96, v96, v97
    v_mov_b32 v97, v96
    s_nop 1
    v_permlane32_swap_b32 v96, v97
    v_add_f32 v96, v96, v97
    ds_write_b32 v12, v96 offset:9216
    s_waitcnt lgkmcnt(0)
    s_waitcnt vmcnt(23)
    s_barrier
    ds_read_b32 v98, v13 offset:9216
    ds_read_b32 v99, v13 offset:9248
    ds_read_b32 v100, v13 offset:9280
    s_add_u32 m0, s42, 36864
    s_add_u32 s49, s40, 1769472
    buffer_load_dwordx4 v1, s[4:7], s49 offen lds
    s_add_u32 m0, s42, 37888
    s_add_u32 s49, s40, 1806336
    buffer_load_dwordx4 v1, s[4:7], s49 offen lds
    s_add_u32 m0, s42, 38912
    s_add_u32 s49, s40, 1843200
    buffer_load_dwordx4 v1, s[4:7], s49 offen lds
    s_add_u32 m0, s42, 39936
    s_add_u32 s49, s40, 1880064
    buffer_load_dwordx4 v1, s[4:7], s49 offen lds
    s_add_u32 m0, s42, 53248
    s_add_u32 s49, s40, 1769472
    buffer_load_dwordx4 v1, s[8:11], s49 offen lds
    s_add_u32 m0, s42, 54272
    s_add_u32 s49, s40, 1806336
    buffer_load_dwordx4 v1, s[8:11], s49 offen lds
    s_add_u32 m0, s42, 55296
    s_add_u32 s49, s40, 1843200
    buffer_load_dwordx4 v1, s[8:11], s49 offen lds
    s_add_u32 m0, s42, 56320
    s_add_u32 s49, s40, 1880064
    buffer_load_dwordx4 v1, s[8:11], s49 offen lds
    ds_read_b64_tr_b16 a[32:33], v3 offset:0
    ds_read_b64_tr_b16 a[34:35], v3 offset:1024
    ds_read_b64_tr_b16 a[36:37], v3 offset:16384
    ds_read_b64_tr_b16 a[38:39], v3 offset:17408
    ds_read_b64_tr_b16 a[40:41], v3 offset:4096
    ds_read_b64_tr_b16 a[42:43], v3 offset:5120
    ds_read_b64_tr_b16 a[44:45], v3 offset:20480
    ds_read_b64_tr_b16 a[46:47], v3 offset:21504
    ds_read_b64_tr_b16 a[48:49], v3 offset:8192
    ds_read_b64_tr_b16 a[50:51], v3 offset:9216
    ds_read_b64_tr_b16 a[52:53], v3 offset:24576
    ds_read_b64_tr_b16 a[54:55], v3 offset:25600
    ds_read_b64_tr_b16 a[56:57], v3 offset:12288
    ds_read_b64_tr_b16 a[58:59], v3 offset:13312
    ds_read_b64_tr_b16 a[60:61], v3 offset:28672
    ds_read_b64_tr_b16 a[62:63], v3 offset:29696
    s_waitcnt lgkmcnt(15)
    v_add_f32 v98, v98, v99
    v_add_f32 v98, v98, v100
    v_mul_f32 v96, 0x3ae38e39, v98
    v_sub_f32 v102, v72, v96
    v_mul_f32 v98, v102, v102
    v_sub_f32 v103, v73, v96
    v_mul_f32 v99, v103, v103
    v_sub_f32 v104, v74, v96
    v_mul_f32 v100, v104, v104
    v_sub_f32 v105, v75, v96
    v_mul_f32 v101, v105, v105
    v_sub_f32 v102, v76, v96
    v_fmac_f32 v98, v102, v102
    v_sub_f32 v103, v77, v96
    v_fmac_f32 v99, v103, v103
    v_sub_f32 v104, v78, v96
    v_fmac_f32 v100, v104, v104
    v_sub_f32 v105, v79, v96
    v_fmac_f32 v101, v105, v105
    v_sub_f32 v102, v80, v96
    v_fmac_f32 v98, v102, v102
    v_sub_f32 v103, v81, v96
    v_fmac_f32 v99, v103, v103
    v_sub_f32 v104, v82, v96
    v_fmac_f32 v100, v104, v104
    v_sub_f32 v105, v83, v96
    v_fmac_f32 v101, v105, v105
    v_sub_f32 v102, v84, v96
    v_fmac_f32 v98, v102, v102
    v_sub_f32 v103, v85, v96
    v_fmac_f32 v99, v103, v103
    v_sub_f32 v104, v86, v96
    v_fmac_f32 v100, v104, v104
    v_sub_f32 v105, v87, v96
    v_fmac_f32 v101, v105, v105
    v_sub_f32 v102, v88, v96
    v_fmac_f32 v98, v102, v102
    v_sub_f32 v103, v89, v96
    v_fmac_f32 v99, v103, v103
    v_sub_f32 v104, v90, v96
    v_fmac_f32 v100, v104, v104
    v_sub_f32 v105, v91, v96
    v_fmac_f32 v101, v105, v105
    v_sub_f32 v102, v92, v96
    v_fmac_f32 v98, v102, v102
    v_sub_f32 v103, v93, v96
    v_fmac_f32 v99, v103, v103
    v_sub_f32 v104, v94, v96
    v_fmac_f32 v100, v104, v104
    v_sub_f32 v105, v95, v96
    v_fmac_f32 v101, v105, v105
    v_add_f32 v98, v98, v99
    v_add_f32 v100, v100, v101
    v_add_f32 v97, v98, v100
    s_nop 1
    v_add_f32_dpp v97, v97, v97 row_ror:8 row_mask:0xf bank_mask:0xf
    v_mov_b32 v102, v97
    s_nop 1
    v_permlane16_swap_b32 v97, v102
    v_add_f32 v97, v97, v102
    v_mov_b32 v102, v97
    s_nop 1
    v_permlane32_swap_b32 v97, v102
    v_add_f32 v97, v97, v102
    ds_write_b32 v12, v97 offset:9312
    v_cvt_pk_bf16_f32 v96, v96, v96
    v_lshlrev_b32 v96, 16, v96
    s_waitcnt lgkmcnt(0)
    s_waitcnt vmcnt(23)
    s_barrier
    ds_read_b32 v98, v13 offset:9312
    ds_read_b32 v99, v13 offset:9344
    ds_read_b32 v100, v13 offset:9376
    s_add_u32 m0, s42, 73728
    s_add_u32 s49, s40, 2359296
    buffer_load_dwordx4 v1, s[4:7], s49 offen lds
    s_add_u32 m0, s42, 74752
    s_add_u32 s49, s40, 2396160
    buffer_load_dwordx4 v1, s[4:7], s49 offen lds
    s_add_u32 m0, s42, 75776
    s_add_u32 s49, s40, 2433024
    buffer_load_dwordx4 v1, s[4:7], s49 offen lds
    s_add_u32 m0, s42, 76800
    s_add_u32 s49, s40, 2469888
    buffer_load_dwordx4 v1, s[4:7], s49 offen lds
    s_add_u32 m0, s42, 90112
    s_add_u32 s49, s40, 2359296
    buffer_load_dwordx4 v1, s[8:11], s49 offen lds
    s_add_u32 m0, s42, 91136
    s_add_u32 s49, s40, 2396160
    buffer_load_dwordx4 v1, s[8:11], s49 offen lds
    s_add_u32 m0, s42, 92160
    s_add_u32 s49, s40, 2433024
    buffer_load_dwordx4 v1, s[8:11], s49 offen lds
    s_add_u32 m0, s42, 93184
    s_add_u32 s49, s40, 2469888
    buffer_load_dwordx4 v1, s[8:11], s49 offen lds
    ds_read_b64_tr_b16 a[64:65], v4 offset:0
    ds_read_b64_tr_b16 a[66:67], v4 offset:1024
    ds_read_b64_tr_b16 a[68:69], v4 offset:16384
    ds_read_b64_tr_b16 a[70:71], v4 offset:17408
    ds_read_b64_tr_b16 a[72:73], v4 offset:4096
    ds_read_b64_tr_b16 a[74:75], v4 offset:5120
    ds_read_b64_tr_b16 a[76:77], v4 offset:20480
    ds_read_b64_tr_b16 a[78:79], v4 offset:21504
    ds_read_b64_tr_b16 a[80:81], v4 offset:8192
    ds_read_b64_tr_b16 a[82:83], v4 offset:9216
    ds_read_b64_tr_b16 a[84:85], v4 offset:24576
    ds_read_b64_tr_b16 a[86:87], v4 offset:25600
    ds_read_b64_tr_b16 a[88:89], v4 offset:12288
    ds_read_b64_tr_b16 a[90:91], v4 offset:13312
    ds_read_b64_tr_b16 a[92:93], v4 offset:28672
    ds_read_b64_tr_b16 a[94:95], v4 offset:29696
    s_waitcnt lgkmcnt(15)
    v_add_f32 v98, v98, v99
    v_add_f32 v98, v98, v100
    v_mul_f32 v97, 0x3ae38e39, v98
    v_cvt_pk_bf16_f32 v97, v97, v97
    v_lshlrev_b32 v97, 16, v97
    v_add_f32 v97, 0x3727c5ac, v97
    v_cvt_pk_bf16_f32 v97, v97, v97
    v_lshlrev_b32 v97, 16, v97
    v_sqrt_f32 v97, v97
    s_nop 0
    v_cvt_pk_bf16_f32 v97, v97, v97
    v_lshlrev_b32 v97, 16, v97
    v_rcp_f32 v97, v97
    v_sub_f32 v72, v72, v96
    v_sub_f32 v73, v73, v96
    v_sub_f32 v74, v74, v96
    v_sub_f32 v75, v75, v96
    v_sub_f32 v76, v76, v96
    v_sub_f32 v77, v77, v96
    v_sub_f32 v78, v78, v96
    v_sub_f32 v79, v79, v96
    v_sub_f32 v80, v80, v96
    v_sub_f32 v81, v81, v96
    v_sub_f32 v82, v82, v96
    v_sub_f32 v83, v83, v96
    v_sub_f32 v84, v84, v96
    v_sub_f32 v85, v85, v96
    v_sub_f32 v86, v86, v96
    v_sub_f32 v87, v87, v96
    v_sub_f32 v88, v88, v96
    v_sub_f32 v89, v89, v96
    v_sub_f32 v90, v90, v96
    v_sub_f32 v91, v91, v96
    v_sub_f32 v92, v92, v96
    v_sub_f32 v93, v93, v96
    v_sub_f32 v94, v94, v96
    v_sub_f32 v95, v95, v96
    v_cvt_pk_bf16_f32 v112, v72, v73
    v_cvt_pk_bf16_f32 v113, v74, v75
    v_cvt_pk_bf16_f32 v114, v76, v77
    v_cvt_pk_bf16_f32 v115, v78, v79
    v_cvt_pk_bf16_f32 v116, v80, v81
    v_cvt_pk_bf16_f32 v117, v82, v83
    v_cvt_pk_bf16_f32 v118, v84, v85
    v_cvt_pk_bf16_f32 v119, v86, v87
    v_cvt_pk_bf16_f32 v120, v88, v89
    v_cvt_pk_bf16_f32 v121, v90, v91
    v_cvt_pk_bf16_f32 v122, v92, v93
    v_cvt_pk_bf16_f32 v123, v94, v95
    v_lshlrev_b32 v72, 16, v112
    v_and_b32 v73, 0xffff0000, v112
    v_lshlrev_b32 v74, 16, v113
    v_and_b32 v75, 0xffff0000, v113
    v_lshlrev_b32 v76, 16, v114
    v_and_b32 v77, 0xffff0000, v114
    v_lshlrev_b32 v78, 16, v115
    v_and_b32 v79, 0xffff0000, v115
    v_lshlrev_b32 v80, 16, v116
    v_and_b32 v81, 0xffff0000, v116
    v_lshlrev_b32 v82, 16, v117
    v_and_b32 v83, 0xffff0000, v117
    v_lshlrev_b32 v84, 16, v118
    v_and_b32 v85, 0xffff0000, v118
    v_lshlrev_b32 v86, 16, v119
    v_and_b32 v87, 0xffff0000, v119
    v_lshlrev_b32 v88, 16, v120
    v_and_b32 v89, 0xffff0000, v120
    v_lshlrev_b32 v90, 16, v121
    v_and_b32 v91, 0xffff0000, v121
    v_lshlrev_b32 v92, 16, v122
    v_and_b32 v93, 0xffff0000, v122
    v_lshlrev_b32 v94, 16, v123
    v_and_b32 v95, 0xffff0000, v123
    v_mul_f32 v72, v72, v97
    v_mul_f32 v73, v73, v97
    v_mul_f32 v74, v74, v97
    v_mul_f32 v75, v75, v97
    v_mul_f32 v76, v76, v97
    v_mul_f32 v77, v77, v97
    v_mul_f32 v78, v78, v97
    v_mul_f32 v79, v79, v97
    v_mul_f32 v80, v80, v97
    v_mul_f32 v81, v81, v97
    v_mul_f32 v82, v82, v97
    v_mul_f32 v83, v83, v97
    v_mul_f32 v84, v84, v97
    v_mul_f32 v85, v85, v97
    v_mul_f32 v86, v86, v97
    v_mul_f32 v87, v87, v97
    v_mul_f32 v88, v88, v97
    v_mul_f32 v89, v89, v97
    v_mul_f32 v90, v90, v97
    v_mul_f32 v91, v91, v97
    v_mul_f32 v92, v92, v97
    v_mul_f32 v93, v93, v97
    v_mul_f32 v94, v94, v97
    v_mul_f32 v95, v95, v97
    v_cvt_pk_bf16_f32 v112, v72, v73
    v_cvt_pk_bf16_f32 v113, v74, v75
    v_cvt_pk_bf16_f32 v114, v76, v77
    v_cvt_pk_bf16_f32 v115, v78, v79
    v_cvt_pk_bf16_f32 v116, v80, v81
    v_cvt_pk_bf16_f32 v117, v82, v83
    v_cvt_pk_bf16_f32 v118, v84, v85
    v_cvt_pk_bf16_f32 v119, v86, v87
    v_cvt_pk_bf16_f32 v120, v88, v89
    v_cvt_pk_bf16_f32 v121, v90, v91
    v_cvt_pk_bf16_f32 v122, v92, v93
    v_cvt_pk_bf16_f32 v123, v94, v95
    s_waitcnt vmcnt(19)
    v_lshlrev_b32 v72, 16, v112
    v_and_b32 v73, 0xffff0000, v112
    v_lshlrev_b32 v74, 16, v113
    v_and_b32 v75, 0xffff0000, v113
    v_lshlrev_b32 v76, 16, v114
    v_and_b32 v77, 0xffff0000, v114
    v_lshlrev_b32 v78, 16, v115
    v_and_b32 v79, 0xffff0000, v115
    v_lshlrev_b32 v80, 16, v116
    v_and_b32 v81, 0xffff0000, v116
    v_lshlrev_b32 v82, 16, v117
    v_and_b32 v83, 0xffff0000, v117
    v_lshlrev_b32 v84, 16, v118
    v_and_b32 v85, 0xffff0000, v118
    v_lshlrev_b32 v86, 16, v119
    v_and_b32 v87, 0xffff0000, v119
    v_lshlrev_b32 v88, 16, v120
    v_and_b32 v89, 0xffff0000, v120
    v_lshlrev_b32 v90, 16, v121
    v_and_b32 v91, 0xffff0000, v121
    v_lshlrev_b32 v92, 16, v122
    v_and_b32 v93, 0xffff0000, v122
    v_lshlrev_b32 v94, 16, v123
    v_and_b32 v95, 0xffff0000, v123
    v_add_f32 v124, 1.0, v124
    v_add_f32 v125, 1.0, v125
    v_add_f32 v126, 1.0, v126
    v_add_f32 v127, 1.0, v127
    v_add_f32 v128, 1.0, v128
    v_add_f32 v129, 1.0, v129
    v_add_f32 v130, 1.0, v130
    v_add_f32 v131, 1.0, v131
    v_add_f32 v132, 1.0, v132
    v_add_f32 v133, 1.0, v133
    v_add_f32 v134, 1.0, v134
    v_add_f32 v135, 1.0, v135
    v_add_f32 v136, 1.0, v136
    v_add_f32 v137, 1.0, v137
    v_add_f32 v138, 1.0, v138
    v_add_f32 v139, 1.0, v139
    v_add_f32 v140, 1.0, v140
    v_add_f32 v141, 1.0, v141
    v_add_f32 v142, 1.0, v142
    v_add_f32 v143, 1.0, v143
    v_add_f32 v144, 1.0, v144
    v_add_f32 v145, 1.0, v145
    v_add_f32 v146, 1.0, v146
    v_add_f32 v147, 1.0, v147
    v_cvt_pk_bf16_f32 v96, v124, v125
    v_cvt_pk_bf16_f32 v97, v126, v127
    v_cvt_pk_bf16_f32 v98, v128, v129
    v_cvt_pk_bf16_f32 v99, v130, v131
    v_cvt_pk_bf16_f32 v100, v132, v133
    v_cvt_pk_bf16_f32 v101, v134, v135
    v_cvt_pk_bf16_f32 v102, v136, v137
    v_cvt_pk_bf16_f32 v103, v138, v139
    v_cvt_pk_bf16_f32 v104, v140, v141
    v_cvt_pk_bf16_f32 v105, v142, v143
    v_cvt_pk_bf16_f32 v106, v144, v145
    v_cvt_pk_bf16_f32 v107, v146, v147
    v_lshlrev_b32 v124, 16, v96
    v_and_b32 v125, 0xffff0000, v96
    v_lshlrev_b32 v126, 16, v97
    v_and_b32 v127, 0xffff0000, v97
    v_lshlrev_b32 v128, 16, v98
    v_and_b32 v129, 0xffff0000, v98
    v_lshlrev_b32 v130, 16, v99
    v_and_b32 v131, 0xffff0000, v99
    v_lshlrev_b32 v132, 16, v100
    v_and_b32 v133, 0xffff0000, v100
    v_lshlrev_b32 v134, 16, v101
    v_and_b32 v135, 0xffff0000, v101
    v_lshlrev_b32 v136, 16, v102
    v_and_b32 v137, 0xffff0000, v102
    v_lshlrev_b32 v138, 16, v103
    v_and_b32 v139, 0xffff0000, v103
    v_lshlrev_b32 v140, 16, v104
    v_and_b32 v141, 0xffff0000, v104
    v_lshlrev_b32 v142, 16, v105
    v_and_b32 v143, 0xffff0000, v105
    v_lshlrev_b32 v144, 16, v106
    v_and_b32 v145, 0xffff0000, v106
    v_lshlrev_b32 v146, 16, v107
    v_and_b32 v147, 0xffff0000, v107
    v_mul_f32 v72, v72, v124
    v_mul_f32 v73, v73, v125
    v_mul_f32 v74, v74, v126
    v_mul_f32 v75, v75, v127
    v_mul_f32 v76, v76, v128
    v_mul_f32 v77, v77, v129
    v_mul_f32 v78, v78, v130
    v_mul_f32 v79, v79, v131
    v_mul_f32 v80, v80, v132
    v_mul_f32 v81, v81, v133
    v_mul_f32 v82, v82, v134
    v_mul_f32 v83, v83, v135
    v_mul_f32 v84, v84, v136
    v_mul_f32 v85, v85, v137
    v_mul_f32 v86, v86, v138
    v_mul_f32 v87, v87, v139
    v_mul_f32 v88, v88, v140
    v_mul_f32 v89, v89, v141
    v_mul_f32 v90, v90, v142
    v_mul_f32 v91, v91, v143
    v_mul_f32 v92, v92, v144
    v_mul_f32 v93, v93, v145
    v_mul_f32 v94, v94, v146
    v_mul_f32 v95, v95, v147
    v_cvt_pk_bf16_f32 v96, v72, v73
    v_cvt_pk_bf16_f32 v97, v74, v75
    v_cvt_pk_bf16_f32 v98, v76, v77
    v_cvt_pk_bf16_f32 v99, v78, v79
    v_cvt_pk_bf16_f32 v100, v80, v81
    v_cvt_pk_bf16_f32 v101, v82, v83
    v_cvt_pk_bf16_f32 v102, v84, v85
    v_cvt_pk_bf16_f32 v103, v86, v87
    v_cvt_pk_bf16_f32 v104, v88, v89
    v_cvt_pk_bf16_f32 v105, v90, v91
    v_cvt_pk_bf16_f32 v106, v92, v93
    v_cvt_pk_bf16_f32 v107, v94, v95
    v_lshlrev_b32 v72, 16, v96
    v_and_b32 v73, 0xffff0000, v96
    v_lshlrev_b32 v74, 16, v97
    v_and_b32 v75, 0xffff0000, v97
    v_lshlrev_b32 v76, 16, v98
    v_and_b32 v77, 0xffff0000, v98
    v_lshlrev_b32 v78, 16, v99
    v_and_b32 v79, 0xffff0000, v99
    v_lshlrev_b32 v80, 16, v100
    v_and_b32 v81, 0xffff0000, v100
    v_lshlrev_b32 v82, 16, v101
    v_and_b32 v83, 0xffff0000, v101
    v_lshlrev_b32 v84, 16, v102
    v_and_b32 v85, 0xffff0000, v102
    v_lshlrev_b32 v86, 16, v103
    v_and_b32 v87, 0xffff0000, v103
    v_lshlrev_b32 v88, 16, v104
    v_and_b32 v89, 0xffff0000, v104
    v_lshlrev_b32 v90, 16, v105
    v_and_b32 v91, 0xffff0000, v105
    v_lshlrev_b32 v92, 16, v106
    v_and_b32 v93, 0xffff0000, v106
    v_lshlrev_b32 v94, 16, v107
    v_and_b32 v95, 0xffff0000, v107
    v_add_f32 v72, v72, v148
    v_add_f32 v73, v73, v149
    v_add_f32 v74, v74, v150
    v_add_f32 v75, v75, v151
    v_add_f32 v76, v76, v152
    v_add_f32 v77, v77, v153
    v_add_f32 v78, v78, v154
    v_add_f32 v79, v79, v155
    v_add_f32 v80, v80, v156
    v_add_f32 v81, v81, v157
    v_add_f32 v82, v82, v158
    v_add_f32 v83, v83, v159
    v_add_f32 v84, v84, v160
    v_add_f32 v85, v85, v161
    v_add_f32 v86, v86, v162
    v_add_f32 v87, v87, v163
    v_add_f32 v88, v88, v164
    v_add_f32 v89, v89, v165
    v_add_f32 v90, v90, v166
    v_add_f32 v91, v91, v167
    v_add_f32 v92, v92, v168
    v_add_f32 v93, v93, v169
    v_add_f32 v94, v94, v170
    v_add_f32 v95, v95, v171
    v_cvt_pk_bf16_f32 v96, v72, v73
    v_cvt_pk_bf16_f32 v97, v74, v75
    v_cvt_pk_bf16_f32 v98, v76, v77
    v_cvt_pk_bf16_f32 v99, v78, v79
    v_cvt_pk_bf16_f32 v100, v80, v81
    v_cvt_pk_bf16_f32 v101, v82, v83
    v_cvt_pk_bf16_f32 v102, v84, v85
    v_cvt_pk_bf16_f32 v103, v86, v87
    v_cvt_pk_bf16_f32 v104, v88, v89
    v_cvt_pk_bf16_f32 v105, v90, v91
    v_cvt_pk_bf16_f32 v106, v92, v93
    v_cvt_pk_bf16_f32 v107, v94, v95
    s_add_u32 s60, s59, 0
    buffer_store_dwordx4 v[96:99], v174, s[16:19], s60 offen sc1
    s_add_u32 s60, s59, 12288
    buffer_store_dwordx4 v[100:103], v174, s[16:19], s60 offen sc1
    s_add_u32 s60, s59, 24576
    buffer_store_dwordx4 v[104:107], v174, s[16:19], s60 offen sc1
    s_waitcnt lgkmcnt(0)
    s_barrier
    s_add_u32 m0, s42, 110592
    s_add_u32 s49, s40, 2949120
    buffer_load_dwordx4 v1, s[4:7], s49 offen lds
    s_add_u32 m0, s42, 111616
    s_add_u32 s49, s40, 2985984
    buffer_load_dwordx4 v1, s[4:7], s49 offen lds
    s_add_u32 m0, s42, 112640
    s_add_u32 s49, s40, 3022848
    buffer_load_dwordx4 v1, s[4:7], s49 offen lds
    s_add_u32 m0, s42, 113664
    s_add_u32 s49, s40, 3059712
    buffer_load_dwordx4 v1, s[4:7], s49 offen lds
    s_add_u32 m0, s42, 126976
    s_add_u32 s49, s40, 2949120
    buffer_load_dwordx4 v1, s[8:11], s49 offen lds
    s_add_u32 m0, s42, 128000
    s_add_u32 s49, s40, 2985984
    buffer_load_dwordx4 v1, s[8:11], s49 offen lds
    s_add_u32 m0, s42, 129024
    s_add_u32 s49, s40, 3022848
    buffer_load_dwordx4 v1, s[8:11], s49 offen lds
    s_add_u32 m0, s42, 130048
    s_add_u32 s49, s40, 3059712
    buffer_load_dwordx4 v1, s[8:11], s49 offen lds
    s_waitcnt vmcnt(8)
    s_branch K34_JOIN
K34_AUX:
    ds_read_b64_tr_b16 a[0:1], v2 offset:0
    ds_read_b64_tr_b16 a[2:3], v2 offset:1024
    ds_read_b64_tr_b16 a[4:5], v2 offset:16384
    ds_read_b64_tr_b16 a[6:7], v2 offset:17408
    ds_read_b64_tr_b16 a[8:9], v2 offset:4096
    ds_read_b64_tr_b16 a[10:11], v2 offset:5120
    ds_read_b64_tr_b16 a[12:13], v2 offset:20480
    ds_read_b64_tr_b16 a[14:15], v2 offset:21504
    ds_read_b64_tr_b16 a[16:17], v2 offset:8192
    ds_read_b64_tr_b16 a[18:19], v2 offset:9216
    ds_read_b64_tr_b16 a[20:21], v2 offset:24576
    ds_read_b64_tr_b16 a[22:23], v2 offset:25600
    ds_read_b64_tr_b16 a[24:25], v2 offset:12288
    ds_read_b64_tr_b16 a[26:27], v2 offset:13312
    ds_read_b64_tr_b16 a[28:29], v2 offset:28672
    ds_read_b64_tr_b16 a[30:31], v2 offset:29696
    s_waitcnt lgkmcnt(0)
    s_waitcnt vmcnt(8)
    s_barrier
    s_add_u32 m0, s42, 36864
    s_add_u32 s49, s40, 1769472
    buffer_load_dwordx4 v1, s[4:7], s49 offen lds
    s_add_u32 m0, s42, 37888
    s_add_u32 s49, s40, 1806336
    buffer_load_dwordx4 v1, s[4:7], s49 offen lds
    s_add_u32 m0, s42, 38912
    s_add_u32 s49, s40, 1843200
    buffer_load_dwordx4 v1, s[4:7], s49 offen lds
    s_add_u32 m0, s42, 39936
    s_add_u32 s49, s40, 1880064
    buffer_load_dwordx4 v1, s[4:7], s49 offen lds
    s_add_u32 m0, s42, 53248
    s_add_u32 s49, s40, 1769472
    buffer_load_dwordx4 v1, s[8:11], s49 offen lds
    s_add_u32 m0, s42, 54272
    s_add_u32 s49, s40, 1806336
    buffer_load_dwordx4 v1, s[8:11], s49 offen lds
    s_add_u32 m0, s42, 55296
    s_add_u32 s49, s40, 1843200
    buffer_load_dwordx4 v1, s[8:11], s49 offen lds
    s_add_u32 m0, s42, 56320
    s_add_u32 s49, s40, 1880064
    buffer_load_dwordx4 v1, s[8:11], s49 offen lds
    ds_read_b64_tr_b16 a[32:33], v3 offset:0
    ds_read_b64_tr_b16 a[34:35], v3 offset:1024
    ds_read_b64_tr_b16 a[36:37], v3 offset:16384
    ds_read_b64_tr_b16 a[38:39], v3 offset:17408
    ds_read_b64_tr_b16 a[40:41], v3 offset:4096
    ds_read_b64_tr_b16 a[42:43], v3 offset:5120
    ds_read_b64_tr_b16 a[44:45], v3 offset:20480
    ds_read_b64_tr_b16 a[46:47], v3 offset:21504
    ds_read_b64_tr_b16 a[48:49], v3 offset:8192
    ds_read_b64_tr_b16 a[50:51], v3 offset:9216
    ds_read_b64_tr_b16 a[52:53], v3 offset:24576
    ds_read_b64_tr_b16 a[54:55], v3 offset:25600
    ds_read_b64_tr_b16 a[56:57], v3 offset:12288
    ds_read_b64_tr_b16 a[58:59], v3 offset:13312
    ds_read_b64_tr_b16 a[60:61], v3 offset:28672
    ds_read_b64_tr_b16 a[62:63], v3 offset:29696
    s_waitcnt lgkmcnt(0)
    s_waitcnt vmcnt(8)
    s_barrier
    s_add_u32 m0, s42, 73728
    s_add_u32 s49, s40, 2359296
    buffer_load_dwordx4 v1, s[4:7], s49 offen lds
    s_add_u32 m0, s42, 74752
    s_add_u32 s49, s40, 2396160
    buffer_load_dwordx4 v1, s[4:7], s49 offen lds
    s_add_u32 m0, s42, 75776
    s_add_u32 s49, s40, 2433024
    buffer_load_dwordx4 v1, s[4:7], s49 offen lds
    s_add_u32 m0, s42, 76800
    s_add_u32 s49, s40, 2469888
    buffer_load_dwordx4 v1, s[4:7], s49 offen lds
    s_add_u32 m0, s42, 90112
    s_add_u32 s49, s40, 2359296
    buffer_load_dwordx4 v1, s[8:11], s49 offen lds
    s_add_u32 m0, s42, 91136
    s_add_u32 s49, s40, 2396160
    buffer_load_dwordx4 v1, s[8:11], s49 offen lds
    s_add_u32 m0, s42, 92160
    s_add_u32 s49, s40, 2433024
    buffer_load_dwordx4 v1, s[8:11], s49 offen lds
    s_add_u32 m0, s42, 93184
    s_add_u32 s49, s40, 2469888
    buffer_load_dwordx4 v1, s[8:11], s49 offen lds
    ds_read_b64_tr_b16 a[64:65], v4 offset:0
    ds_read_b64_tr_b16 a[66:67], v4 offset:1024
    ds_read_b64_tr_b16 a[68:69], v4 offset:16384
    ds_read_b64_tr_b16 a[70:71], v4 offset:17408
    ds_read_b64_tr_b16 a[72:73], v4 offset:4096
    ds_read_b64_tr_b16 a[74:75], v4 offset:5120
    ds_read_b64_tr_b16 a[76:77], v4 offset:20480
    ds_read_b64_tr_b16 a[78:79], v4 offset:21504
    ds_read_b64_tr_b16 a[80:81], v4 offset:8192
    ds_read_b64_tr_b16 a[82:83], v4 offset:9216
    ds_read_b64_tr_b16 a[84:85], v4 offset:24576
    ds_read_b64_tr_b16 a[86:87], v4 offset:25600
    ds_read_b64_tr_b16 a[88:89], v4 offset:12288
    ds_read_b64_tr_b16 a[90:91], v4 offset:13312
    ds_read_b64_tr_b16 a[92:93], v4 offset:28672
    ds_read_b64_tr_b16 a[94:95], v4 offset:29696
    s_waitcnt lgkmcnt(0)
    s_barrier
    s_add_u32 m0, s42, 110592
    s_add_u32 s49, s40, 2949120
    buffer_load_dwordx4 v1, s[4:7], s49 offen lds
    s_add_u32 m0, s42, 111616
    s_add_u32 s49, s40, 2985984
    buffer_load_dwordx4 v1, s[4:7], s49 offen lds
    s_add_u32 m0, s42, 112640
    s_add_u32 s49, s40, 3022848
    buffer_load_dwordx4 v1, s[4:7], s49 offen lds
    s_add_u32 m0, s42, 113664
    s_add_u32 s49, s40, 3059712
    buffer_load_dwordx4 v1, s[4:7], s49 offen lds
    s_add_u32 m0, s42, 126976
    s_add_u32 s49, s40, 2949120
    buffer_load_dwordx4 v1, s[8:11], s49 offen lds
    s_add_u32 m0, s42, 128000
    s_add_u32 s49, s40, 2985984
    buffer_load_dwordx4 v1, s[8:11], s49 offen lds
    s_add_u32 m0, s42, 129024
    s_add_u32 s49, s40, 3022848
    buffer_load_dwordx4 v1, s[8:11], s49 offen lds
    s_add_u32 m0, s42, 130048
    s_add_u32 s49, s40, 3059712
    buffer_load_dwordx4 v1, s[8:11], s49 offen lds
K34_JOIN:
    s_barrier
    s_lshl_b32 s63, s37, 7
    s_cmp_lg_u32 s39, 0
    s_cbranch_scc1 K34_NS
    s_mov_b64 exec, 1
    v_mov_b32 v11, 1
    buffer_atomic_add v11, off, s[68:71], s72 sc1
    s_mov_b64 exec, -1
K34_NS:
    s_cmp_ge_u32 s3, 252
    s_cbranch_scc1 K34_HEND
    s_add_u32 m0, s44, 0
    s_add_u32 s49, s43, 0
    buffer_load_dwordx4 v5, s[16:19], s49 offen offset:0 sc1 lds
    buffer_load_dwordx4 v5, s[16:19], s49 offen offset:1024 sc1 lds
    buffer_load_dwordx4 v5, s[16:19], s49 offen offset:2048 sc1 lds
    buffer_load_dwordx4 v5, s[16:19], s49 offen offset:3072 sc1 lds
    s_add_u32 m0, s44, 4096
    s_add_u32 s49, s43, 4096
    buffer_load_dwordx4 v5, s[16:19], s49 offen offset:0 sc1 lds
    buffer_load_dwordx4 v5, s[16:19], s49 offen offset:1024 sc1 lds
    buffer_load_dwordx4 v5, s[16:19], s49 offen offset:2048 sc1 lds
    buffer_load_dwordx4 v5, s[16:19], s49 offen offset:3072 sc1 lds
    s_add_u32 m0, s44, 8192
    s_add_u32 s49, s43, 8192
    buffer_load_dwordx4 v5, s[16:19], s49 offen offset:0 sc1 lds
    s_waitcnt vmcnt(25)
    s_barrier
    ds_read_b64_tr_b16 a[96:97], v2 offset:0
    ds_read_b64_tr_b16 a[98:99], v2 offset:1024
    ds_read_b64_tr_b16 a[100:101], v2 offset:16384
    ds_read_b64_tr_b16 a[102:103], v2 offset:17408
    ds_read_b64_tr_b16 a[104:105], v2 offset:4096
    ds_read_b64_tr_b16 a[106:107], v2 offset:5120
    ds_read_b64_tr_b16 a[108:109], v2 offset:20480
    ds_read_b64_tr_b16 a[110:111], v2 offset:21504
    ds_read_b64_tr_b16 a[112:113], v2 offset:8192
    ds_read_b64_tr_b16 a[114:115], v2 offset:9216
    ds_read_b64_tr_b16 a[116:117], v2 offset:24576
    ds_read_b64_tr_b16 a[118:119], v2 offset:25600
    ds_read_b64_tr_b16 a[120:121], v2 offset:12288
    ds_read_b64_tr_b16 a[122:123], v2 offset:13312
    ds_read_b64_tr_b16 a[124:125], v2 offset:28672
    ds_read_b64_tr_b16 a[126:127], v2 offset:29696
    s_waitcnt lgkmcnt(0)
    s_barrier
    s_add_u32 m0, s42, 36864
    s_add_u32 s49, s40, 3538944
    buffer_load_dwordx4 v1, s[4:7], s49 offen lds
    s_add_u32 m0, s42, 37888
    s_add_u32 s49, s40, 3575808
    buffer_load_dwordx4 v1, s[4:7], s49 offen lds
    s_add_u32 m0, s42, 38912
    s_add_u32 s49, s40, 3612672
    buffer_load_dwordx4 v1, s[4:7], s49 offen lds
    s_add_u32 m0, s42, 39936
    s_add_u32 s49, s40, 3649536
    buffer_load_dwordx4 v1, s[4:7], s49 offen lds
    s_add_u32 m0, s42, 53248
    s_add_u32 s49, s40, 3538944
    buffer_load_dwordx4 v1, s[8:11], s49 offen lds
    s_add_u32 m0, s42, 54272
    s_add_u32 s49, s40, 3575808
    buffer_load_dwordx4 v1, s[8:11], s49 offen lds
    s_add_u32 m0, s42, 55296
    s_add_u32 s49, s40, 3612672
    buffer_load_dwordx4 v1, s[8:11], s49 offen lds
    s_add_u32 m0, s42, 56320
    s_add_u32 s49, s40, 3649536
    buffer_load_dwordx4 v1, s[8:11], s49 offen lds
    s_waitcnt vmcnt(25)
    s_barrier
    ds_read_b64_tr_b16 a[128:129], v3 offset:0
    ds_read_b64_tr_b16 a[130:131], v3 offset:1024
    ds_read_b64_tr_b16 a[132:133], v3 offset:16384
    ds_read_b64_tr_b16 a[134:135], v3 offset:17408
    ds_read_b64_tr_b16 a[136:137], v3 offset:4096
    ds_read_b64_tr_b16 a[138:139], v3 offset:5120
    ds_read_b64_tr_b16 a[140:141], v3 offset:20480
    ds_read_b64_tr_b16 a[142:143], v3 offset:21504
    ds_read_b64_tr_b16 a[144:145], v3 offset:8192
    ds_read_b64_tr_b16 a[146:147], v3 offset:9216
    ds_read_b64_tr_b16 a[148:149], v3 offset:24576
    ds_read_b64_tr_b16 a[150:151], v3 offset:25600
    ds_read_b64_tr_b16 a[152:153], v3 offset:12288
    ds_read_b64_tr_b16 a[154:155], v3 offset:13312
    ds_read_b64_tr_b16 a[156:157], v3 offset:28672
    ds_read_b64_tr_b16 a[158:159], v3 offset:29696
    s_waitcnt lgkmcnt(0)
    s_barrier
    s_add_u32 m0, s42, 73728
    s_add_u32 s49, s40, 4128768
    buffer_load_dwordx4 v1, s[4:7], s49 offen lds
    s_add_u32 m0, s42, 74752
    s_add_u32 s49, s40, 4165632
    buffer_load_dwordx4 v1, s[4:7], s49 offen lds
    s_add_u32 m0, s42, 75776
    s_add_u32 s49, s40, 4202496
    buffer_load_dwordx4 v1, s[4:7], s49 offen lds
    s_add_u32 m0, s42, 76800
    s_add_u32 s49, s40, 4239360
    buffer_load_dwordx4 v1, s[4:7], s49 offen lds
    s_add_u32 m0, s42, 90112
    s_add_u32 s49, s40, 4128768
    buffer_load_dwordx4 v1, s[8:11], s49 offen lds
    s_add_u32 m0, s42, 91136
    s_add_u32 s49, s40, 4165632
    buffer_load_dwordx4 v1, s[8:11], s49 offen lds
    s_add_u32 m0, s42, 92160
    s_add_u32 s49, s40, 4202496
    buffer_load_dwordx4 v1, s[8:11], s49 offen lds
    s_add_u32 m0, s42, 93184
    s_add_u32 s49, s40, 4239360
    buffer_load_dwordx4 v1, s[8:11], s49 offen lds
    s_waitcnt vmcnt(25)
    s_barrier
    ds_read_b64_tr_b16 a[160:161], v4 offset:0
    ds_read_b64_tr_b16 a[162:163], v4 offset:1024
    ds_read_b64_tr_b16 a[164:165], v4 offset:16384
    ds_read_b64_tr_b16 a[166:167], v4 offset:17408
    ds_read_b64_tr_b16 a[168:169], v4 offset:4096
    ds_read_b64_tr_b16 a[170:171], v4 offset:5120
    ds_read_b64_tr_b16 a[172:173], v4 offset:20480
    ds_read_b64_tr_b16 a[174:175], v4 offset:21504
    ds_read_b64_tr_b16 a[176:177], v4 offset:8192
    ds_read_b64_tr_b16 a[178:179], v4 offset:9216
    ds_read_b64_tr_b16 a[180:181], v4 offset:24576
    ds_read_b64_tr_b16 a[182:183], v4 offset:25600
    ds_read_b64_tr_b16 a[184:185], v4 offset:12288
    ds_read_b64_tr_b16 a[186:187], v4 offset:13312
    ds_read_b64_tr_b16 a[188:189], v4 offset:28672
    ds_read_b64_tr_b16 a[190:191], v4 offset:29696
    s_waitcnt lgkmcnt(0)
    s_barrier
    s_cmp_lg_u32 s39, 0
    s_cbranch_scc1 K34_P0
    buffer_load_dword v11, off, s[68:71], s63 sc1
K34_P0:
    s_add_u32 m0, s42, 110592
    s_add_u32 s49, s40, 4718592
    buffer_load_dwordx4 v1, s[4:7], s49 offen lds
    s_add_u32 m0, s42, 111616
    s_add_u32 s49, s40, 4755456
    buffer_load_dwordx4 v1, s[4:7], s49 offen lds
    s_add_u32 m0, s42, 112640
    s_add_u32 s49, s40, 4792320
    buffer_load_dwordx4 v1, s[4:7], s49 offen lds
    s_add_u32 m0, s42, 113664
    s_add_u32 s49, s40, 4829184
    buffer_load_dwordx4 v1, s[4:7], s49 offen lds
    s_add_u32 m0, s42, 126976
    s_add_u32 s49, s40, 4718592
    buffer_load_dwordx4 v1, s[8:11], s49 offen lds
    s_add_u32 m0, s42, 128000
    s_add_u32 s49, s40, 4755456
    buffer_load_dwordx4 v1, s[8:11], s49 offen lds
    s_add_u32 m0, s42, 129024
    s_add_u32 s49, s40, 4792320
    buffer_load_dwordx4 v1, s[8:11], s49 offen lds
    s_add_u32 m0, s42, 130048
    s_add_u32 s49, s40, 4829184
    buffer_load_dwordx4 v1, s[8:11], s49 offen lds
    s_waitcnt vmcnt(16)
    s_barrier
    ds_read_b64_tr_b16 a[192:193], v2 offset:0
    ds_read_b64_tr_b16 a[194:195], v2 offset:1024
    ds_read_b64_tr_b16 a[196:197], v2 offset:16384
    ds_read_b64_tr_b16 a[198:199], v2 offset:17408
    ds_read_b64_tr_b16 a[200:201], v2 offset:4096
    ds_read_b64_tr_b16 a[202:203], v2 offset:5120
    ds_read_b64_tr_b16 a[204:205], v2 offset:20480
    ds_read_b64_tr_b16 a[206:207], v2 offset:21504
    ds_read_b64_tr_b16 a[208:209], v2 offset:8192
    ds_read_b64_tr_b16 a[210:211], v2 offset:9216
    ds_read_b64_tr_b16 a[212:213], v2 offset:24576
    ds_read_b64_tr_b16 a[214:215], v2 offset:25600
    ds_read_b64_tr_b16 a[216:217], v2 offset:12288
    ds_read_b64_tr_b16 a[218:219], v2 offset:13312
    ds_read_b64_tr_b16 a[220:221], v2 offset:28672
    ds_read_b64_tr_b16 a[222:223], v2 offset:29696
    s_waitcnt lgkmcnt(0)
    s_cmp_lg_u32 s39, 0
    s_cbranch_scc1 K34_PD
    s_cmp_eq_u32 s37, 0
    s_cselect_b32 s56, 40, 36
    s_mov_b32 s57, 0
    s_waitcnt vmcnt(8)
    s_branch K34_PC
K34_PL:
    buffer_load_dword v11, off, s[68:71], s63 sc1
    s_waitcnt vmcnt(0)
K34_PC:
    v_readfirstlane_b32 s58, v11
    s_cmp_ge_u32 s58, s56
    s_nop 3
    s_cbranch_scc1 K34_PD
    s_sleep 2
    s_add_u32 s57, s57, 1
    s_cmp_lt_u32 s57, 0x10000
    s_cbranch_scc1 K34_PL
K34_PD:
    s_barrier
    s_add_u32 m0, s44, 36864
    s_add_u32 s49, s43, 36864
    buffer_load_dwordx4 v5, s[16:19], s49 offen offset:0 sc1 lds
    buffer_load_dwordx4 v5, s[16:19], s49 offen offset:1024 sc1 lds
    buffer_load_dwordx4 v5, s[16:19], s49 offen offset:2048 sc1 lds
    buffer_load_dwordx4 v5, s[16:19], s49 offen offset:3072 sc1 lds
    s_add_u32 m0, s44, 40960
    s_add_u32 s49, s43, 40960
    buffer_load_dwordx4 v5, s[16:19], s49 offen offset:0 sc1 lds
    buffer_load_dwordx4 v5, s[16:19], s49 offen offset:1024 sc1 lds
    buffer_load_dwordx4 v5, s[16:19], s49 offen offset:2048 sc1 lds
    buffer_load_dwordx4 v5, s[16:19], s49 offen offset:3072 sc1 lds
    s_add_u32 m0, s44, 45056
    s_add_u32 s49, s43, 45056
    buffer_load_dwordx4 v5, s[16:19], s49 offen offset:0 sc1 lds
    v_mov_b32 v13, 0x7ffffff0
    buffer_load_dwordx4 v[172:175], v13, s[24:27], 0 offen
    s_waitcnt vmcnt(18)
    s_barrier
    ds_read_b64_tr_b16 a[224:225], v3 offset:0
    ds_read_b64_tr_b16 a[226:227], v3 offset:1024
    ds_read_b64_tr_b16 a[228:229], v3 offset:16384
    ds_read_b64_tr_b16 a[230:231], v3 offset:17408
    ds_read_b64_tr_b16 a[232:233], v3 offset:4096
    ds_read_b64_tr_b16 a[234:235], v3 offset:5120
    ds_read_b64_tr_b16 a[236:237], v3 offset:20480
    ds_read_b64_tr_b16 a[238:239], v3 offset:21504
    ds_read_b64_tr_b16 a[240:241], v3 offset:8192
    ds_read_b64_tr_b16 a[242:243], v3 offset:9216
    ds_read_b64_tr_b16 a[244:245], v3 offset:24576
    ds_read_b64_tr_b16 a[246:247], v3 offset:25600
    ds_read_b64_tr_b16 a[248:249], v3 offset:12288
    ds_read_b64_tr_b16 a[250:251], v3 offset:13312
    ds_read_b64_tr_b16 a[252:253], v3 offset:28672
    ds_read_b64_tr_b16 a[254:255], v3 offset:29696
    s_waitcnt lgkmcnt(0)
    s_barrier
    s_add_u32 m0, s44, 73728
    s_add_u32 s49, s43, 73728
    buffer_load_dwordx4 v5, s[16:19], s49 offen offset:0 sc1 lds
    buffer_load_dwordx4 v5, s[16:19], s49 offen offset:1024 sc1 lds
    buffer_load_dwordx4 v5, s[16:19], s49 offen offset:2048 sc1 lds
    buffer_load_dwordx4 v5, s[16:19], s49 offen offset:3072 sc1 lds
    s_add_u32 m0, s44, 77824
    s_add_u32 s49, s43, 77824
    buffer_load_dwordx4 v5, s[16:19], s49 offen offset:0 sc1 lds
    buffer_load_dwordx4 v5, s[16:19], s49 offen offset:1024 sc1 lds
    buffer_load_dwordx4 v5, s[16:19], s49 offen offset:2048 sc1 lds
    buffer_load_dwordx4 v5, s[16:19], s49 offen offset:3072 sc1 lds
    s_add_u32 m0, s44, 81920
    s_add_u32 s49, s43, 81920
    buffer_load_dwordx4 v5, s[16:19], s49 offen offset:0 sc1 lds
    v_mov_b32 v13, 0x7ffffff0
    buffer_load_dwordx4 v[172:175], v13, s[24:27], 0 offen
    s_waitcnt vmcnt(20)
    s_barrier
    ds_read_b64_tr_b16 v[40:41], v4 offset:0
    ds_read_b64_tr_b16 v[42:43], v4 offset:1024
    ds_read_b64_tr_b16 v[44:45], v4 offset:16384
    ds_read_b64_tr_b16 v[46:47], v4 offset:17408
    ds_read_b64_tr_b16 v[48:49], v4 offset:4096
    ds_read_b64_tr_b16 v[50:51], v4 offset:5120
    ds_read_b64_tr_b16 v[52:53], v4 offset:20480
    ds_read_b64_tr_b16 v[54:55], v4 offset:21504
    ds_read_b64_tr_b16 v[56:57], v4 offset:8192
    ds_read_b64_tr_b16 v[58:59], v4 offset:9216
    ds_read_b64_tr_b16 v[60:61], v4 offset:24576
    ds_read_b64_tr_b16 v[62:63], v4 offset:25600
    ds_read_b64_tr_b16 v[64:65], v4 offset:12288
    ds_read_b64_tr_b16 v[66:67], v4 offset:13312
    ds_read_b64_tr_b16 v[68:69], v4 offset:28672
    ds_read_b64_tr_b16 v[70:71], v4 offset:29696
    s_waitcnt lgkmcnt(0)
    s_barrier
    v_mov_b32 v2, v5
    v_add_u32 v3, 36864, v5
    v_mov_b32 v1, 0x7ffffff0
    s_mov_b32 s55, 0
    s_cmp_eq_u32 s37, 0
    s_cselect_b32 s56, 6, 5
    s_cselect_b32 s61, 99, 8
    s_mov_b32 s57, 110592
    s_mov_b32 s58, 0
    s_mov_b32 s60, 0
    s_add_u32 s43, s43, 110592
    s_sub_u32 s45, s45, 2048
    s_waitcnt vmcnt(44)
    s_barrier
    s_mul_i32 s59, s39, 9216
    v_add_u32 v11, s59, v5
    ds_read_b128 v[136:139], v11 offset:0
    ds_read_b128 v[140:143], v11 offset:1024
    ds_read_b128 v[144:147], v11 offset:2048
    ds_read_b128 v[148:151], v11 offset:3072
    ds_read_b128 v[152:155], v11 offset:4096
    ds_read_b128 v[156:159], v11 offset:5120
    ds_read_b128 v[160:163], v11 offset:6144
    ds_read_b128 v[164:167], v11 offset:7168
    ds_read_b128 v[168:171], v11 offset:8192
    s_waitcnt lgkmcnt(8)
    v_max3_u32 v12, v136, v137, v138
    v_max_u32 v12, v12, v139
    s_waitcnt lgkmcnt(7)
    v_max3_u32 v12, v140, v141, v12
    v_max3_u32 v12, v142, v143, v12
    s_waitcnt lgkmcnt(6)
    v_max3_u32 v12, v144, v145, v12
    v_max3_u32 v12, v146, v147, v12
    s_waitcnt lgkmcnt(5)
    v_max3_u32 v12, v148, v149, v12
    v_max3_u32 v12, v150, v151, v12
    s_waitcnt lgkmcnt(4)
    v_max3_u32 v12, v152, v153, v12
    v_max3_u32 v12, v154, v155, v12
    s_waitcnt lgkmcnt(3)
    v_max3_u32 v12, v156, v157, v12
    v_max3_u32 v12, v158, v159, v12
    s_waitcnt lgkmcnt(2)
    v_max3_u32 v12, v160, v161, v12
    v_max3_u32 v12, v162, v163, v12
    s_waitcnt lgkmcnt(1)
    v_max3_u32 v12, v164, v165, v12
    v_max3_u32 v12, v166, v167, v12
    s_waitcnt lgkmcnt(0)
    v_max3_u32 v12, v168, v169, v12
    v_max3_u32 v12, v170, v171, v12
    v_cmp_eq_u32 vcc, -1, v12
    s_cmp_lg_u64 vcc, 0
    s_cselect_b32 s59, 1, 0
    v_mov_b32 v12, s59
    s_lshl_b32 s59, s39, 2
    s_add_u32 s59, s59, 147456
    v_mov_b32 v11, s59
    ds_write_b32 v11, v12
    s_waitcnt lgkmcnt(0)
    s_barrier
    v_mov_b32 v11, 147456
    ds_read_b128 v[136:139], v11
    s_waitcnt lgkmcnt(0)
    v_or3_b32 v12, v136, v137, v138
    v_or_b32 v12, v12, v139
    s_nop 0
    v_readfirstlane_b32 s59, v12
    s_cmp_eq_u32 s59, 0
    s_nop 3
    s_cbranch_scc1 K34_XOK
    s_add_u32 m0, s44, 0
    s_sub_u32 s49, s43, 110592
    buffer_load_dwordx4 v5, s[16:19], s49 offen offset:0 sc0 sc1 lds
    buffer_load_dwordx4 v5, s[16:19], s49 offen offset:1024 sc0 sc1 lds
    buffer_load_dwordx4 v5, s[16:19], s49 offen offset:2048 sc0 sc1 lds
    buffer_load_dwordx4 v5, s[16:19], s49 offen offset:3072 sc0 sc1 lds
    s_add_u32 m0, s44, 4096
    s_sub_u32 s49, s43, 106496
    buffer_load_dwordx4 v5, s[16:19], s49 offen offset:0 sc0 sc1 lds
    buffer_load_dwordx4 v5, s[16:19], s49 offen offset:1024 sc0 sc1 lds
    buffer_load_dwordx4 v5, s[16:19], s49 offen offset:2048 sc0 sc1 lds
    buffer_load_dwordx4 v5, s[16:19], s49 offen offset:3072 sc0 sc1 lds
    s_add_u32 m0, s44, 8192
    s_sub_u32 s49, s43, 102400
    buffer_load_dwordx4 v5, s[16:19], s49 offen offset:0 sc0 sc1 lds
    s_waitcnt vmcnt(0)
    s_barrier
K34_XOK:
    ds_read_b128 v[16:19], v5 offset:0
    ds_read_b128 v[20:23], v5 offset:1024
    ds_read_b128 v[24:27], v5 offset:2048
    ds_read_b128 v[28:31], v5 offset:3072
K34_LOOP:
    ds_read_b128 v[32:35], v2 offset:4096
    s_waitcnt lgkmcnt(4)
    v_mfma_f32_32x32x16_bf16 v[72:87], a[0:3], v[16:19], 0
    v_cvt_pk_bf16_f32 v160, v104, v105
    v_cvt_pk_bf16_f32 v161, v106, v107
    v_cvt_pk_bf16_f32 v162, v108, v109
    v_mfma_f32_32x32x16_bf16 v[88:103], a[4:7], v[16:19], 0
    v_cvt_pk_bf16_f32 v163, v110, v111
    v_lshlrev_b32 v136, 16, v160
    v_and_b32 v137, s47, v160
    ds_read_b128 v[36:39], v2 offset:5120
    s_waitcnt lgkmcnt(4)
    v_mfma_f32_32x32x16_bf16 v[72:87], a[8:11], v[20:23], v[72:87]
    v_lshlrev_b32 v138, 16, v161
    v_and_b32 v139, s47, v161
    v_lshlrev_b32 v140, 16, v162
    v_mfma_f32_32x32x16_bf16 v[88:103], a[12:15], v[20:23], v[88:103]
    v_and_b32 v141, s47, v162
    v_lshlrev_b32 v142, 16, v163
    v_and_b32 v143, s47, v163
    ds_read_b128 v[16:19], v2 offset:6144
    s_waitcnt lgkmcnt(4)
    v_mfma_f32_32x32x16_bf16 v[72:87], a[16:19], v[24:27], v[72:87]
    v_mul_f32 v144, s48, v136
    v_mul_f32 v145, s48, v137
    v_mfma_f32_32x32x16_bf16 v[88:103], a[20:23], v[24:27], v[88:103]
    v_mul_f32 v146, s48, v138
    v_mul_f32 v147, s48, v139
    v_mul_f32 v148, s48, v140
    ds_read_b128 v[20:23], v2 offset:7168
    s_waitcnt lgkmcnt(4)
    v_mfma_f32_32x32x16_bf16 v[72:87], a[24:27], v[28:31], v[72:87]
    v_mul_f32 v149, s48, v141
    v_mul_f32 v150, s48, v142
    v_mul_f32 v151, s48, v143
    v_mfma_f32_32x32x16_bf16 v[88:103], a[28:31], v[28:31], v[88:103]
    v_exp_f32 v144, v144
    v_exp_f32 v145, v145
    v_exp_f32 v146, v146
    ds_read_b128 v[24:27], v2 offset:8192
    s_waitcnt lgkmcnt(4)
    v_mfma_f32_32x32x16_bf16 v[72:87], a[32:35], v[32:35], v[72:87]
    v_exp_f32 v147, v147
    v_exp_f32 v148, v148
    v_exp_f32 v149, v149
    v_mfma_f32_32x32x16_bf16 v[88:103], a[36:39], v[32:35], v[88:103]
    v_exp_f32 v150, v150
    v_exp_f32 v151, v151
    ds_read_b128 v[28:31], v2 offset:9216
    s_waitcnt lgkmcnt(4)
    v_mfma_f32_32x32x16_bf16 v[72:87], a[40:43], v[36:39], v[72:87]
    v_cvt_pk_bf16_f32 v160, v120, v121
    v_cvt_pk_bf16_f32 v161, v122, v123
    v_cvt_pk_bf16_f32 v162, v124, v125
    v_mfma_f32_32x32x16_bf16 v[88:103], a[44:47], v[36:39], v[88:103]
    v_cvt_pk_bf16_f32 v163, v126, v127
    v_add_f32 v144, 1.0, v144
    v_add_f32 v145, 1.0, v145
    ds_read_b128 v[32:35], v2 offset:10240
    s_waitcnt lgkmcnt(4)
    v_mfma_f32_32x32x16_bf16 v[72:87], a[48:51], v[16:19], v[72:87]
    v_add_f32 v146, 1.0, v146
    v_add_f32 v147, 1.0, v147
    v_add_f32 v148, 1.0, v148
    v_mfma_f32_32x32x16_bf16 v[88:103], a[52:55], v[16:19], v[88:103]
    v_add_f32 v149, 1.0, v149
    v_add_f32 v150, 1.0, v150
    v_add_f32 v151, 1.0, v151
    ds_read_b128 v[36:39], v2 offset:11264
    s_waitcnt lgkmcnt(4)
    v_mfma_f32_32x32x16_bf16 v[72:87], a[56:59], v[20:23], v[72:87]
    v_rcp_f32 v144, v144
    v_rcp_f32 v145, v145
    v_mfma_f32_32x32x16_bf16 v[88:103], a[60:63], v[20:23], v[88:103]
    v_rcp_f32 v146, v146
    v_rcp_f32 v147, v147
    v_rcp_f32 v148, v148
    ds_read_b128 v[16:19], v2 offset:12288
    s_waitcnt lgkmcnt(4)
    v_mfma_f32_32x32x16_bf16 v[72:87], a[64:67], v[24:27], v[72:87]
    v_rcp_f32 v149, v149
    v_rcp_f32 v150, v150
    v_rcp_f32 v151, v151
    v_mfma_f32_32x32x16_bf16 v[88:103], a[68:71], v[24:27], v[88:103]
    v_lshlrev_b32 v152, 16, v160
    v_and_b32 v153, s47, v160
    v_lshlrev_b32 v154, 16, v161
    ds_read_b128 v[20:23], v2 offset:13312
    s_waitcnt lgkmcnt(4)
    v_mfma_f32_32x32x16_bf16 v[72:87], a[72:75], v[28:31], v[72:87]
    v_and_b32 v155, s47, v161
    v_lshlrev_b32 v156, 16, v162
    v_and_b32 v157, s47, v162
    v_mfma_f32_32x32x16_bf16 v[88:103], a[76:79], v[28:31], v[88:103]
    v_lshlrev_b32 v158, 16, v163
    v_and_b32 v159, s47, v163
    ds_read_b128 v[24:27], v2 offset:14336
    s_waitcnt lgkmcnt(4)
    v_mfma_f32_32x32x16_bf16 v[72:87], a[80:83], v[32:35], v[72:87]
    v_mul_f32 v136, v136, v144
    v_mul_f32 v137, v137, v145
    v_mul_f32 v138, v138, v146
    v_mfma_f32_32x32x16_bf16 v[88:103], a[84:87], v[32:35], v[88:103]
    v_mul_f32 v139, v139, v147
    v_mul_f32 v140, v140, v148
    v_mul_f32 v141, v141, v149
    ds_read_b128 v[28:31], v2 offset:15360
    s_waitcnt lgkmcnt(4)
    v_mfma_f32_32x32x16_bf16 v[72:87], a[88:91], v[36:39], v[72:87]
    v_mul_f32 v142, v142, v150
    v_mul_f32 v143, v143, v151
    v_cvt_pk_bf16_f32 v160, v136, v137
    v_mfma_f32_32x32x16_bf16 v[88:103], a[92:95], v[36:39], v[88:103]
    v_cvt_pk_bf16_f32 v161, v138, v139
    v_cvt_pk_bf16_f32 v162, v140, v141
    v_cvt_pk_bf16_f32 v163, v142, v143
    ds_read_b128 v[32:35], v2 offset:16384
    s_waitcnt lgkmcnt(4)
    v_mfma_f32_32x32x16_bf16 v[72:87], a[96:99], v[16:19], v[72:87]
    v_lshlrev_b32 v136, 16, v160
    v_and_b32 v137, s47, v160
    v_mfma_f32_32x32x16_bf16 v[88:103], a[100:103], v[16:19], v[88:103]
    v_lshlrev_b32 v138, 16, v161
    v_and_b32 v139, s47, v161
    v_lshlrev_b32 v140, 16, v162
    ds_read_b128 v[36:39], v2 offset:17408
    s_waitcnt lgkmcnt(4)
    v_mfma_f32_32x32x16_bf16 v[72:87], a[104:107], v[20:23], v[72:87]
    v_and_b32 v141, s47, v162
    v_lshlrev_b32 v142, 16, v163
    v_and_b32 v143, s47, v163
    v_mfma_f32_32x32x16_bf16 v[88:103], a[108:111], v[20:23], v[88:103]
    v_mul_f32 v136, v136, v152
    v_mul_f32 v137, v137, v153
    v_mul_f32 v138, v138, v154
    ds_read_b128 v[16:19], v2 offset:18432
    s_waitcnt lgkmcnt(4)
    v_mfma_f32_32x32x16_bf16 v[72:87], a[112:115], v[24:27], v[72:87]
    v_mul_f32 v139, v139, v155
    v_mul_f32 v140, v140, v156
    v_mul_f32 v141, v141, v157
    v_mfma_f32_32x32x16_bf16 v[88:103], a[116:119], v[24:27], v[88:103]
    v_mul_f32 v142, v142, v158
    v_mul_f32 v143, v143, v159
    ds_read_b128 v[20:23], v2 offset:19456
    s_waitcnt lgkmcnt(4)
    v_mfma_f32_32x32x16_bf16 v[72:87], a[120:123], v[28:31], v[72:87]
    v_cvt_pk_bf16_f32 v164, v136, v137
    v_cvt_pk_bf16_f32 v165, v138, v139
    v_cvt_pk_bf16_f32 v166, v140, v141
    v_mfma_f32_32x32x16_bf16 v[88:103], a[124:127], v[28:31], v[88:103]
    v_cvt_pk_bf16_f32 v167, v142, v143
    buffer_store_dwordx4 v[164:167], v1, s[20:23], s45 offen offset:0 sc1
    v_cvt_pk_bf16_f32 v160, v112, v113
    ds_read_b128 v[24:27], v2 offset:20480
    s_waitcnt lgkmcnt(4)
    v_mfma_f32_32x32x16_bf16 v[72:87], a[128:131], v[32:35], v[72:87]
    v_cvt_pk_bf16_f32 v161, v114, v115
    v_cvt_pk_bf16_f32 v162, v116, v117
    v_cvt_pk_bf16_f32 v163, v118, v119
    v_mfma_f32_32x32x16_bf16 v[88:103], a[132:135], v[32:35], v[88:103]
    v_lshlrev_b32 v136, 16, v160
    v_and_b32 v137, s47, v160
    v_lshlrev_b32 v138, 16, v161
    ds_read_b128 v[28:31], v2 offset:21504
    s_waitcnt lgkmcnt(4)
    v_mfma_f32_32x32x16_bf16 v[72:87], a[136:139], v[36:39], v[72:87]
    v_and_b32 v139, s47, v161
    v_lshlrev_b32 v140, 16, v162
    v_mfma_f32_32x32x16_bf16 v[88:103], a[140:143], v[36:39], v[88:103]
    v_and_b32 v141, s47, v162
    v_lshlrev_b32 v142, 16, v163
    v_and_b32 v143, s47, v163
    ds_read_b128 v[32:35], v2 offset:22528
    s_waitcnt lgkmcnt(4)
    v_mfma_f32_32x32x16_bf16 v[72:87], a[144:147], v[16:19], v[72:87]
    v_mul_f32 v144, s48, v136
    v_mul_f32 v145, s48, v137
    v_mul_f32 v146, s48, v138
    v_mfma_f32_32x32x16_bf16 v[88:103], a[148:151], v[16:19], v[88:103]
    v_mul_f32 v147, s48, v139
    v_mul_f32 v148, s48, v140
    v_mul_f32 v149, s48, v141
    ds_read_b128 v[36:39], v2 offset:23552
    s_waitcnt lgkmcnt(4)
    v_mfma_f32_32x32x16_bf16 v[72:87], a[152:155], v[20:23], v[72:87]
    v_mul_f32 v150, s48, v142
    v_mul_f32 v151, s48, v143
    v_exp_f32 v144, v144
    v_mfma_f32_32x32x16_bf16 v[88:103], a[156:159], v[20:23], v[88:103]
    v_exp_f32 v145, v145
    v_exp_f32 v146, v146
    ds_read_b128 v[16:19], v2 offset:24576
    s_waitcnt lgkmcnt(4)
    v_mfma_f32_32x32x16_bf16 v[72:87], a[160:163], v[24:27], v[72:87]
    v_exp_f32 v147, v147
    v_exp_f32 v148, v148
    v_exp_f32 v149, v149
    v_mfma_f32_32x32x16_bf16 v[88:103], a[164:167], v[24:27], v[88:103]
    v_exp_f32 v150, v150
    v_exp_f32 v151, v151
    v_cvt_pk_bf16_f32 v160, v128, v129
    ds_read_b128 v[20:23], v2 offset:25600
    s_waitcnt lgkmcnt(4)
    v_mfma_f32_32x32x16_bf16 v[72:87], a[168:171], v[28:31], v[72:87]
    v_cvt_pk_bf16_f32 v161, v130, v131
    v_cvt_pk_bf16_f32 v162, v132, v133
    v_cvt_pk_bf16_f32 v163, v134, v135
    v_mfma_f32_32x32x16_bf16 v[88:103], a[172:175], v[28:31], v[88:103]
    v_add_f32 v144, 1.0, v144
    v_add_f32 v145, 1.0, v145
    v_add_f32 v146, 1.0, v146
    ds_read_b128 v[24:27], v2 offset:26624
    s_waitcnt lgkmcnt(4)
    v_mfma_f32_32x32x16_bf16 v[72:87], a[176:179], v[32:35], v[72:87]
    v_add_f32 v147, 1.0, v147
    v_add_f32 v148, 1.0, v148
    v_mfma_f32_32x32x16_bf16 v[88:103], a[180:183], v[32:35], v[88:103]
    v_add_f32 v149, 1.0, v149
    v_add_f32 v150, 1.0, v150
    v_add_f32 v151, 1.0, v151
    ds_read_b128 v[28:31], v2 offset:27648
    s_waitcnt lgkmcnt(4)
    v_mfma_f32_32x32x16_bf16 v[72:87], a[184:187], v[36:39], v[72:87]
    v_rcp_f32 v144, v144
    v_rcp_f32 v145, v145
    v_rcp_f32 v146, v146
    v_mfma_f32_32x32x16_bf16 v[88:103], a[188:191], v[36:39], v[88:103]
    v_rcp_f32 v147, v147
    v_rcp_f32 v148, v148
    v_rcp_f32 v149, v149
    ds_read_b128 v[32:35], v2 offset:28672
    s_waitcnt lgkmcnt(4)
    v_mfma_f32_32x32x16_bf16 v[72:87], a[192:195], v[16:19], v[72:87]
    v_rcp_f32 v150, v150
    v_rcp_f32 v151, v151
    v_lshlrev_b32 v152, 16, v160
    v_mfma_f32_32x32x16_bf16 v[88:103], a[196:199], v[16:19], v[88:103]
    v_and_b32 v153, s47, v160
    v_lshlrev_b32 v154, 16, v161
    ds_read_b128 v[36:39], v2 offset:29696
    s_waitcnt lgkmcnt(4)
    v_mfma_f32_32x32x16_bf16 v[72:87], a[200:203], v[20:23], v[72:87]
    v_and_b32 v155, s47, v161
    v_lshlrev_b32 v156, 16, v162
    v_and_b32 v157, s47, v162
    v_mfma_f32_32x32x16_bf16 v[88:103], a[204:207], v[20:23], v[88:103]
    v_lshlrev_b32 v158, 16, v163
    v_and_b32 v159, s47, v163
    v_mul_f32 v136, v136, v144
    ds_read_b128 v[16:19], v2 offset:30720
    s_waitcnt lgkmcnt(4)
    v_mfma_f32_32x32x16_bf16 v[72:87], a[208:211], v[24:27], v[72:87]
    v_mul_f32 v137, v137, v145
    v_mul_f32 v138, v138, v146
    v_mul_f32 v139, v139, v147
    v_mfma_f32_32x32x16_bf16 v[88:103], a[212:215], v[24:27], v[88:103]
    v_mul_f32 v140, v140, v148
    v_mul_f32 v141, v141, v149
    v_mul_f32 v142, v142, v150
    ds_read_b128 v[20:23], v2 offset:31744
    s_waitcnt lgkmcnt(4)
    v_mfma_f32_32x32x16_bf16 v[72:87], a[216:219], v[28:31], v[72:87]
    v_mul_f32 v143, v143, v151
    v_cvt_pk_bf16_f32 v160, v136, v137
    v_mfma_f32_32x32x16_bf16 v[88:103], a[220:223], v[28:31], v[88:103]
    v_cvt_pk_bf16_f32 v161, v138, v139
    v_cvt_pk_bf16_f32 v162, v140, v141
    v_cvt_pk_bf16_f32 v163, v142, v143
    ds_read_b128 v[24:27], v2 offset:32768
    s_waitcnt lgkmcnt(4)
    v_mfma_f32_32x32x16_bf16 v[72:87], a[224:227], v[32:35], v[72:87]
    v_lshlrev_b32 v136, 16, v160
    v_and_b32 v137, s47, v160
    v_lshlrev_b32 v138, 16, v161
    v_mfma_f32_32x32x16_bf16 v[88:103], a[228:231], v[32:35], v[88:103]
    v_and_b32 v139, s47, v161
    v_lshlrev_b32 v140, 16, v162
    v_and_b32 v141, s47, v162
    ds_read_b128 v[28:31], v2 offset:33792
    s_waitcnt lgkmcnt(4)
    v_mfma_f32_32x32x16_bf16 v[72:87], a[232:235], v[36:39], v[72:87]
    v_lshlrev_b32 v142, 16, v163
    v_and_b32 v143, s47, v163
    v_mul_f32 v136, v136, v152
    v_mfma_f32_32x32x16_bf16 v[88:103], a[236:239], v[36:39], v[88:103]
    v_mul_f32 v137, v137, v153
    v_mul_f32 v138, v138, v154
    ds_read_b128 v[32:35], v2 offset:34816
    s_waitcnt lgkmcnt(4)
    v_mfma_f32_32x32x16_bf16 v[72:87], a[240:243], v[16:19], v[72:87]
    v_mul_f32 v139, v139, v155
    v_mul_f32 v140, v140, v156
    v_mul_f32 v141, v141, v157
    v_mfma_f32_32x32x16_bf16 v[88:103], a[244:247], v[16:19], v[88:103]
    v_mul_f32 v142, v142, v158
    v_mul_f32 v143, v143, v159
    v_cvt_pk_bf16_f32 v168, v136, v137
    ds_read_b128 v[36:39], v2 offset:35840
    s_waitcnt lgkmcnt(4)
    v_mfma_f32_32x32x16_bf16 v[72:87], a[248:251], v[20:23], v[72:87]
    v_cvt_pk_bf16_f32 v169, v138, v139
    v_cvt_pk_bf16_f32 v170, v140, v141
    v_cvt_pk_bf16_f32 v171, v142, v143
    v_mfma_f32_32x32x16_bf16 v[88:103], a[252:255], v[20:23], v[88:103]
    buffer_store_dwordx4 v[168:171], v1, s[20:23], s45 offen offset:512 sc1
    s_add_u32 s45, s45, 2048
    s_waitcnt vmcnt(13)
    s_barrier
    ds_read_b128 v[16:19], v3 offset:0
    s_waitcnt lgkmcnt(4)
    v_mfma_f32_32x32x16_bf16 v[72:87], v[40:43], v[24:27], v[72:87]
    v_xor_b32 v2, 0x12000, v2
    s_cmp_le_u32 s55, s56
    s_cselect_b32 s59, 0, 1073741824
    v_add_u32 v4, s59, v5
    v_mfma_f32_32x32x16_bf16 v[88:103], v[44:47], v[24:27], v[88:103]
    s_add_u32 s52, s44, s57
    s_add_u32 m0, s52, 0
    s_add_u32 s49, s43, 0
    ds_read_b128 v[20:23], v3 offset:1024
    s_waitcnt lgkmcnt(4)
    v_mfma_f32_32x32x16_bf16 v[72:87], v[48:51], v[28:31], v[72:87]
    buffer_load_dwordx4 v4, s[16:19], s49 offen offset:0 sc1 lds
    buffer_load_dwordx4 v4, s[16:19], s49 offen offset:1024 sc1 lds
    buffer_load_dwordx4 v4, s[16:19], s49 offen offset:2048 sc1 lds
    buffer_load_dwordx4 v4, s[16:19], s49 offen offset:3072 sc1 lds
    v_mfma_f32_32x32x16_bf16 v[88:103], v[52:55], v[28:31], v[88:103]
    s_add_u32 m0, s52, 4096
    s_add_u32 s49, s43, 4096
    buffer_load_dwordx4 v4, s[16:19], s49 offen offset:0 sc1 lds
    ds_read_b128 v[24:27], v3 offset:2048
    s_waitcnt lgkmcnt(4)
    v_mfma_f32_32x32x16_bf16 v[72:87], v[56:59], v[32:35], v[72:87]
    buffer_load_dwordx4 v4, s[16:19], s49 offen offset:1024 sc1 lds
    buffer_load_dwordx4 v4, s[16:19], s49 offen offset:2048 sc1 lds
    buffer_load_dwordx4 v4, s[16:19], s49 offen offset:3072 sc1 lds
    v_mfma_f32_32x32x16_bf16 v[88:103], v[60:63], v[32:35], v[88:103]
    s_add_u32 m0, s52, 8192
    s_add_u32 s49, s43, 8192
    buffer_load_dwordx4 v4, s[16:19], s49 offen offset:0 sc1 lds
    s_cmp_le_u32 s55, 5
    ds_read_b128 v[28:31], v3 offset:3072
    s_waitcnt lgkmcnt(4)
    v_mfma_f32_32x32x16_bf16 v[72:87], v[64:67], v[36:39], v[72:87]
    s_cselect_b32 s59, s60, 1073741824
    v_add_u32 v13, s59, v14
    buffer_load_dwordx4 v[172:175], v13, s[24:27], 0 offen
    v_mfma_f32_32x32x16_bf16 v[88:103], v[68:71], v[36:39], v[88:103]
    s_add_u32 s60, s60, 4096
    s_xor_b32 s57, s57, 0x12000
    s_add_u32 s43, s43, 36864
    s_cmp_eq_u32 s55, s61
    s_cbranch_scc1 K34_F0
    s_add_u32 s55, s55, 1
    ds_read_b128 v[32:35], v3 offset:4096
    s_waitcnt lgkmcnt(4)
    v_mfma_f32_32x32x16_bf16 v[104:119], a[0:3], v[16:19], 0
    v_cvt_pk_bf16_f32 v160, v72, v73
    v_cvt_pk_bf16_f32 v161, v74, v75
    v_cvt_pk_bf16_f32 v162, v76, v77
    v_mfma_f32_32x32x16_bf16 v[120:135], a[4:7], v[16:19], 0
    v_cvt_pk_bf16_f32 v163, v78, v79
    v_lshlrev_b32 v136, 16, v160
    v_and_b32 v137, s47, v160
    ds_read_b128 v[36:39], v3 offset:5120
    s_waitcnt lgkmcnt(4)
    v_mfma_f32_32x32x16_bf16 v[104:119], a[8:11], v[20:23], v[104:119]
    v_lshlrev_b32 v138, 16, v161
    v_and_b32 v139, s47, v161
    v_lshlrev_b32 v140, 16, v162
    v_mfma_f32_32x32x16_bf16 v[120:135], a[12:15], v[20:23], v[120:135]
    v_and_b32 v141, s47, v162
    v_lshlrev_b32 v142, 16, v163
    v_and_b32 v143, s47, v163
    ds_read_b128 v[16:19], v3 offset:6144
    s_waitcnt lgkmcnt(4)
    v_mfma_f32_32x32x16_bf16 v[104:119], a[16:19], v[24:27], v[104:119]
    v_mul_f32 v144, s48, v136
    v_mul_f32 v145, s48, v137
    v_mul_f32 v146, s48, v138
    v_mfma_f32_32x32x16_bf16 v[120:135], a[20:23], v[24:27], v[120:135]
    v_mul_f32 v147, s48, v139
    v_mul_f32 v148, s48, v140
    ds_read_b128 v[20:23], v3 offset:7168
    s_waitcnt lgkmcnt(4)
    v_mfma_f32_32x32x16_bf16 v[104:119], a[24:27], v[28:31], v[104:119]
    v_mul_f32 v149, s48, v141
    v_mul_f32 v150, s48, v142
    v_mul_f32 v151, s48, v143
    v_mfma_f32_32x32x16_bf16 v[120:135], a[28:31], v[28:31], v[120:135]
    v_exp_f32 v144, v144
    v_exp_f32 v145, v145
    v_exp_f32 v146, v146
    ds_read_b128 v[24:27], v3 offset:8192
    s_waitcnt lgkmcnt(4)
    v_mfma_f32_32x32x16_bf16 v[104:119], a[32:35], v[32:35], v[104:119]
    v_exp_f32 v147, v147
    v_exp_f32 v148, v148
    v_exp_f32 v149, v149
    v_mfma_f32_32x32x16_bf16 v[120:135], a[36:39], v[32:35], v[120:135]
    v_exp_f32 v150, v150
    v_exp_f32 v151, v151
    v_cvt_pk_bf16_f32 v160, v88, v89
    ds_read_b128 v[28:31], v3 offset:9216
    s_waitcnt lgkmcnt(4)
    v_mfma_f32_32x32x16_bf16 v[104:119], a[40:43], v[36:39], v[104:119]
    v_cvt_pk_bf16_f32 v161, v90, v91
    v_cvt_pk_bf16_f32 v162, v92, v93
    v_mfma_f32_32x32x16_bf16 v[120:135], a[44:47], v[36:39], v[120:135]
    v_cvt_pk_bf16_f32 v163, v94, v95
    v_add_f32 v144, 1.0, v144
    v_add_f32 v145, 1.0, v145
    ds_read_b128 v[32:35], v3 offset:10240
    s_waitcnt lgkmcnt(4)
    v_mfma_f32_32x32x16_bf16 v[104:119], a[48:51], v[16:19], v[104:119]
    v_add_f32 v146, 1.0, v146
    v_add_f32 v147, 1.0, v147
    v_add_f32 v148, 1.0, v148
    v_mfma_f32_32x32x16_bf16 v[120:135], a[52:55], v[16:19], v[120:135]
    v_add_f32 v149, 1.0, v149
    v_add_f32 v150, 1.0, v150
    v_add_f32 v151, 1.0, v151
    ds_read_b128 v[36:39], v3 offset:11264
    s_waitcnt lgkmcnt(4)
    v_mfma_f32_32x32x16_bf16 v[104:119], a[56:59], v[20:23], v[104:119]
    v_rcp_f32 v144, v144
    v_rcp_f32 v145, v145
    v_rcp_f32 v146, v146
    v_mfma_f32_32x32x16_bf16 v[120:135], a[60:63], v[20:23], v[120:135]
    v_rcp_f32 v147, v147
    v_rcp_f32 v148, v148
    ds_read_b128 v[16:19], v3 offset:12288
    s_waitcnt lgkmcnt(4)
    v_mfma_f32_32x32x16_bf16 v[104:119], a[64:67], v[24:27], v[104:119]
    v_rcp_f32 v149, v149
    v_rcp_f32 v150, v150
    v_rcp_f32 v151, v151
    v_mfma_f32_32x32x16_bf16 v[120:135], a[68:71], v[24:27], v[120:135]
    v_lshlrev_b32 v152, 16, v160
    v_and_b32 v153, s47, v160
    v_lshlrev_b32 v154, 16, v161
    ds_read_b128 v[20:23], v3 offset:13312
    s_waitcnt lgkmcnt(4)
    v_mfma_f32_32x32x16_bf16 v[104:119], a[72:75], v[28:31], v[104:119]
    v_and_b32 v155, s47, v161
    v_lshlrev_b32 v156, 16, v162
    v_and_b32 v157, s47, v162
    v_mfma_f32_32x32x16_bf16 v[120:135], a[76:79], v[28:31], v[120:135]
    v_lshlrev_b32 v158, 16, v163
    v_and_b32 v159, s47, v163
    v_mul_f32 v136, v136, v144
    ds_read_b128 v[24:27], v3 offset:14336
    s_waitcnt lgkmcnt(4)
    v_mfma_f32_32x32x16_bf16 v[104:119], a[80:83], v[32:35], v[104:119]
    v_mul_f32 v137, v137, v145
    v_mul_f32 v138, v138, v146
    v_mul_f32 v139, v139, v147
    v_mfma_f32_32x32x16_bf16 v[120:135], a[84:87], v[32:35], v[120:135]
    v_mul_f32 v140, v140, v148
    v_mul_f32 v141, v141, v149
    ds_read_b128 v[28:31], v3 offset:15360
    s_waitcnt lgkmcnt(4)
    v_mfma_f32_32x32x16_bf16 v[104:119], a[88:91], v[36:39], v[104:119]
    v_mul_f32 v142, v142, v150
    v_mul_f32 v143, v143, v151
    v_cvt_pk_bf16_f32 v160, v136, v137
    v_mfma_f32_32x32x16_bf16 v[120:135], a[92:95], v[36:39], v[120:135]
    v_cvt_pk_bf16_f32 v161, v138, v139
    v_cvt_pk_bf16_f32 v162, v140, v141
    v_cvt_pk_bf16_f32 v163, v142, v143
    ds_read_b128 v[32:35], v3 offset:16384
    s_waitcnt lgkmcnt(4)
    v_mfma_f32_32x32x16_bf16 v[104:119], a[96:99], v[16:19], v[104:119]
    v_lshlrev_b32 v136, 16, v160
    v_and_b32 v137, s47, v160
    v_lshlrev_b32 v138, 16, v161
    v_mfma_f32_32x32x16_bf16 v[120:135], a[100:103], v[16:19], v[120:135]
    v_and_b32 v139, s47, v161
    v_lshlrev_b32 v140, 16, v162
    v_and_b32 v141, s47, v162
    ds_read_b128 v[36:39], v3 offset:17408
    s_waitcnt lgkmcnt(4)
    v_mfma_f32_32x32x16_bf16 v[104:119], a[104:107], v[20:23], v[104:119]
    v_lshlrev_b32 v142, 16, v163
    v_and_b32 v143, s47, v163
    v_mfma_f32_32x32x16_bf16 v[120:135], a[108:111], v[20:23], v[120:135]
    v_mul_f32 v136, v136, v152
    v_mul_f32 v137, v137, v153
    v_mul_f32 v138, v138, v154
    ds_read_b128 v[16:19], v3 offset:18432
    s_waitcnt lgkmcnt(4)
    v_mfma_f32_32x32x16_bf16 v[104:119], a[112:115], v[24:27], v[104:119]
    v_mul_f32 v139, v139, v155
    v_mul_f32 v140, v140, v156
    v_mul_f32 v141, v141, v157
    v_mfma_f32_32x32x16_bf16 v[120:135], a[116:119], v[24:27], v[120:135]
    v_mul_f32 v142, v142, v158
    v_mul_f32 v143, v143, v159
    v_cvt_pk_bf16_f32 v164, v136, v137
    ds_read_b128 v[20:23], v3 offset:19456
    s_waitcnt lgkmcnt(4)
    v_mfma_f32_32x32x16_bf16 v[104:119], a[120:123], v[28:31], v[104:119]
    v_cvt_pk_bf16_f32 v165, v138, v139
    v_cvt_pk_bf16_f32 v166, v140, v141
    v_cvt_pk_bf16_f32 v167, v142, v143
    v_mfma_f32_32x32x16_bf16 v[120:135], a[124:127], v[28:31], v[120:135]
    buffer_store_dwordx4 v[164:167], v10, s[20:23], s45 offen offset:0 sc1
    v_cvt_pk_bf16_f32 v160, v80, v81
    ds_read_b128 v[24:27], v3 offset:20480
    s_waitcnt lgkmcnt(4)
    v_mfma_f32_32x32x16_bf16 v[104:119], a[128:131], v[32:35], v[104:119]
    v_cvt_pk_bf16_f32 v161, v82, v83
    v_cvt_pk_bf16_f32 v162, v84, v85
    v_cvt_pk_bf16_f32 v163, v86, v87
    v_mfma_f32_32x32x16_bf16 v[120:135], a[132:135], v[32:35], v[120:135]
    v_lshlrev_b32 v136, 16, v160
    v_and_b32 v137, s47, v160
    v_lshlrev_b32 v138, 16, v161
    ds_read_b128 v[28:31], v3 offset:21504
    s_waitcnt lgkmcnt(4)
    v_mfma_f32_32x32x16_bf16 v[104:119], a[136:139], v[36:39], v[104:119]
    v_and_b32 v139, s47, v161
    v_lshlrev_b32 v140, 16, v162
    v_and_b32 v141, s47, v162
    v_mfma_f32_32x32x16_bf16 v[120:135], a[140:143], v[36:39], v[120:135]
    v_lshlrev_b32 v142, 16, v163
    v_and_b32 v143, s47, v163
    v_mul_f32 v144, s48, v136
    ds_read_b128 v[32:35], v3 offset:22528
    s_waitcnt lgkmcnt(4)
    v_mfma_f32_32x32x16_bf16 v[104:119], a[144:147], v[16:19], v[104:119]
    v_mul_f32 v145, s48, v137
    v_mul_f32 v146, s48, v138
    v_mul_f32 v147, s48, v139
    v_mfma_f32_32x32x16_bf16 v[120:135], a[148:151], v[16:19], v[120:135]
    v_mul_f32 v148, s48, v140
    v_mul_f32 v149, s48, v141
    ds_read_b128 v[36:39], v3 offset:23552
    s_waitcnt lgkmcnt(4)
    v_mfma_f32_32x32x16_bf16 v[104:119], a[152:155], v[20:23], v[104:119]
    v_mul_f32 v150, s48, v142
    v_mul_f32 v151, s48, v143
    v_exp_f32 v144, v144
    v_mfma_f32_32x32x16_bf16 v[120:135], a[156:159], v[20:23], v[120:135]
    v_exp_f32 v145, v145
    v_exp_f32 v146, v146
    v_exp_f32 v147, v147
    ds_read_b128 v[16:19], v3 offset:24576
    s_waitcnt lgkmcnt(4)
    v_mfma_f32_32x32x16_bf16 v[104:119], a[160:163], v[24:27], v[104:119]
    v_exp_f32 v148, v148
    v_exp_f32 v149, v149
    v_exp_f32 v150, v150
    v_mfma_f32_32x32x16_bf16 v[120:135], a[164:167], v[24:27], v[120:135]
    v_exp_f32 v151, v151
    v_cvt_pk_bf16_f32 v160, v96, v97
    v_cvt_pk_bf16_f32 v161, v98, v99
    ds_read_b128 v[20:23], v3 offset:25600
    s_waitcnt lgkmcnt(4)
    v_mfma_f32_32x32x16_bf16 v[104:119], a[168:171], v[28:31], v[104:119]
    v_cvt_pk_bf16_f32 v162, v100, v101
    v_cvt_pk_bf16_f32 v163, v102, v103
    v_mfma_f32_32x32x16_bf16 v[120:135], a[172:175], v[28:31], v[120:135]
    v_add_f32 v144, 1.0, v144
    v_add_f32 v145, 1.0, v145
    v_add_f32 v146, 1.0, v146
    ds_read_b128 v[24:27], v3 offset:26624
    s_waitcnt lgkmcnt(4)
    v_mfma_f32_32x32x16_bf16 v[104:119], a[176:179], v[32:35], v[104:119]
    v_add_f32 v147, 1.0, v147
    v_add_f32 v148, 1.0, v148
    v_add_f32 v149, 1.0, v149
    v_mfma_f32_32x32x16_bf16 v[120:135], a[180:183], v[32:35], v[120:135]
    v_add_f32 v150, 1.0, v150
    v_add_f32 v151, 1.0, v151
    v_rcp_f32 v144, v144
    ds_read_b128 v[28:31], v3 offset:27648
    s_waitcnt lgkmcnt(4)
    v_mfma_f32_32x32x16_bf16 v[104:119], a[184:187], v[36:39], v[104:119]
    v_rcp_f32 v145, v145
    v_rcp_f32 v146, v146
    v_rcp_f32 v147, v147
    v_mfma_f32_32x32x16_bf16 v[120:135], a[188:191], v[36:39], v[120:135]
    v_rcp_f32 v148, v148
    v_rcp_f32 v149, v149
    ds_read_b128 v[32:35], v3 offset:28672
    s_waitcnt lgkmcnt(4)
    v_mfma_f32_32x32x16_bf16 v[104:119], a[192:195], v[16:19], v[104:119]
    v_rcp_f32 v150, v150
    v_rcp_f32 v151, v151
    v_lshlrev_b32 v152, 16, v160
    v_mfma_f32_32x32x16_bf16 v[120:135], a[196:199], v[16:19], v[120:135]
    v_and_b32 v153, s47, v160
    v_lshlrev_b32 v154, 16, v161
    v_and_b32 v155, s47, v161
    ds_read_b128 v[36:39], v3 offset:29696
    s_waitcnt lgkmcnt(4)
    v_mfma_f32_32x32x16_bf16 v[104:119], a[200:203], v[20:23], v[104:119]
    v_lshlrev_b32 v156, 16, v162
    v_and_b32 v157, s47, v162
    v_lshlrev_b32 v158, 16, v163
    v_mfma_f32_32x32x16_bf16 v[120:135], a[204:207], v[20:23], v[120:135]
    v_and_b32 v159, s47, v163
    v_mul_f32 v136, v136, v144
    v_mul_f32 v137, v137, v145
    ds_read_b128 v[16:19], v3 offset:30720
    s_waitcnt lgkmcnt(4)
    v_mfma_f32_32x32x16_bf16 v[104:119], a[208:211], v[24:27], v[104:119]
    v_mul_f32 v138, v138, v146
    v_mul_f32 v139, v139, v147
    v_mul_f32 v140, v140, v148
    v_mfma_f32_32x32x16_bf16 v[120:135], a[212:215], v[24:27], v[120:135]
    v_mul_f32 v141, v141, v149
    v_mul_f32 v142, v142, v150
    ds_read_b128 v[20:23], v3 offset:31744
    s_waitcnt lgkmcnt(4)
    v_mfma_f32_32x32x16_bf16 v[104:119], a[216:219], v[28:31], v[104:119]
    v_mul_f32 v143, v143, v151
    v_cvt_pk_bf16_f32 v160, v136, v137
    v_cvt_pk_bf16_f32 v161, v138, v139
    v_mfma_f32_32x32x16_bf16 v[120:135], a[220:223], v[28:31], v[120:135]
    v_cvt_pk_bf16_f32 v162, v140, v141
    v_cvt_pk_bf16_f32 v163, v142, v143
    v_lshlrev_b32 v136, 16, v160
    ds_read_b128 v[24:27], v3 offset:32768
    s_waitcnt lgkmcnt(4)
    v_mfma_f32_32x32x16_bf16 v[104:119], a[224:227], v[32:35], v[104:119]
    v_and_b32 v137, s47, v160
    v_lshlrev_b32 v138, 16, v161
    v_and_b32 v139, s47, v161
    v_mfma_f32_32x32x16_bf16 v[120:135], a[228:231], v[32:35], v[120:135]
    v_lshlrev_b32 v140, 16, v162
    v_and_b32 v141, s47, v162
    v_lshlrev_b32 v142, 16, v163
    ds_read_b128 v[28:31], v3 offset:33792
    s_waitcnt lgkmcnt(4)
    v_mfma_f32_32x32x16_bf16 v[104:119], a[232:235], v[36:39], v[104:119]
    v_and_b32 v143, s47, v163
    v_mul_f32 v136, v136, v152
    v_mfma_f32_32x32x16_bf16 v[120:135], a[236:239], v[36:39], v[120:135]
    v_mul_f32 v137, v137, v153
    v_mul_f32 v138, v138, v154
    v_mul_f32 v139, v139, v155
    ds_read_b128 v[32:35], v3 offset:34816
    s_waitcnt lgkmcnt(4)
    v_mfma_f32_32x32x16_bf16 v[104:119], a[240:243], v[16:19], v[104:119]
    v_mul_f32 v140, v140, v156
    v_mul_f32 v141, v141, v157
    v_mul_f32 v142, v142, v158
    v_mfma_f32_32x32x16_bf16 v[120:135], a[244:247], v[16:19], v[120:135]
    v_mul_f32 v143, v143, v159
    v_cvt_pk_bf16_f32 v168, v136, v137
    v_cvt_pk_bf16_f32 v169, v138, v139
    ds_read_b128 v[36:39], v3 offset:35840
    s_waitcnt lgkmcnt(4)
    v_mfma_f32_32x32x16_bf16 v[104:119], a[248:251], v[20:23], v[104:119]
    v_cvt_pk_bf16_f32 v170, v140, v141
    v_cvt_pk_bf16_f32 v171, v142, v143
    buffer_store_dwordx4 v[168:171], v10, s[20:23], s45 offen offset:512 sc1
    v_mfma_f32_32x32x16_bf16 v[120:135], a[252:255], v[20:23], v[120:135]
    s_add_u32 s45, s45, 2048
    v_mov_b32 v1, v10
    s_waitcnt vmcnt(13)
    s_barrier
    ds_read_b128 v[16:19], v2 offset:0
    s_waitcnt lgkmcnt(4)
    v_mfma_f32_32x32x16_bf16 v[104:119], v[40:43], v[24:27], v[104:119]
    v_xor_b32 v3, 0x12000, v3
    s_cmp_le_u32 s55, s56
    s_cselect_b32 s59, 0, 1073741824
    v_add_u32 v4, s59, v5
    v_mfma_f32_32x32x16_bf16 v[120:135], v[44:47], v[24:27], v[120:135]
    s_add_u32 s52, s44, s58
    s_add_u32 m0, s52, 0
    s_add_u32 s49, s43, 0
    ds_read_b128 v[20:23], v2 offset:1024
    s_waitcnt lgkmcnt(4)
    v_mfma_f32_32x32x16_bf16 v[104:119], v[48:51], v[28:31], v[104:119]
    buffer_load_dwordx4 v4, s[16:19], s49 offen offset:0 sc1 lds
    buffer_load_dwordx4 v4, s[16:19], s49 offen offset:1024 sc1 lds
    buffer_load_dwordx4 v4, s[16:19], s49 offen offset:2048 sc1 lds
    buffer_load_dwordx4 v4, s[16:19], s49 offen offset:3072 sc1 lds
    v_mfma_f32_32x32x16_bf16 v[120:135], v[52:55], v[28:31], v[120:135]
    s_add_u32 m0, s52, 4096
    s_add_u32 s49, s43, 4096
    buffer_load_dwordx4 v4, s[16:19], s49 offen offset:0 sc1 lds
    ds_read_b128 v[24:27], v2 offset:2048
    s_waitcnt lgkmcnt(4)
    v_mfma_f32_32x32x16_bf16 v[104:119], v[56:59], v[32:35], v[104:119]
    buffer_load_dwordx4 v4, s[16:19], s49 offen offset:1024 sc1 lds
    buffer_load_dwordx4 v4, s[16:19], s49 offen offset:2048 sc1 lds
    buffer_load_dwordx4 v4, s[16:19], s49 offen offset:3072 sc1 lds
    v_mfma_f32_32x32x16_bf16 v[120:135], v[60:63], v[32:35], v[120:135]
    s_add_u32 m0, s52, 8192
    s_add_u32 s49, s43, 8192
    buffer_load_dwordx4 v4, s[16:19], s49 offen offset:0 sc1 lds
    s_cmp_le_u32 s55, 5
    ds_read_b128 v[28:31], v2 offset:3072
    s_waitcnt lgkmcnt(4)
    v_mfma_f32_32x32x16_bf16 v[104:119], v[64:67], v[36:39], v[104:119]
    s_cselect_b32 s59, s60, 1073741824
    v_add_u32 v13, s59, v14
    buffer_load_dwordx4 v[172:175], v13, s[24:27], 0 offen
    v_mfma_f32_32x32x16_bf16 v[120:135], v[68:71], v[36:39], v[120:135]
    s_add_u32 s60, s60, 4096
    s_xor_b32 s58, s58, 0x12000
    s_add_u32 s43, s43, 36864
    s_add_u32 s55, s55, 1
    s_cmp_lt_u32 s55, 10
    s_cbranch_scc1 K34_LOOP
    s_nop 1
    v_cvt_pk_bf16_f32 v160, v104, v105
    v_cvt_pk_bf16_f32 v161, v106, v107
    v_cvt_pk_bf16_f32 v162, v108, v109
    v_cvt_pk_bf16_f32 v163, v110, v111
    v_lshlrev_b32 v136, 16, v160
    v_and_b32 v137, s47, v160
    v_lshlrev_b32 v138, 16, v161
    v_and_b32 v139, s47, v161
    v_lshlrev_b32 v140, 16, v162
    v_and_b32 v141, s47, v162
    v_lshlrev_b32 v142, 16, v163
    v_and_b32 v143, s47, v163
    v_mul_f32 v144, s48, v136
    v_mul_f32 v145, s48, v137
    v_mul_f32 v146, s48, v138
    v_mul_f32 v147, s48, v139
    v_mul_f32 v148, s48, v140
    v_mul_f32 v149, s48, v141
    v_mul_f32 v150, s48, v142
    v_mul_f32 v151, s48, v143
    v_exp_f32 v144, v144
    v_exp_f32 v145, v145
    v_exp_f32 v146, v146
    v_exp_f32 v147, v147
    v_exp_f32 v148, v148
    v_exp_f32 v149, v149
    v_exp_f32 v150, v150
    v_exp_f32 v151, v151
    v_cvt_pk_bf16_f32 v160, v120, v121
    v_cvt_pk_bf16_f32 v161, v122, v123
    v_cvt_pk_bf16_f32 v162, v124, v125
    v_cvt_pk_bf16_f32 v163, v126, v127
    v_add_f32 v144, 1.0, v144
    v_add_f32 v145, 1.0, v145
    v_add_f32 v146, 1.0, v146
    v_add_f32 v147, 1.0, v147
    v_add_f32 v148, 1.0, v148
    v_add_f32 v149, 1.0, v149
    v_add_f32 v150, 1.0, v150
    v_add_f32 v151, 1.0, v151
    v_rcp_f32 v144, v144
    v_rcp_f32 v145, v145
    v_rcp_f32 v146, v146
    v_rcp_f32 v147, v147
    v_rcp_f32 v148, v148
    v_rcp_f32 v149, v149
    v_rcp_f32 v150, v150
    v_rcp_f32 v151, v151
    v_lshlrev_b32 v152, 16, v160
    v_and_b32 v153, s47, v160
    v_lshlrev_b32 v154, 16, v161
    v_and_b32 v155, s47, v161
    v_lshlrev_b32 v156, 16, v162
    v_and_b32 v157, s47, v162
    v_lshlrev_b32 v158, 16, v163
    v_and_b32 v159, s47, v163
    v_mul_f32 v136, v136, v144
    v_mul_f32 v137, v137, v145
    v_mul_f32 v138, v138, v146
    v_mul_f32 v139, v139, v147
    v_mul_f32 v140, v140, v148
    v_mul_f32 v141, v141, v149
    v_mul_f32 v142, v142, v150
    v_mul_f32 v143, v143, v151
    v_cvt_pk_bf16_f32 v160, v136, v137
    v_cvt_pk_bf16_f32 v161, v138, v139
    v_cvt_pk_bf16_f32 v162, v140, v141
    v_cvt_pk_bf16_f32 v163, v142, v143
    v_lshlrev_b32 v136, 16, v160
    v_and_b32 v137, s47, v160
    v_lshlrev_b32 v138, 16, v161
    v_and_b32 v139, s47, v161
    v_lshlrev_b32 v140, 16, v162
    v_and_b32 v141, s47, v162
    v_lshlrev_b32 v142, 16, v163
    v_and_b32 v143, s47, v163
    v_mul_f32 v136, v136, v152
    v_mul_f32 v137, v137, v153
    v_mul_f32 v138, v138, v154
    v_mul_f32 v139, v139, v155
    v_mul_f32 v140, v140, v156
    v_mul_f32 v141, v141, v157
    v_mul_f32 v142, v142, v158
    v_mul_f32 v143, v143, v159
    v_cvt_pk_bf16_f32 v164, v136, v137
    v_cvt_pk_bf16_f32 v165, v138, v139
    v_cvt_pk_bf16_f32 v166, v140, v141
    v_cvt_pk_bf16_f32 v167, v142, v143
    buffer_store_dwordx4 v[164:167], v10, s[20:23], s45 offen offset:0 sc1
    v_cvt_pk_bf16_f32 v160, v112, v113
    v_cvt_pk_bf16_f32 v161, v114, v115
    v_cvt_pk_bf16_f32 v162, v116, v117
    v_cvt_pk_bf16_f32 v163, v118, v119
    v_lshlrev_b32 v136, 16, v160
    v_and_b32 v137, s47, v160
    v_lshlrev_b32 v138, 16, v161
    v_and_b32 v139, s47, v161
    v_lshlrev_b32 v140, 16, v162
    v_and_b32 v141, s47, v162
    v_lshlrev_b32 v142, 16, v163
    v_and_b32 v143, s47, v163
    v_mul_f32 v144, s48, v136
    v_mul_f32 v145, s48, v137
    v_mul_f32 v146, s48, v138
    v_mul_f32 v147, s48, v139
    v_mul_f32 v148, s48, v140
    v_mul_f32 v149, s48, v141
    v_mul_f32 v150, s48, v142
    v_mul_f32 v151, s48, v143
    v_exp_f32 v144, v144
    v_exp_f32 v145, v145
    v_exp_f32 v146, v146
    v_exp_f32 v147, v147
    v_exp_f32 v148, v148
    v_exp_f32 v149, v149
    v_exp_f32 v150, v150
    v_exp_f32 v151, v151
    v_cvt_pk_bf16_f32 v160, v128, v129
    v_cvt_pk_bf16_f32 v161, v130, v131
    v_cvt_pk_bf16_f32 v162, v132, v133
    v_cvt_pk_bf16_f32 v163, v134, v135
    v_add_f32 v144, 1.0, v144
    v_add_f32 v145, 1.0, v145
    v_add_f32 v146, 1.0, v146
    v_add_f32 v147, 1.0, v147
    v_add_f32 v148, 1.0, v148
    v_add_f32 v149, 1.0, v149
    v_add_f32 v150, 1.0, v150
    v_add_f32 v151, 1.0, v151
    v_rcp_f32 v144, v144
    v_rcp_f32 v145, v145
    v_rcp_f32 v146, v146
    v_rcp_f32 v147, v147
    v_rcp_f32 v148, v148
    v_rcp_f32 v149, v149
    v_rcp_f32 v150, v150
    v_rcp_f32 v151, v151
    v_lshlrev_b32 v152, 16, v160
    v_and_b32 v153, s47, v160
    v_lshlrev_b32 v154, 16, v161
    v_and_b32 v155, s47, v161
    v_lshlrev_b32 v156, 16, v162
    v_and_b32 v157, s47, v162
    v_lshlrev_b32 v158, 16, v163
    v_and_b32 v159, s47, v163
    v_mul_f32 v136, v136, v144
    v_mul_f32 v137, v137, v145
    v_mul_f32 v138, v138, v146
    v_mul_f32 v139, v139, v147
    v_mul_f32 v140, v140, v148
    v_mul_f32 v141, v141, v149
    v_mul_f32 v142, v142, v150
    v_mul_f32 v143, v143, v151
    v_cvt_pk_bf16_f32 v160, v136, v137
    v_cvt_pk_bf16_f32 v161, v138, v139
    v_cvt_pk_bf16_f32 v162, v140, v141
    v_cvt_pk_bf16_f32 v163, v142, v143
    v_lshlrev_b32 v136, 16, v160
    v_and_b32 v137, s47, v160
    v_lshlrev_b32 v138, 16, v161
    v_and_b32 v139, s47, v161
    v_lshlrev_b32 v140, 16, v162
    v_and_b32 v141, s47, v162
    v_lshlrev_b32 v142, 16, v163
    v_and_b32 v143, s47, v163
    v_mul_f32 v136, v136, v152
    v_mul_f32 v137, v137, v153
    v_mul_f32 v138, v138, v154
    v_mul_f32 v139, v139, v155
    v_mul_f32 v140, v140, v156
    v_mul_f32 v141, v141, v157
    v_mul_f32 v142, v142, v158
    v_mul_f32 v143, v143, v159
    v_cvt_pk_bf16_f32 v168, v136, v137
    v_cvt_pk_bf16_f32 v169, v138, v139
    v_cvt_pk_bf16_f32 v170, v140, v141
    v_cvt_pk_bf16_f32 v171, v142, v143
    buffer_store_dwordx4 v[168:171], v10, s[20:23], s45 offen offset:512 sc1
    s_nop 1
    s_branch K345_J
K34_F0:
    s_nop 11
    v_cvt_pk_bf16_f32 v160, v72, v73
    v_cvt_pk_bf16_f32 v161, v74, v75
    v_cvt_pk_bf16_f32 v162, v76, v77
    v_cvt_pk_bf16_f32 v163, v78, v79
    v_lshlrev_b32 v136, 16, v160
    v_and_b32 v137, s47, v160
    v_lshlrev_b32 v138, 16, v161
    v_and_b32 v139, s47, v161
    v_lshlrev_b32 v140, 16, v162
    v_and_b32 v141, s47, v162
    v_lshlrev_b32 v142, 16, v163
    v_and_b32 v143, s47, v163
    v_mul_f32 v144, s48, v136
    v_mul_f32 v145, s48, v137
    v_mul_f32 v146, s48, v138
    v_mul_f32 v147, s48, v139
    v_mul_f32 v148, s48, v140
    v_mul_f32 v149, s48, v141
    v_mul_f32 v150, s48, v142
    v_mul_f32 v151, s48, v143
    v_exp_f32 v144, v144
    v_exp_f32 v145, v145
    v_exp_f32 v146, v146
    v_exp_f32 v147, v147
    v_exp_f32 v148, v148
    v_exp_f32 v149, v149
    v_exp_f32 v150, v150
    v_exp_f32 v151, v151
    v_cvt_pk_bf16_f32 v160, v88, v89
    v_cvt_pk_bf16_f32 v161, v90, v91
    v_cvt_pk_bf16_f32 v162, v92, v93
    v_cvt_pk_bf16_f32 v163, v94, v95
    v_add_f32 v144, 1.0, v144
    v_add_f32 v145, 1.0, v145
    v_add_f32 v146, 1.0, v146
    v_add_f32 v147, 1.0, v147
    v_add_f32 v148, 1.0, v148
    v_add_f32 v149, 1.0, v149
    v_add_f32 v150, 1.0, v150
    v_add_f32 v151, 1.0, v151
    v_rcp_f32 v144, v144
    v_rcp_f32 v145, v145
    v_rcp_f32 v146, v146
    v_rcp_f32 v147, v147
    v_rcp_f32 v148, v148
    v_rcp_f32 v149, v149
    v_rcp_f32 v150, v150
    v_rcp_f32 v151, v151
    v_lshlrev_b32 v152, 16, v160
    v_and_b32 v153, s47, v160
    v_lshlrev_b32 v154, 16, v161
    v_and_b32 v155, s47, v161
    v_lshlrev_b32 v156, 16, v162
    v_and_b32 v157, s47, v162
    v_lshlrev_b32 v158, 16, v163
    v_and_b32 v159, s47, v163
    v_mul_f32 v136, v136, v144
    v_mul_f32 v137, v137, v145
    v_mul_f32 v138, v138, v146
    v_mul_f32 v139, v139, v147
    v_mul_f32 v140, v140, v148
    v_mul_f32 v141, v141, v149
    v_mul_f32 v142, v142, v150
    v_mul_f32 v143, v143, v151
    v_cvt_pk_bf16_f32 v160, v136, v137
    v_cvt_pk_bf16_f32 v161, v138, v139
    v_cvt_pk_bf16_f32 v162, v140, v141
    v_cvt_pk_bf16_f32 v163, v142, v143
    v_lshlrev_b32 v136, 16, v160
    v_and_b32 v137, s47, v160
    v_lshlrev_b32 v138, 16, v161
    v_and_b32 v139, s47, v161
    v_lshlrev_b32 v140, 16, v162
    v_and_b32 v141, s47, v162
    v_lshlrev_b32 v142, 16, v163
    v_and_b32 v143, s47, v163
    v_mul_f32 v136, v136, v152
    v_mul_f32 v137, v137, v153
    v_mul_f32 v138, v138, v154
    v_mul_f32 v139, v139, v155
    v_mul_f32 v140, v140, v156
    v_mul_f32 v141, v141, v157
    v_mul_f32 v142, v142, v158
    v_mul_f32 v143, v143, v159
    v_cvt_pk_bf16_f32 v164, v136, v137
    v_cvt_pk_bf16_f32 v165, v138, v139
    v_cvt_pk_bf16_f32 v166, v140, v141
    v_cvt_pk_bf16_f32 v167, v142, v143
    buffer_store_dwordx4 v[164:167], v10, s[20:23], s45 offen offset:0 sc1
    v_cvt_pk_bf16_f32 v160, v80, v81
    v_cvt_pk_bf16_f32 v161, v82, v83
    v_cvt_pk_bf16_f32 v162, v84, v85
    v_cvt_pk_bf16_f32 v163, v86, v87
    v_lshlrev_b32 v136, 16, v160
    v_and_b32 v137, s47, v160
    v_lshlrev_b32 v138, 16, v161
    v_and_b32 v139, s47, v161
    v_lshlrev_b32 v140, 16, v162
    v_and_b32 v141, s47, v162
    v_lshlrev_b32 v142, 16, v163
    v_and_b32 v143, s47, v163
    v_mul_f32 v144, s48, v136
    v_mul_f32 v145, s48, v137
    v_mul_f32 v146, s48, v138
    v_mul_f32 v147, s48, v139
    v_mul_f32 v148, s48, v140
    v_mul_f32 v149, s48, v141
    v_mul_f32 v150, s48, v142
    v_mul_f32 v151, s48, v143
    v_exp_f32 v144, v144
    v_exp_f32 v145, v145
    v_exp_f32 v146, v146
    v_exp_f32 v147, v147
    v_exp_f32 v148, v148
    v_exp_f32 v149, v149
    v_exp_f32 v150, v150
    v_exp_f32 v151, v151
    v_cvt_pk_bf16_f32 v160, v96, v97
    v_cvt_pk_bf16_f32 v161, v98, v99
    v_cvt_pk_bf16_f32 v162, v100, v101
    v_cvt_pk_bf16_f32 v163, v102, v103
    v_add_f32 v144, 1.0, v144
    v_add_f32 v145, 1.0, v145
    v_add_f32 v146, 1.0, v146
    v_add_f32 v147, 1.0, v147
    v_add_f32 v148, 1.0, v148
    v_add_f32 v149, 1.0, v149
    v_add_f32 v150, 1.0, v150
    v_add_f32 v151, 1.0, v151
    v_rcp_f32 v144, v144
    v_rcp_f32 v145, v145
    v_rcp_f32 v146, v146
    v_rcp_f32 v147, v147
    v_rcp_f32 v148, v148
    v_rcp_f32 v149, v149
    v_rcp_f32 v150, v150
    v_rcp_f32 v151, v151
    v_lshlrev_b32 v152, 16, v160
    v_and_b32 v153, s47, v160
    v_lshlrev_b32 v154, 16, v161
    v_and_b32 v155, s47, v161
    v_lshlrev_b32 v156, 16, v162
    v_and_b32 v157, s47, v162
    v_lshlrev_b32 v158, 16, v163
    v_and_b32 v159, s47, v163
    v_mul_f32 v136, v136, v144
    v_mul_f32 v137, v137, v145
    v_mul_f32 v138, v138, v146
    v_mul_f32 v139, v139, v147
    v_mul_f32 v140, v140, v148
    v_mul_f32 v141, v141, v149
    v_mul_f32 v142, v142, v150
    v_mul_f32 v143, v143, v151
    v_cvt_pk_bf16_f32 v160, v136, v137
    v_cvt_pk_bf16_f32 v161, v138, v139
    v_cvt_pk_bf16_f32 v162, v140, v141
    v_cvt_pk_bf16_f32 v163, v142, v143
    v_lshlrev_b32 v136, 16, v160
    v_and_b32 v137, s47, v160
    v_lshlrev_b32 v138, 16, v161
    v_and_b32 v139, s47, v161
    v_lshlrev_b32 v140, 16, v162
    v_and_b32 v141, s47, v162
    v_lshlrev_b32 v142, 16, v163
    v_and_b32 v143, s47, v163
    v_mul_f32 v136, v136, v152
    v_mul_f32 v137, v137, v153
    v_mul_f32 v138, v138, v154
    v_mul_f32 v139, v139, v155
    v_mul_f32 v140, v140, v156
    v_mul_f32 v141, v141, v157
    v_mul_f32 v142, v142, v158
    v_mul_f32 v143, v143, v159
    v_cvt_pk_bf16_f32 v168, v136, v137
    v_cvt_pk_bf16_f32 v169, v138, v139
    v_cvt_pk_bf16_f32 v170, v140, v141
    v_cvt_pk_bf16_f32 v171, v142, v143
    buffer_store_dwordx4 v[168:171], v10, s[20:23], s45 offen offset:512 sc1
    s_nop 1
K345_J:
    s_mul_i32 s74, s36, 7282
    s_lshr_b32 s74, s74, 16
    s_lshl_b32 s74, s74, 3
    s_add_u32 s74, s74, s37
    s_lshl_b32 s74, s74, 7
    s_branch K345_K5
K4_END:
    s_endpgm
K34_HEND:
    s_mov_b32 s74, 0x7ffffff0
K345_K5:
    v_mov_b32 v0, v15
    s_load_dwordx2 s[4:5], s[0:1], 96
    s_load_dwordx2 s[12:13], s[0:1], 136
    s_load_dwordx2 s[8:9], s[0:1], 120
    v_mov_b32 v15, v0
    v_readfirstlane_b32 s39, v0
    s_lshr_b32 s39, s39, 6
    v_and_b32 v0, 63, v0
    v_lshlrev_b32 v1, 4, v0
    s_mul_i32 s40, s39, 144
    s_add_u32 s41, s40, 0
    v_add_u32 v10, s41, v0
    v_mul_u32_u24 v11, 3641, v10
    v_lshrrev_b32 v11, 16, v11
    v_mul_u32_u24 v12, 18, v11
    v_sub_u32 v12, v10, v12
    v_mul_u32_u24 v2, 1152, v11
    v_lshl_add_u32 v2, v12, 4, v2
    s_add_u32 s41, s40, 48
    v_add_u32 v10, s41, v0
    v_mul_u32_u24 v11, 3641, v10
    v_lshrrev_b32 v11, 16, v11
    v_mul_u32_u24 v12, 18, v11
    v_sub_u32 v12, v10, v12
    v_mul_u32_u24 v3, 1152, v11
    v_lshl_add_u32 v3, v12, 4, v3
    s_add_u32 s41, s40, 96
    v_add_u32 v10, s41, v0
    v_mul_u32_u24 v11, 3641, v10
    v_lshrrev_b32 v11, 16, v11
    v_mul_u32_u24 v12, 18, v11
    v_sub_u32 v12, v10, v12
    v_mul_u32_u24 v4, 1152, v11
    v_lshl_add_u32 v4, v12, 4, v4
    v_lshrrev_b32 v10, 5, v0
    v_lshlrev_b32 v10, 4, v10
    v_bfe_u32 v11, v0, 4, 1
    v_lshl_add_u32 v10, v11, 2, v10
    v_bfe_u32 v11, v0, 2, 2
    v_add_u32 v10, v10, v11
    v_mul_u32_u24 v5, 288, v10
    v_and_b32 v11, 3, v0
    v_lshl_add_u32 v5, v11, 3, v5
    s_lshl_b32 s40, s39, 11
    s_and_b32 s36, s2, 7
    s_lshr_b32 s37, s2, 3
    s_and_b32 s38, s36, 3
    s_lshr_b32 s36, s36, 2
    s_lshl_b32 s36, s36, 3
    s_lshr_b32 s43, s37, 2
    s_add_u32 s36, s36, s43
    s_and_b32 s37, s37, 3
    s_mul_i32 s41, s38, 4718592
    s_lshl_b32 s42, s36, 13
    s_add_u32 s41, s41, s42
    s_add_u32 s41, s41, s40
    s_mul_i32 s42, s38, 1327104
    s_mul_i32 s43, s37, 288
    s_add_u32 s42, s42, s43
    s_mul_i32 s43, s39, 2304
    s_mov_b32 s44, -1
    s_mov_b32 s45, 0xffff
    s_waitcnt lgkmcnt(0)
    s_mov_b32 s6, 0x510000
    s_mov_b32 s7, 0x20000
    s_add_u32 s16, s12, 0xe00000
    s_addc_u32 s17, s13, 0
    s_mov_b32 s18, 0x1200000
    s_mov_b32 s19, 0x20000
    s_add_u32 s20, s12, 0x2000000
    s_addc_u32 s21, s13, 0
    s_mov_b32 s22, 0x1200000
    s_mov_b32 s23, 0x20000
    s_mov_b32 s10, 0x240000
    s_mov_b32 s11, 0x20000
    s_add_u32 s24, s12, 0x0
    s_addc_u32 s25, s13, 0
    s_mov_b32 s26, 0x3600
    s_mov_b32 s27, 0x20000
    s_add_u32 s28, s12, 0xbc0000
    s_addc_u32 s29, s13, 0
    s_mov_b32 s30, 0x240000
    s_mov_b32 s31, 0x20000
    s_add_u32 s52, s12, 0x15000
    s_addc_u32 s53, s13, 0
    s_mov_b32 s54, 0x2000
    s_mov_b32 s55, 0x20000
    s_add_u32 s56, s12, 0x10000
    s_addc_u32 s57, s13, 0
    s_mov_b32 s58, 0x1000
    s_mov_b32 s59, 0x20000
    s_lshl_b32 s60, s36, 2
    s_add_u32 s61, s60, 2
    s_max_u32 s60, s60, 1
    s_sub_u32 s60, s60, 1
    s_mul_i32 s60, s60, 7282
    s_lshr_b32 s60, s60, 16
    s_lshl_b32 s62, s38, 3
    s_add_u32 s60, s60, s62
    s_lshl_b32 s60, s60, 7
    s_mul_i32 s61, s61, 7282
    s_lshr_b32 s61, s61, 16
    s_lshl_b32 s62, s38, 3
    s_add_u32 s61, s61, s62
    s_lshl_b32 s61, s61, 7
    v_mov_b32 v11, 1
    v_mov_b32 v12, s74
    s_waitcnt vmcnt(0)
    s_barrier
    s_cmp_lg_u32 s39, 0
    s_cbranch_scc1 K5_QD
    s_mov_b64 exec, 1
    buffer_atomic_add v11, v12, s[56:59], 0 offen sc1
    s_mov_b64 exec, -1
    s_mov_b32 s63, 0
K5_QL:
    buffer_load_dword v11, off, s[56:59], s60 sc1
    buffer_load_dword v12, off, s[56:59], s61 sc1
    s_waitcnt vmcnt(0)
    v_min_u32 v11, v11, v12
    s_nop 0
    v_readfirstlane_b32 s62, v11
    s_cmp_ge_u32 s62, 9
    s_nop 3
    s_cbranch_scc1 K5_QD
    s_sleep 2
    s_add_u32 s63, s63, 1
    s_cmp_lt_u32 s63, 0x10000
    s_cbranch_scc1 K5_QL
K5_QD:
    s_barrier
    s_add_u32 s49, s43, 0
    buffer_load_dwordx4 a[0:3], v1, s[16:19], s41 offen
    buffer_load_dwordx4 a[4:7], v1, s[16:19], s41 offen offset:1024
    s_mov_b64 exec, s[44:45]
    s_add_u32 m0, s49, 0
    s_nop 0
    buffer_load_dwordx4 v2, s[4:7], s42 offen lds
    s_add_u32 m0, s49, 768
    s_nop 0
    buffer_load_dwordx4 v3, s[4:7], s42 offen lds
    s_add_u32 m0, s49, 1536
    s_nop 0
    buffer_load_dwordx4 v4, s[4:7], s42 offen lds
    s_mov_b64 exec, -1
    s_add_u32 s41, s41, 131072
    s_add_u32 s42, s42, 36864
    s_add_u32 s49, s43, 9216
    buffer_load_dwordx4 a[8:11], v1, s[16:19], s41 offen
    buffer_load_dwordx4 a[12:15], v1, s[16:19], s41 offen offset:1024
    s_mov_b64 exec, s[44:45]
    s_add_u32 m0, s49, 0
    s_nop 0
    buffer_load_dwordx4 v2, s[4:7], s42 offen lds
    s_add_u32 m0, s49, 768
    s_nop 0
    buffer_load_dwordx4 v3, s[4:7], s42 offen lds
    s_add_u32 m0, s49, 1536
    s_nop 0
    buffer_load_dwordx4 v4, s[4:7], s42 offen lds
    s_mov_b64 exec, -1
    s_add_u32 s41, s41, 131072
    s_add_u32 s42, s42, 36864
    s_add_u32 s49, s43, 18432
    buffer_load_dwordx4 a[16:19], v1, s[16:19], s41 offen
    buffer_load_dwordx4 a[20:23], v1, s[16:19], s41 offen offset:1024
    s_mov_b64 exec, s[44:45]
    s_add_u32 m0, s49, 0
    s_nop 0
    buffer_load_dwordx4 v2, s[4:7], s42 offen lds
    s_add_u32 m0, s49, 768
    s_nop 0
    buffer_load_dwordx4 v3, s[4:7], s42 offen lds
    s_add_u32 m0, s49, 1536
    s_nop 0
    buffer_load_dwordx4 v4, s[4:7], s42 offen lds
    s_mov_b64 exec, -1
    s_add_u32 s41, s41, 131072
    s_add_u32 s42, s42, 36864
    s_add_u32 s49, s43, 27648
    buffer_load_dwordx4 a[24:27], v1, s[16:19], s41 offen
    buffer_load_dwordx4 a[28:31], v1, s[16:19], s41 offen offset:1024
    s_mov_b64 exec, s[44:45]
    s_add_u32 m0, s49, 0
    s_nop 0
    buffer_load_dwordx4 v2, s[4:7], s42 offen lds
    s_add_u32 m0, s49, 768
    s_nop 0
    buffer_load_dwordx4 v3, s[4:7], s42 offen lds
    s_add_u32 m0, s49, 1536
    s_nop 0
    buffer_load_dwordx4 v4, s[4:7], s42 offen lds
    s_mov_b64 exec, -1
    s_add_u32 s41, s41, 131072
    s_add_u32 s42, s42, 36864
    v_mov_b32 v16, 0
    v_mov_b32 v17, 0
    v_mov_b32 v18, 0
    v_mov_b32 v19, 0
    v_mov_b32 v20, 0
    v_mov_b32 v21, 0
    v_mov_b32 v22, 0
    v_mov_b32 v23, 0
    v_mov_b32 v24, 0
    v_mov_b32 v25, 0
    v_mov_b32 v26, 0
    v_mov_b32 v27, 0
    v_mov_b32 v28, 0
    v_mov_b32 v29, 0
    v_mov_b32 v30, 0
    v_mov_b32 v31, 0
    v_mov_b32 v32, 0
    v_mov_b32 v33, 0
    v_mov_b32 v34, 0
    v_mov_b32 v35, 0
    v_mov_b32 v36, 0
    v_mov_b32 v37, 0
    v_mov_b32 v38, 0
    v_mov_b32 v39, 0
    v_mov_b32 v40, 0
    v_mov_b32 v41, 0
    v_mov_b32 v42, 0
    v_mov_b32 v43, 0
    v_mov_b32 v44, 0
    v_mov_b32 v45, 0
    v_mov_b32 v46, 0
    v_mov_b32 v47, 0
    v_mov_b32 v48, 0
    v_mov_b32 v49, 0
    v_mov_b32 v50, 0
    v_mov_b32 v51, 0
    v_mov_b32 v52, 0
    v_mov_b32 v53, 0
    v_mov_b32 v54, 0
    v_mov_b32 v55, 0
    v_mov_b32 v56, 0
    v_mov_b32 v57, 0
    v_mov_b32 v58, 0
    v_mov_b32 v59, 0
    v_mov_b32 v60, 0
    v_mov_b32 v61, 0
    v_mov_b32 v62, 0
    v_mov_b32 v63, 0
    v_mov_b32 v64, 0
    v_mov_b32 v65, 0
    v_mov_b32 v66, 0
    v_mov_b32 v67, 0
    v_mov_b32 v68, 0
    v_mov_b32 v69, 0
    v_mov_b32 v70, 0
    v_mov_b32 v71, 0
    v_mov_b32 v72, 0
    v_mov_b32 v73, 0
    v_mov_b32 v74, 0
    v_mov_b32 v75, 0
    v_mov_b32 v76, 0
    v_mov_b32 v77, 0
    v_mov_b32 v78, 0
    v_mov_b32 v79, 0
    v_mov_b32 v80, 0
    v_mov_b32 v81, 0
    v_mov_b32 v82, 0
    v_mov_b32 v83, 0
    v_mov_b32 v84, 0
    v_mov_b32 v85, 0
    v_mov_b32 v86, 0
    v_mov_b32 v87, 0
    s_mov_b32 s47, 36864
    s_mov_b32 s48, 0
    s_mov_b32 s50, 0
    s_waitcnt vmcnt(15)
    s_barrier
    ds_read_b64_tr_b16 v[88:89], v5 offset:0
    ds_read_b64_tr_b16 v[90:91], v5 offset:2304
    ds_read_b64_tr_b16 v[92:93], v5 offset:32
    ds_read_b64_tr_b16 v[94:95], v5 offset:2336
    ds_read_b64_tr_b16 v[96:97], v5 offset:64
    ds_read_b64_tr_b16 v[98:99], v5 offset:2368
    ds_read_b64_tr_b16 v[100:101], v5 offset:96
    ds_read_b64_tr_b16 v[102:103], v5 offset:2400
    ds_read_b64_tr_b16 v[104:105], v5 offset:128
    ds_read_b64_tr_b16 v[106:107], v5 offset:2432
    ds_read_b64_tr_b16 v[108:109], v5 offset:160
    ds_read_b64_tr_b16 v[110:111], v5 offset:2464
    ds_read_b64_tr_b16 v[112:113], v5 offset:192
    ds_read_b64_tr_b16 v[114:115], v5 offset:2496
    ds_read_b64_tr_b16 v[116:117], v5 offset:224
    ds_read_b64_tr_b16 v[118:119], v5 offset:2528
    ds_read_b64_tr_b16 v[120:121], v5 offset:256
    ds_read_b64_tr_b16 v[122:123], v5 offset:2560
K5_LOOP:
    s_mov_b32 s51, s47
    s_add_u32 s47, s48, 9216
    s_cmp_lt_u32 s47, 46080
    s_cselect_b32 s47, s47, 0
    s_waitcnt vmcnt(10) lgkmcnt(0)
    s_barrier
    v_mfma_f32_16x16x32_bf16 v[16:19], v[88:91], a[0:3], v[16:19]
    v_add_u32 v8, s47, v5
    s_add_u32 s49, s43, s51
    v_mfma_f32_16x16x32_bf16 v[52:55], v[88:91], a[4:7], v[52:55]
    ds_read_b64_tr_b16 v[124:125], v8 offset:0
    v_mfma_f32_16x16x32_bf16 v[20:23], v[92:95], a[0:3], v[20:23]
    ds_read_b64_tr_b16 v[126:127], v8 offset:2304
    ds_read_b64_tr_b16 v[128:129], v8 offset:32
    v_mfma_f32_16x16x32_bf16 v[56:59], v[92:95], a[4:7], v[56:59]
    ds_read_b64_tr_b16 v[130:131], v8 offset:2336
    v_mfma_f32_16x16x32_bf16 v[24:27], v[96:99], a[0:3], v[24:27]
    ds_read_b64_tr_b16 v[132:133], v8 offset:64
    ds_read_b64_tr_b16 v[134:135], v8 offset:2368
    v_mfma_f32_16x16x32_bf16 v[60:63], v[96:99], a[4:7], v[60:63]
    ds_read_b64_tr_b16 v[136:137], v8 offset:96
    v_mfma_f32_16x16x32_bf16 v[28:31], v[100:103], a[0:3], v[28:31]
    ds_read_b64_tr_b16 v[138:139], v8 offset:2400
    v_mfma_f32_16x16x32_bf16 v[64:67], v[100:103], a[4:7], v[64:67]
    ds_read_b64_tr_b16 v[140:141], v8 offset:128
    ds_read_b64_tr_b16 v[142:143], v8 offset:2432
    v_mfma_f32_16x16x32_bf16 v[32:35], v[104:107], a[0:3], v[32:35]
    ds_read_b64_tr_b16 v[144:145], v8 offset:160
    v_mfma_f32_16x16x32_bf16 v[68:71], v[104:107], a[4:7], v[68:71]
    ds_read_b64_tr_b16 v[146:147], v8 offset:2464
    ds_read_b64_tr_b16 v[148:149], v8 offset:192
    v_mfma_f32_16x16x32_bf16 v[36:39], v[108:111], a[0:3], v[36:39]
    ds_read_b64_tr_b16 v[150:151], v8 offset:2496
    v_mfma_f32_16x16x32_bf16 v[72:75], v[108:111], a[4:7], v[72:75]
    ds_read_b64_tr_b16 v[152:153], v8 offset:224
    ds_read_b64_tr_b16 v[154:155], v8 offset:2528
    v_mfma_f32_16x16x32_bf16 v[40:43], v[112:115], a[0:3], v[40:43]
    ds_read_b64_tr_b16 v[156:157], v8 offset:256
    v_mfma_f32_16x16x32_bf16 v[76:79], v[112:115], a[4:7], v[76:79]
    ds_read_b64_tr_b16 v[158:159], v8 offset:2560
    v_mfma_f32_16x16x32_bf16 v[44:47], v[116:119], a[0:3], v[44:47]
    buffer_load_dwordx4 a[32:35], v1, s[16:19], s41 offen
    buffer_load_dwordx4 a[36:39], v1, s[16:19], s41 offen offset:1024
    v_mfma_f32_16x16x32_bf16 v[80:83], v[116:119], a[4:7], v[80:83]
    s_mov_b64 exec, s[44:45]
    s_add_u32 m0, s49, 0
    s_nop 0
    buffer_load_dwordx4 v2, s[4:7], s42 offen lds
    s_add_u32 m0, s49, 768
    s_nop 0
    buffer_load_dwordx4 v3, s[4:7], s42 offen lds
    s_add_u32 m0, s49, 1536
    s_nop 0
    buffer_load_dwordx4 v4, s[4:7], s42 offen lds
    s_mov_b64 exec, -1
    v_mfma_f32_16x16x32_bf16 v[48:51], v[120:123], a[0:3], v[48:51]
    s_add_u32 s41, s41, 131072
    v_mfma_f32_16x16x32_bf16 v[84:87], v[120:123], a[4:7], v[84:87]
    s_add_u32 s42, s42, 36864
    s_mov_b32 s51, s48
    s_add_u32 s48, s47, 9216
    s_cmp_lt_u32 s48, 46080
    s_cselect_b32 s48, s48, 0
    s_waitcnt vmcnt(10) lgkmcnt(0)
    s_barrier
    v_mfma_f32_16x16x32_bf16 v[16:19], v[124:127], a[8:11], v[16:19]
    v_add_u32 v7, s48, v5
    s_add_u32 s49, s43, s51
    v_mfma_f32_16x16x32_bf16 v[52:55], v[124:127], a[12:15], v[52:55]
    ds_read_b64_tr_b16 v[88:89], v7 offset:0
    v_mfma_f32_16x16x32_bf16 v[20:23], v[128:131], a[8:11], v[20:23]
    ds_read_b64_tr_b16 v[90:91], v7 offset:2304
    ds_read_b64_tr_b16 v[92:93], v7 offset:32
    v_mfma_f32_16x16x32_bf16 v[56:59], v[128:131], a[12:15], v[56:59]
    ds_read_b64_tr_b16 v[94:95], v7 offset:2336
    v_mfma_f32_16x16x32_bf16 v[24:27], v[132:135], a[8:11], v[24:27]
    ds_read_b64_tr_b16 v[96:97], v7 offset:64
    ds_read_b64_tr_b16 v[98:99], v7 offset:2368
    v_mfma_f32_16x16x32_bf16 v[60:63], v[132:135], a[12:15], v[60:63]
    ds_read_b64_tr_b16 v[100:101], v7 offset:96
    v_mfma_f32_16x16x32_bf16 v[28:31], v[136:139], a[8:11], v[28:31]
    ds_read_b64_tr_b16 v[102:103], v7 offset:2400
    v_mfma_f32_16x16x32_bf16 v[64:67], v[136:139], a[12:15], v[64:67]
    ds_read_b64_tr_b16 v[104:105], v7 offset:128
    ds_read_b64_tr_b16 v[106:107], v7 offset:2432
    v_mfma_f32_16x16x32_bf16 v[32:35], v[140:143], a[8:11], v[32:35]
    ds_read_b64_tr_b16 v[108:109], v7 offset:160
    v_mfma_f32_16x16x32_bf16 v[68:71], v[140:143], a[12:15], v[68:71]
    ds_read_b64_tr_b16 v[110:111], v7 offset:2464
    ds_read_b64_tr_b16 v[112:113], v7 offset:192
    v_mfma_f32_16x16x32_bf16 v[36:39], v[144:147], a[8:11], v[36:39]
    ds_read_b64_tr_b16 v[114:115], v7 offset:2496
    v_mfma_f32_16x16x32_bf16 v[72:75], v[144:147], a[12:15], v[72:75]
    ds_read_b64_tr_b16 v[116:117], v7 offset:224
    ds_read_b64_tr_b16 v[118:119], v7 offset:2528
    v_mfma_f32_16x16x32_bf16 v[40:43], v[148:151], a[8:11], v[40:43]
    ds_read_b64_tr_b16 v[120:121], v7 offset:256
    v_mfma_f32_16x16x32_bf16 v[76:79], v[148:151], a[12:15], v[76:79]
    ds_read_b64_tr_b16 v[122:123], v7 offset:2560
    v_mfma_f32_16x16x32_bf16 v[44:47], v[152:155], a[8:11], v[44:47]
    buffer_load_dwordx4 a[40:43], v1, s[16:19], s41 offen
    buffer_load_dwordx4 a[44:47], v1, s[16:19], s41 offen offset:1024
    v_mfma_f32_16x16x32_bf16 v[80:83], v[152:155], a[12:15], v[80:83]
    s_mov_b64 exec, s[44:45]
    s_add_u32 m0, s49, 0
    s_nop 0
    buffer_load_dwordx4 v2, s[4:7], s42 offen lds
    s_add_u32 m0, s49, 768
    s_nop 0
    buffer_load_dwordx4 v3, s[4:7], s42 offen lds
    s_add_u32 m0, s49, 1536
    s_nop 0
    buffer_load_dwordx4 v4, s[4:7], s42 offen lds
    s_mov_b64 exec, -1
    v_mfma_f32_16x16x32_bf16 v[48:51], v[156:159], a[8:11], v[48:51]
    s_add_u32 s41, s41, 131072
    v_mfma_f32_16x16x32_bf16 v[84:87], v[156:159], a[12:15], v[84:87]
    s_add_u32 s42, s42, 36864
    s_mov_b32 s51, s47
    s_add_u32 s47, s48, 9216
    s_cmp_lt_u32 s47, 46080
    s_cselect_b32 s47, s47, 0
    s_waitcnt vmcnt(10) lgkmcnt(0)
    s_barrier
    v_mfma_f32_16x16x32_bf16 v[16:19], v[88:91], a[16:19], v[16:19]
    v_add_u32 v8, s47, v5
    s_add_u32 s49, s43, s51
    v_mfma_f32_16x16x32_bf16 v[52:55], v[88:91], a[20:23], v[52:55]
    ds_read_b64_tr_b16 v[124:125], v8 offset:0
    v_mfma_f32_16x16x32_bf16 v[20:23], v[92:95], a[16:19], v[20:23]
    ds_read_b64_tr_b16 v[126:127], v8 offset:2304
    ds_read_b64_tr_b16 v[128:129], v8 offset:32
    v_mfma_f32_16x16x32_bf16 v[56:59], v[92:95], a[20:23], v[56:59]
    ds_read_b64_tr_b16 v[130:131], v8 offset:2336
    v_mfma_f32_16x16x32_bf16 v[24:27], v[96:99], a[16:19], v[24:27]
    ds_read_b64_tr_b16 v[132:133], v8 offset:64
    ds_read_b64_tr_b16 v[134:135], v8 offset:2368
    v_mfma_f32_16x16x32_bf16 v[60:63], v[96:99], a[20:23], v[60:63]
    ds_read_b64_tr_b16 v[136:137], v8 offset:96
    v_mfma_f32_16x16x32_bf16 v[28:31], v[100:103], a[16:19], v[28:31]
    ds_read_b64_tr_b16 v[138:139], v8 offset:2400
    v_mfma_f32_16x16x32_bf16 v[64:67], v[100:103], a[20:23], v[64:67]
    ds_read_b64_tr_b16 v[140:141], v8 offset:128
    ds_read_b64_tr_b16 v[142:143], v8 offset:2432
    v_mfma_f32_16x16x32_bf16 v[32:35], v[104:107], a[16:19], v[32:35]
    ds_read_b64_tr_b16 v[144:145], v8 offset:160
    v_mfma_f32_16x16x32_bf16 v[68:71], v[104:107], a[20:23], v[68:71]
    ds_read_b64_tr_b16 v[146:147], v8 offset:2464
    ds_read_b64_tr_b16 v[148:149], v8 offset:192
    v_mfma_f32_16x16x32_bf16 v[36:39], v[108:111], a[16:19], v[36:39]
    ds_read_b64_tr_b16 v[150:151], v8 offset:2496
    v_mfma_f32_16x16x32_bf16 v[72:75], v[108:111], a[20:23], v[72:75]
    ds_read_b64_tr_b16 v[152:153], v8 offset:224
    ds_read_b64_tr_b16 v[154:155], v8 offset:2528
    v_mfma_f32_16x16x32_bf16 v[40:43], v[112:115], a[16:19], v[40:43]
    ds_read_b64_tr_b16 v[156:157], v8 offset:256
    v_mfma_f32_16x16x32_bf16 v[76:79], v[112:115], a[20:23], v[76:79]
    ds_read_b64_tr_b16 v[158:159], v8 offset:2560
    v_mfma_f32_16x16x32_bf16 v[44:47], v[116:119], a[16:19], v[44:47]
    buffer_load_dwordx4 a[48:51], v1, s[16:19], s41 offen
    buffer_load_dwordx4 a[52:55], v1, s[16:19], s41 offen offset:1024
    v_mfma_f32_16x16x32_bf16 v[80:83], v[116:119], a[20:23], v[80:83]
    s_mov_b64 exec, s[44:45]
    s_add_u32 m0, s49, 0
    s_nop 0
    buffer_load_dwordx4 v2, s[4:7], s42 offen lds
    s_add_u32 m0, s49, 768
    s_nop 0
    buffer_load_dwordx4 v3, s[4:7], s42 offen lds
    s_add_u32 m0, s49, 1536
    s_nop 0
    buffer_load_dwordx4 v4, s[4:7], s42 offen lds
    s_mov_b64 exec, -1
    v_mfma_f32_16x16x32_bf16 v[48:51], v[120:123], a[16:19], v[48:51]
    s_add_u32 s41, s41, 131072
    v_mfma_f32_16x16x32_bf16 v[84:87], v[120:123], a[20:23], v[84:87]
    s_add_u32 s42, s42, 36864
    s_mov_b32 s51, s48
    s_add_u32 s48, s47, 9216
    s_cmp_lt_u32 s48, 46080
    s_cselect_b32 s48, s48, 0
    s_waitcnt vmcnt(10) lgkmcnt(0)
    s_barrier
    v_mfma_f32_16x16x32_bf16 v[16:19], v[124:127], a[24:27], v[16:19]
    v_add_u32 v7, s48, v5
    s_add_u32 s49, s43, s51
    v_mfma_f32_16x16x32_bf16 v[52:55], v[124:127], a[28:31], v[52:55]
    ds_read_b64_tr_b16 v[88:89], v7 offset:0
    v_mfma_f32_16x16x32_bf16 v[20:23], v[128:131], a[24:27], v[20:23]
    ds_read_b64_tr_b16 v[90:91], v7 offset:2304
    ds_read_b64_tr_b16 v[92:93], v7 offset:32
    v_mfma_f32_16x16x32_bf16 v[56:59], v[128:131], a[28:31], v[56:59]
    ds_read_b64_tr_b16 v[94:95], v7 offset:2336
    v_mfma_f32_16x16x32_bf16 v[24:27], v[132:135], a[24:27], v[24:27]
    ds_read_b64_tr_b16 v[96:97], v7 offset:64
    ds_read_b64_tr_b16 v[98:99], v7 offset:2368
    v_mfma_f32_16x16x32_bf16 v[60:63], v[132:135], a[28:31], v[60:63]
    ds_read_b64_tr_b16 v[100:101], v7 offset:96
    v_mfma_f32_16x16x32_bf16 v[28:31], v[136:139], a[24:27], v[28:31]
    ds_read_b64_tr_b16 v[102:103], v7 offset:2400
    v_mfma_f32_16x16x32_bf16 v[64:67], v[136:139], a[28:31], v[64:67]
    ds_read_b64_tr_b16 v[104:105], v7 offset:128
    ds_read_b64_tr_b16 v[106:107], v7 offset:2432
    v_mfma_f32_16x16x32_bf16 v[32:35], v[140:143], a[24:27], v[32:35]
    ds_read_b64_tr_b16 v[108:109], v7 offset:160
    v_mfma_f32_16x16x32_bf16 v[68:71], v[140:143], a[28:31], v[68:71]
    ds_read_b64_tr_b16 v[110:111], v7 offset:2464
    ds_read_b64_tr_b16 v[112:113], v7 offset:192
    v_mfma_f32_16x16x32_bf16 v[36:39], v[144:147], a[24:27], v[36:39]
    ds_read_b64_tr_b16 v[114:115], v7 offset:2496
    v_mfma_f32_16x16x32_bf16 v[72:75], v[144:147], a[28:31], v[72:75]
    ds_read_b64_tr_b16 v[116:117], v7 offset:224
    ds_read_b64_tr_b16 v[118:119], v7 offset:2528
    v_mfma_f32_16x16x32_bf16 v[40:43], v[148:151], a[24:27], v[40:43]
    ds_read_b64_tr_b16 v[120:121], v7 offset:256
    v_mfma_f32_16x16x32_bf16 v[76:79], v[148:151], a[28:31], v[76:79]
    ds_read_b64_tr_b16 v[122:123], v7 offset:2560
    v_mfma_f32_16x16x32_bf16 v[44:47], v[152:155], a[24:27], v[44:47]
    buffer_load_dwordx4 a[56:59], v1, s[16:19], s41 offen
    buffer_load_dwordx4 a[60:63], v1, s[16:19], s41 offen offset:1024
    v_mfma_f32_16x16x32_bf16 v[80:83], v[152:155], a[28:31], v[80:83]
    s_mov_b64 exec, s[44:45]
    s_add_u32 m0, s49, 0
    s_nop 0
    buffer_load_dwordx4 v2, s[4:7], s42 offen lds
    s_add_u32 m0, s49, 768
    s_nop 0
    buffer_load_dwordx4 v3, s[4:7], s42 offen lds
    s_add_u32 m0, s49, 1536
    s_nop 0
    buffer_load_dwordx4 v4, s[4:7], s42 offen lds
    s_mov_b64 exec, -1
    v_mfma_f32_16x16x32_bf16 v[48:51], v[156:159], a[24:27], v[48:51]
    s_add_u32 s41, s41, 131072
    v_mfma_f32_16x16x32_bf16 v[84:87], v[156:159], a[28:31], v[84:87]
    s_add_u32 s42, s42, 36864
    s_mov_b32 s51, s47
    s_add_u32 s47, s48, 9216
    s_cmp_lt_u32 s47, 46080
    s_cselect_b32 s47, s47, 0
    s_waitcnt vmcnt(10) lgkmcnt(0)
    s_barrier
    v_mfma_f32_16x16x32_bf16 v[16:19], v[88:91], a[32:35], v[16:19]
    v_add_u32 v8, s47, v5
    s_add_u32 s49, s43, s51
    v_mfma_f32_16x16x32_bf16 v[52:55], v[88:91], a[36:39], v[52:55]
    ds_read_b64_tr_b16 v[124:125], v8 offset:0
    v_mfma_f32_16x16x32_bf16 v[20:23], v[92:95], a[32:35], v[20:23]
    ds_read_b64_tr_b16 v[126:127], v8 offset:2304
    ds_read_b64_tr_b16 v[128:129], v8 offset:32
    v_mfma_f32_16x16x32_bf16 v[56:59], v[92:95], a[36:39], v[56:59]
    ds_read_b64_tr_b16 v[130:131], v8 offset:2336
    v_mfma_f32_16x16x32_bf16 v[24:27], v[96:99], a[32:35], v[24:27]
    ds_read_b64_tr_b16 v[132:133], v8 offset:64
    ds_read_b64_tr_b16 v[134:135], v8 offset:2368
    v_mfma_f32_16x16x32_bf16 v[60:63], v[96:99], a[36:39], v[60:63]
    ds_read_b64_tr_b16 v[136:137], v8 offset:96
    v_mfma_f32_16x16x32_bf16 v[28:31], v[100:103], a[32:35], v[28:31]
    ds_read_b64_tr_b16 v[138:139], v8 offset:2400
    v_mfma_f32_16x16x32_bf16 v[64:67], v[100:103], a[36:39], v[64:67]
    ds_read_b64_tr_b16 v[140:141], v8 offset:128
    ds_read_b64_tr_b16 v[142:143], v8 offset:2432
    v_mfma_f32_16x16x32_bf16 v[32:35], v[104:107], a[32:35], v[32:35]
    ds_read_b64_tr_b16 v[144:145], v8 offset:160
    v_mfma_f32_16x16x32_bf16 v[68:71], v[104:107], a[36:39], v[68:71]
    ds_read_b64_tr_b16 v[146:147], v8 offset:2464
    ds_read_b64_tr_b16 v[148:149], v8 offset:192
    v_mfma_f32_16x16x32_bf16 v[36:39], v[108:111], a[32:35], v[36:39]
    ds_read_b64_tr_b16 v[150:151], v8 offset:2496
    v_mfma_f32_16x16x32_bf16 v[72:75], v[108:111], a[36:39], v[72:75]
    ds_read_b64_tr_b16 v[152:153], v8 offset:224
    ds_read_b64_tr_b16 v[154:155], v8 offset:2528
    v_mfma_f32_16x16x32_bf16 v[40:43], v[112:115], a[32:35], v[40:43]
    ds_read_b64_tr_b16 v[156:157], v8 offset:256
    v_mfma_f32_16x16x32_bf16 v[76:79], v[112:115], a[36:39], v[76:79]
    ds_read_b64_tr_b16 v[158:159], v8 offset:2560
    v_mfma_f32_16x16x32_bf16 v[44:47], v[116:119], a[32:35], v[44:47]
    buffer_load_dwordx4 a[64:67], v1, s[16:19], s41 offen
    buffer_load_dwordx4 a[68:71], v1, s[16:19], s41 offen offset:1024
    v_mfma_f32_16x16x32_bf16 v[80:83], v[116:119], a[36:39], v[80:83]
    s_mov_b64 exec, s[44:45]
    s_add_u32 m0, s49, 0
    s_nop 0
    buffer_load_dwordx4 v2, s[4:7], s42 offen lds
    s_add_u32 m0, s49, 768
    s_nop 0
    buffer_load_dwordx4 v3, s[4:7], s42 offen lds
    s_add_u32 m0, s49, 1536
    s_nop 0
    buffer_load_dwordx4 v4, s[4:7], s42 offen lds
    s_mov_b64 exec, -1
    v_mfma_f32_16x16x32_bf16 v[48:51], v[120:123], a[32:35], v[48:51]
    s_add_u32 s41, s41, 131072
    v_mfma_f32_16x16x32_bf16 v[84:87], v[120:123], a[36:39], v[84:87]
    s_add_u32 s42, s42, 36864
    s_mov_b32 s51, s48
    s_add_u32 s48, s47, 9216
    s_cmp_lt_u32 s48, 46080
    s_cselect_b32 s48, s48, 0
    s_waitcnt vmcnt(10) lgkmcnt(0)
    s_barrier
    v_mfma_f32_16x16x32_bf16 v[16:19], v[124:127], a[40:43], v[16:19]
    v_add_u32 v7, s48, v5
    s_add_u32 s49, s43, s51
    v_mfma_f32_16x16x32_bf16 v[52:55], v[124:127], a[44:47], v[52:55]
    ds_read_b64_tr_b16 v[88:89], v7 offset:0
    v_mfma_f32_16x16x32_bf16 v[20:23], v[128:131], a[40:43], v[20:23]
    ds_read_b64_tr_b16 v[90:91], v7 offset:2304
    ds_read_b64_tr_b16 v[92:93], v7 offset:32
    v_mfma_f32_16x16x32_bf16 v[56:59], v[128:131], a[44:47], v[56:59]
    ds_read_b64_tr_b16 v[94:95], v7 offset:2336
    v_mfma_f32_16x16x32_bf16 v[24:27], v[132:135], a[40:43], v[24:27]
    ds_read_b64_tr_b16 v[96:97], v7 offset:64
    ds_read_b64_tr_b16 v[98:99], v7 offset:2368
    v_mfma_f32_16x16x32_bf16 v[60:63], v[132:135], a[44:47], v[60:63]
    ds_read_b64_tr_b16 v[100:101], v7 offset:96
    v_mfma_f32_16x16x32_bf16 v[28:31], v[136:139], a[40:43], v[28:31]
    ds_read_b64_tr_b16 v[102:103], v7 offset:2400
    v_mfma_f32_16x16x32_bf16 v[64:67], v[136:139], a[44:47], v[64:67]
    ds_read_b64_tr_b16 v[104:105], v7 offset:128
    ds_read_b64_tr_b16 v[106:107], v7 offset:2432
    v_mfma_f32_16x16x32_bf16 v[32:35], v[140:143], a[40:43], v[32:35]
    ds_read_b64_tr_b16 v[108:109], v7 offset:160
    v_mfma_f32_16x16x32_bf16 v[68:71], v[140:143], a[44:47], v[68:71]
    ds_read_b64_tr_b16 v[110:111], v7 offset:2464
    ds_read_b64_tr_b16 v[112:113], v7 offset:192
    v_mfma_f32_16x16x32_bf16 v[36:39], v[144:147], a[40:43], v[36:39]
    ds_read_b64_tr_b16 v[114:115], v7 offset:2496
    v_mfma_f32_16x16x32_bf16 v[72:75], v[144:147], a[44:47], v[72:75]
    ds_read_b64_tr_b16 v[116:117], v7 offset:224
    ds_read_b64_tr_b16 v[118:119], v7 offset:2528
    v_mfma_f32_16x16x32_bf16 v[40:43], v[148:151], a[40:43], v[40:43]
    ds_read_b64_tr_b16 v[120:121], v7 offset:256
    v_mfma_f32_16x16x32_bf16 v[76:79], v[148:151], a[44:47], v[76:79]
    ds_read_b64_tr_b16 v[122:123], v7 offset:2560
    v_mfma_f32_16x16x32_bf16 v[44:47], v[152:155], a[40:43], v[44:47]
    buffer_load_dwordx4 a[72:75], v1, s[16:19], s41 offen
    buffer_load_dwordx4 a[76:79], v1, s[16:19], s41 offen offset:1024
    v_mfma_f32_16x16x32_bf16 v[80:83], v[152:155], a[44:47], v[80:83]
    s_mov_b64 exec, s[44:45]
    s_add_u32 m0, s49, 0
    s_nop 0
    buffer_load_dwordx4 v2, s[4:7], s42 offen lds
    s_add_u32 m0, s49, 768
    s_nop 0
    buffer_load_dwordx4 v3, s[4:7], s42 offen lds
    s_add_u32 m0, s49, 1536
    s_nop 0
    buffer_load_dwordx4 v4, s[4:7], s42 offen lds
    s_mov_b64 exec, -1
    v_mfma_f32_16x16x32_bf16 v[48:51], v[156:159], a[40:43], v[48:51]
    s_add_u32 s41, s41, 131072
    v_mfma_f32_16x16x32_bf16 v[84:87], v[156:159], a[44:47], v[84:87]
    s_add_u32 s42, s42, 36864
    s_mov_b32 s51, s47
    s_add_u32 s47, s48, 9216
    s_cmp_lt_u32 s47, 46080
    s_cselect_b32 s47, s47, 0
    s_waitcnt vmcnt(10) lgkmcnt(0)
    s_barrier
    v_mfma_f32_16x16x32_bf16 v[16:19], v[88:91], a[48:51], v[16:19]
    v_add_u32 v8, s47, v5
    s_add_u32 s49, s43, s51
    v_mfma_f32_16x16x32_bf16 v[52:55], v[88:91], a[52:55], v[52:55]
    ds_read_b64_tr_b16 v[124:125], v8 offset:0
    v_mfma_f32_16x16x32_bf16 v[20:23], v[92:95], a[48:51], v[20:23]
    ds_read_b64_tr_b16 v[126:127], v8 offset:2304
    ds_read_b64_tr_b16 v[128:129], v8 offset:32
    v_mfma_f32_16x16x32_bf16 v[56:59], v[92:95], a[52:55], v[56:59]
    ds_read_b64_tr_b16 v[130:131], v8 offset:2336
    v_mfma_f32_16x16x32_bf16 v[24:27], v[96:99], a[48:51], v[24:27]
    ds_read_b64_tr_b16 v[132:133], v8 offset:64
    ds_read_b64_tr_b16 v[134:135], v8 offset:2368
    v_mfma_f32_16x16x32_bf16 v[60:63], v[96:99], a[52:55], v[60:63]
    ds_read_b64_tr_b16 v[136:137], v8 offset:96
    v_mfma_f32_16x16x32_bf16 v[28:31], v[100:103], a[48:51], v[28:31]
    ds_read_b64_tr_b16 v[138:139], v8 offset:2400
    v_mfma_f32_16x16x32_bf16 v[64:67], v[100:103], a[52:55], v[64:67]
    ds_read_b64_tr_b16 v[140:141], v8 offset:128
    ds_read_b64_tr_b16 v[142:143], v8 offset:2432
    v_mfma_f32_16x16x32_bf16 v[32:35], v[104:107], a[48:51], v[32:35]
    ds_read_b64_tr_b16 v[144:145], v8 offset:160
    v_mfma_f32_16x16x32_bf16 v[68:71], v[104:107], a[52:55], v[68:71]
    ds_read_b64_tr_b16 v[146:147], v8 offset:2464
    ds_read_b64_tr_b16 v[148:149], v8 offset:192
    v_mfma_f32_16x16x32_bf16 v[36:39], v[108:111], a[48:51], v[36:39]
    ds_read_b64_tr_b16 v[150:151], v8 offset:2496
    v_mfma_f32_16x16x32_bf16 v[72:75], v[108:111], a[52:55], v[72:75]
    ds_read_b64_tr_b16 v[152:153], v8 offset:224
    ds_read_b64_tr_b16 v[154:155], v8 offset:2528
    v_mfma_f32_16x16x32_bf16 v[40:43], v[112:115], a[48:51], v[40:43]
    ds_read_b64_tr_b16 v[156:157], v8 offset:256
    v_mfma_f32_16x16x32_bf16 v[76:79], v[112:115], a[52:55], v[76:79]
    ds_read_b64_tr_b16 v[158:159], v8 offset:2560
    v_mfma_f32_16x16x32_bf16 v[44:47], v[116:119], a[48:51], v[44:47]
    buffer_load_dwordx4 a[80:83], v1, s[16:19], s41 offen
    buffer_load_dwordx4 a[84:87], v1, s[16:19], s41 offen offset:1024
    v_mfma_f32_16x16x32_bf16 v[80:83], v[116:119], a[52:55], v[80:83]
    s_mov_b64 exec, s[44:45]
    s_add_u32 m0, s49, 0
    s_nop 0
    buffer_load_dwordx4 v2, s[4:7], s42 offen lds
    s_add_u32 m0, s49, 768
    s_nop 0
    buffer_load_dwordx4 v3, s[4:7], s42 offen lds
    s_add_u32 m0, s49, 1536
    s_nop 0
    buffer_load_dwordx4 v4, s[4:7], s42 offen lds
    s_mov_b64 exec, -1
    v_mfma_f32_16x16x32_bf16 v[48:51], v[120:123], a[48:51], v[48:51]
    s_add_u32 s41, s41, 131072
    v_mfma_f32_16x16x32_bf16 v[84:87], v[120:123], a[52:55], v[84:87]
    s_add_u32 s42, s42, 36864
    s_mov_b32 s51, s48
    s_add_u32 s48, s47, 9216
    s_cmp_lt_u32 s48, 46080
    s_cselect_b32 s48, s48, 0
    s_waitcnt vmcnt(10) lgkmcnt(0)
    s_barrier
    v_mfma_f32_16x16x32_bf16 v[16:19], v[124:127], a[56:59], v[16:19]
    v_add_u32 v7, s48, v5
    s_add_u32 s49, s43, s51
    v_mfma_f32_16x16x32_bf16 v[52:55], v[124:127], a[60:63], v[52:55]
    ds_read_b64_tr_b16 v[88:89], v7 offset:0
    v_mfma_f32_16x16x32_bf16 v[20:23], v[128:131], a[56:59], v[20:23]
    ds_read_b64_tr_b16 v[90:91], v7 offset:2304
    ds_read_b64_tr_b16 v[92:93], v7 offset:32
    v_mfma_f32_16x16x32_bf16 v[56:59], v[128:131], a[60:63], v[56:59]
    ds_read_b64_tr_b16 v[94:95], v7 offset:2336
    v_mfma_f32_16x16x32_bf16 v[24:27], v[132:135], a[56:59], v[24:27]
    ds_read_b64_tr_b16 v[96:97], v7 offset:64
    ds_read_b64_tr_b16 v[98:99], v7 offset:2368
    v_mfma_f32_16x16x32_bf16 v[60:63], v[132:135], a[60:63], v[60:63]
    ds_read_b64_tr_b16 v[100:101], v7 offset:96
    v_mfma_f32_16x16x32_bf16 v[28:31], v[136:139], a[56:59], v[28:31]
    ds_read_b64_tr_b16 v[102:103], v7 offset:2400
    v_mfma_f32_16x16x32_bf16 v[64:67], v[136:139], a[60:63], v[64:67]
    ds_read_b64_tr_b16 v[104:105], v7 offset:128
    ds_read_b64_tr_b16 v[106:107], v7 offset:2432
    v_mfma_f32_16x16x32_bf16 v[32:35], v[140:143], a[56:59], v[32:35]
    ds_read_b64_tr_b16 v[108:109], v7 offset:160
    v_mfma_f32_16x16x32_bf16 v[68:71], v[140:143], a[60:63], v[68:71]
    ds_read_b64_tr_b16 v[110:111], v7 offset:2464
    ds_read_b64_tr_b16 v[112:113], v7 offset:192
    v_mfma_f32_16x16x32_bf16 v[36:39], v[144:147], a[56:59], v[36:39]
    ds_read_b64_tr_b16 v[114:115], v7 offset:2496
    v_mfma_f32_16x16x32_bf16 v[72:75], v[144:147], a[60:63], v[72:75]
    ds_read_b64_tr_b16 v[116:117], v7 offset:224
    ds_read_b64_tr_b16 v[118:119], v7 offset:2528
    v_mfma_f32_16x16x32_bf16 v[40:43], v[148:151], a[56:59], v[40:43]
    ds_read_b64_tr_b16 v[120:121], v7 offset:256
    v_mfma_f32_16x16x32_bf16 v[76:79], v[148:151], a[60:63], v[76:79]
    ds_read_b64_tr_b16 v[122:123], v7 offset:2560
    v_mfma_f32_16x16x32_bf16 v[44:47], v[152:155], a[56:59], v[44:47]
    buffer_load_dwordx4 a[88:91], v1, s[16:19], s41 offen
    buffer_load_dwordx4 a[92:95], v1, s[16:19], s41 offen offset:1024
    v_mfma_f32_16x16x32_bf16 v[80:83], v[152:155], a[60:63], v[80:83]
    s_mov_b64 exec, s[44:45]
    s_add_u32 m0, s49, 0
    s_nop 0
    buffer_load_dwordx4 v2, s[4:7], s42 offen lds
    s_add_u32 m0, s49, 768
    s_nop 0
    buffer_load_dwordx4 v3, s[4:7], s42 offen lds
    s_add_u32 m0, s49, 1536
    s_nop 0
    buffer_load_dwordx4 v4, s[4:7], s42 offen lds
    s_mov_b64 exec, -1
    v_mfma_f32_16x16x32_bf16 v[48:51], v[156:159], a[56:59], v[48:51]
    s_add_u32 s41, s41, 131072
    v_mfma_f32_16x16x32_bf16 v[84:87], v[156:159], a[60:63], v[84:87]
    s_add_u32 s42, s42, 36864
    s_mov_b32 s51, s47
    s_add_u32 s47, s48, 9216
    s_cmp_lt_u32 s47, 46080
    s_cselect_b32 s47, s47, 0
    s_waitcnt vmcnt(10) lgkmcnt(0)
    s_barrier
    v_mfma_f32_16x16x32_bf16 v[16:19], v[88:91], a[64:67], v[16:19]
    v_add_u32 v8, s47, v5
    s_add_u32 s49, s43, s51
    v_mfma_f32_16x16x32_bf16 v[52:55], v[88:91], a[68:71], v[52:55]
    ds_read_b64_tr_b16 v[124:125], v8 offset:0
    v_mfma_f32_16x16x32_bf16 v[20:23], v[92:95], a[64:67], v[20:23]
    ds_read_b64_tr_b16 v[126:127], v8 offset:2304
    ds_read_b64_tr_b16 v[128:129], v8 offset:32
    v_mfma_f32_16x16x32_bf16 v[56:59], v[92:95], a[68:71], v[56:59]
    ds_read_b64_tr_b16 v[130:131], v8 offset:2336
    v_mfma_f32_16x16x32_bf16 v[24:27], v[96:99], a[64:67], v[24:27]
    ds_read_b64_tr_b16 v[132:133], v8 offset:64
    ds_read_b64_tr_b16 v[134:135], v8 offset:2368
    v_mfma_f32_16x16x32_bf16 v[60:63], v[96:99], a[68:71], v[60:63]
    ds_read_b64_tr_b16 v[136:137], v8 offset:96
    v_mfma_f32_16x16x32_bf16 v[28:31], v[100:103], a[64:67], v[28:31]
    ds_read_b64_tr_b16 v[138:139], v8 offset:2400
    v_mfma_f32_16x16x32_bf16 v[64:67], v[100:103], a[68:71], v[64:67]
    ds_read_b64_tr_b16 v[140:141], v8 offset:128
    ds_read_b64_tr_b16 v[142:143], v8 offset:2432
    v_mfma_f32_16x16x32_bf16 v[32:35], v[104:107], a[64:67], v[32:35]
    ds_read_b64_tr_b16 v[144:145], v8 offset:160
    v_mfma_f32_16x16x32_bf16 v[68:71], v[104:107], a[68:71], v[68:71]
    ds_read_b64_tr_b16 v[146:147], v8 offset:2464
    ds_read_b64_tr_b16 v[148:149], v8 offset:192
    v_mfma_f32_16x16x32_bf16 v[36:39], v[108:111], a[64:67], v[36:39]
    ds_read_b64_tr_b16 v[150:151], v8 offset:2496
    v_mfma_f32_16x16x32_bf16 v[72:75], v[108:111], a[68:71], v[72:75]
    ds_read_b64_tr_b16 v[152:153], v8 offset:224
    ds_read_b64_tr_b16 v[154:155], v8 offset:2528
    v_mfma_f32_16x16x32_bf16 v[40:43], v[112:115], a[64:67], v[40:43]
    ds_read_b64_tr_b16 v[156:157], v8 offset:256
    v_mfma_f32_16x16x32_bf16 v[76:79], v[112:115], a[68:71], v[76:79]
    ds_read_b64_tr_b16 v[158:159], v8 offset:2560
    s_cmp_eq_u32 s50, 2
    s_cbranch_scc1 K5_ND8
    v_mfma_f32_16x16x32_bf16 v[44:47], v[116:119], a[64:67], v[44:47]
    buffer_load_dwordx4 a[0:3], v1, s[16:19], s41 offen
    buffer_load_dwordx4 a[4:7], v1, s[16:19], s41 offen offset:1024
    v_mfma_f32_16x16x32_bf16 v[80:83], v[116:119], a[68:71], v[80:83]
    s_mov_b64 exec, s[44:45]
    s_add_u32 m0, s49, 0
    s_nop 0
    buffer_load_dwordx4 v2, s[4:7], s42 offen lds
    s_add_u32 m0, s49, 768
    s_nop 0
    buffer_load_dwordx4 v3, s[4:7], s42 offen lds
    s_add_u32 m0, s49, 1536
    s_nop 0
    buffer_load_dwordx4 v4, s[4:7], s42 offen lds
    s_mov_b64 exec, -1
    v_mfma_f32_16x16x32_bf16 v[48:51], v[120:123], a[64:67], v[48:51]
    s_add_u32 s41, s41, 131072
    v_mfma_f32_16x16x32_bf16 v[84:87], v[120:123], a[68:71], v[84:87]
    s_add_u32 s42, s42, 36864
K5_J8:
    s_mov_b32 s51, s48
    s_add_u32 s48, s47, 9216
    s_cmp_lt_u32 s48, 46080
    s_cselect_b32 s48, s48, 0
    s_cmp_eq_u32 s50, 2
    s_cbranch_scc1 K5_TW9
    s_waitcnt vmcnt(10) lgkmcnt(0)
K5_WB9:
    s_barrier
    v_mfma_f32_16x16x32_bf16 v[16:19], v[124:127], a[72:75], v[16:19]
    v_add_u32 v7, s48, v5
    s_add_u32 s49, s43, s51
    v_mfma_f32_16x16x32_bf16 v[52:55], v[124:127], a[76:79], v[52:55]
    ds_read_b64_tr_b16 v[88:89], v7 offset:0
    v_mfma_f32_16x16x32_bf16 v[20:23], v[128:131], a[72:75], v[20:23]
    ds_read_b64_tr_b16 v[90:91], v7 offset:2304
    ds_read_b64_tr_b16 v[92:93], v7 offset:32
    v_mfma_f32_16x16x32_bf16 v[56:59], v[128:131], a[76:79], v[56:59]
    ds_read_b64_tr_b16 v[94:95], v7 offset:2336
    v_mfma_f32_16x16x32_bf16 v[24:27], v[132:135], a[72:75], v[24:27]
    ds_read_b64_tr_b16 v[96:97], v7 offset:64
    ds_read_b64_tr_b16 v[98:99], v7 offset:2368
    v_mfma_f32_16x16x32_bf16 v[60:63], v[132:135], a[76:79], v[60:63]
    ds_read_b64_tr_b16 v[100:101], v7 offset:96
    v_mfma_f32_16x16x32_bf16 v[28:31], v[136:139], a[72:75], v[28:31]
    ds_read_b64_tr_b16 v[102:103], v7 offset:2400
    v_mfma_f32_16x16x32_bf16 v[64:67], v[136:139], a[76:79], v[64:67]
    ds_read_b64_tr_b16 v[104:105], v7 offset:128
    ds_read_b64_tr_b16 v[106:107], v7 offset:2432
    v_mfma_f32_16x16x32_bf16 v[32:35], v[140:143], a[72:75], v[32:35]
    ds_read_b64_tr_b16 v[108:109], v7 offset:160
    v_mfma_f32_16x16x32_bf16 v[68:71], v[140:143], a[76:79], v[68:71]
    ds_read_b64_tr_b16 v[110:111], v7 offset:2464
    ds_read_b64_tr_b16 v[112:113], v7 offset:192
    v_mfma_f32_16x16x32_bf16 v[36:39], v[144:147], a[72:75], v[36:39]
    ds_read_b64_tr_b16 v[114:115], v7 offset:2496
    v_mfma_f32_16x16x32_bf16 v[72:75], v[144:147], a[76:79], v[72:75]
    ds_read_b64_tr_b16 v[116:117], v7 offset:224
    ds_read_b64_tr_b16 v[118:119], v7 offset:2528
    v_mfma_f32_16x16x32_bf16 v[40:43], v[148:151], a[72:75], v[40:43]
    ds_read_b64_tr_b16 v[120:121], v7 offset:256
    v_mfma_f32_16x16x32_bf16 v[76:79], v[148:151], a[76:79], v[76:79]
    ds_read_b64_tr_b16 v[122:123], v7 offset:2560
    s_cmp_eq_u32 s50, 2
    s_cbranch_scc1 K5_ND9
    v_mfma_f32_16x16x32_bf16 v[44:47], v[152:155], a[72:75], v[44:47]
    buffer_load_dwordx4 a[8:11], v1, s[16:19], s41 offen
    buffer_load_dwordx4 a[12:15], v1, s[16:19], s41 offen offset:1024
    v_mfma_f32_16x16x32_bf16 v[80:83], v[152:155], a[76:79], v[80:83]
    s_mov_b64 exec, s[44:45]
    s_add_u32 m0, s49, 0
    s_nop 0
    buffer_load_dwordx4 v2, s[4:7], s42 offen lds
    s_add_u32 m0, s49, 768
    s_nop 0
    buffer_load_dwordx4 v3, s[4:7], s42 offen lds
    s_add_u32 m0, s49, 1536
    s_nop 0
    buffer_load_dwordx4 v4, s[4:7], s42 offen lds
    s_mov_b64 exec, -1
    v_mfma_f32_16x16x32_bf16 v[48:51], v[156:159], a[72:75], v[48:51]
    s_add_u32 s41, s41, 131072
    v_mfma_f32_16x16x32_bf16 v[84:87], v[156:159], a[76:79], v[84:87]
    s_add_u32 s42, s42, 36864
K5_J9:
    s_mov_b32 s51, s47
    s_add_u32 s47, s48, 9216
    s_cmp_lt_u32 s47, 46080
    s_cselect_b32 s47, s47, 0
    s_cmp_eq_u32 s50, 2
    s_cbranch_scc1 K5_TW10
    s_waitcnt vmcnt(10) lgkmcnt(0)
K5_WB10:
    s_barrier
    v_mfma_f32_16x16x32_bf16 v[16:19], v[88:91], a[80:83], v[16:19]
    v_add_u32 v8, s47, v5
    s_add_u32 s49, s43, s51
    v_mfma_f32_16x16x32_bf16 v[52:55], v[88:91], a[84:87], v[52:55]
    ds_read_b64_tr_b16 v[124:125], v8 offset:0
    v_mfma_f32_16x16x32_bf16 v[20:23], v[92:95], a[80:83], v[20:23]
    ds_read_b64_tr_b16 v[126:127], v8 offset:2304
    ds_read_b64_tr_b16 v[128:129], v8 offset:32
    v_mfma_f32_16x16x32_bf16 v[56:59], v[92:95], a[84:87], v[56:59]
    ds_read_b64_tr_b16 v[130:131], v8 offset:2336
    v_mfma_f32_16x16x32_bf16 v[24:27], v[96:99], a[80:83], v[24:27]
    ds_read_b64_tr_b16 v[132:133], v8 offset:64
    ds_read_b64_tr_b16 v[134:135], v8 offset:2368
    v_mfma_f32_16x16x32_bf16 v[60:63], v[96:99], a[84:87], v[60:63]
    ds_read_b64_tr_b16 v[136:137], v8 offset:96
    v_mfma_f32_16x16x32_bf16 v[28:31], v[100:103], a[80:83], v[28:31]
    ds_read_b64_tr_b16 v[138:139], v8 offset:2400
    v_mfma_f32_16x16x32_bf16 v[64:67], v[100:103], a[84:87], v[64:67]
    ds_read_b64_tr_b16 v[140:141], v8 offset:128
    ds_read_b64_tr_b16 v[142:143], v8 offset:2432
    v_mfma_f32_16x16x32_bf16 v[32:35], v[104:107], a[80:83], v[32:35]
    ds_read_b64_tr_b16 v[144:145], v8 offset:160
    v_mfma_f32_16x16x32_bf16 v[68:71], v[104:107], a[84:87], v[68:71]
    ds_read_b64_tr_b16 v[146:147], v8 offset:2464
    ds_read_b64_tr_b16 v[148:149], v8 offset:192
    v_mfma_f32_16x16x32_bf16 v[36:39], v[108:111], a[80:83], v[36:39]
    ds_read_b64_tr_b16 v[150:151], v8 offset:2496
    v_mfma_f32_16x16x32_bf16 v[72:75], v[108:111], a[84:87], v[72:75]
    ds_read_b64_tr_b16 v[152:153], v8 offset:224
    ds_read_b64_tr_b16 v[154:155], v8 offset:2528
    v_mfma_f32_16x16x32_bf16 v[40:43], v[112:115], a[80:83], v[40:43]
    ds_read_b64_tr_b16 v[156:157], v8 offset:256
    v_mfma_f32_16x16x32_bf16 v[76:79], v[112:115], a[84:87], v[76:79]
    ds_read_b64_tr_b16 v[158:159], v8 offset:2560
    s_cmp_eq_u32 s50, 2
    s_cbranch_scc1 K5_ND10
    v_mfma_f32_16x16x32_bf16 v[44:47], v[116:119], a[80:83], v[44:47]
    buffer_load_dwordx4 a[16:19], v1, s[16:19], s41 offen
    buffer_load_dwordx4 a[20:23], v1, s[16:19], s41 offen offset:1024
    v_mfma_f32_16x16x32_bf16 v[80:83], v[116:119], a[84:87], v[80:83]
    s_mov_b64 exec, s[44:45]
    s_add_u32 m0, s49, 0
    s_nop 0
    buffer_load_dwordx4 v2, s[4:7], s42 offen lds
    s_add_u32 m0, s49, 768
    s_nop 0
    buffer_load_dwordx4 v3, s[4:7], s42 offen lds
    s_add_u32 m0, s49, 1536
    s_nop 0
    buffer_load_dwordx4 v4, s[4:7], s42 offen lds
    s_mov_b64 exec, -1
    v_mfma_f32_16x16x32_bf16 v[48:51], v[120:123], a[80:83], v[48:51]
    s_add_u32 s41, s41, 131072
    v_mfma_f32_16x16x32_bf16 v[84:87], v[120:123], a[84:87], v[84:87]
    s_add_u32 s42, s42, 36864
K5_J10:
    s_mov_b32 s51, s48
    s_add_u32 s48, s47, 9216
    s_cmp_lt_u32 s48, 46080
    s_cselect_b32 s48, s48, 0
    s_waitcnt vmcnt(10) lgkmcnt(0)
    s_barrier
    v_mfma_f32_16x16x32_bf16 v[16:19], v[124:127], a[88:91], v[16:19]
    v_add_u32 v7, s48, v5
    s_add_u32 s49, s43, s51
    v_mfma_f32_16x16x32_bf16 v[52:55], v[124:127], a[92:95], v[52:55]
    ds_read_b64_tr_b16 v[88:89], v7 offset:0
    v_mfma_f32_16x16x32_bf16 v[20:23], v[128:131], a[88:91], v[20:23]
    ds_read_b64_tr_b16 v[90:91], v7 offset:2304
    ds_read_b64_tr_b16 v[92:93], v7 offset:32
    v_mfma_f32_16x16x32_bf16 v[56:59], v[128:131], a[92:95], v[56:59]
    ds_read_b64_tr_b16 v[94:95], v7 offset:2336
    v_mfma_f32_16x16x32_bf16 v[24:27], v[132:135], a[88:91], v[24:27]
    ds_read_b64_tr_b16 v[96:97], v7 offset:64
    ds_read_b64_tr_b16 v[98:99], v7 offset:2368
    v_mfma_f32_16x16x32_bf16 v[60:63], v[132:135], a[92:95], v[60:63]
    ds_read_b64_tr_b16 v[100:101], v7 offset:96
    v_mfma_f32_16x16x32_bf16 v[28:31], v[136:139], a[88:91], v[28:31]
    ds_read_b64_tr_b16 v[102:103], v7 offset:2400
    v_mfma_f32_16x16x32_bf16 v[64:67], v[136:139], a[92:95], v[64:67]
    ds_read_b64_tr_b16 v[104:105], v7 offset:128
    ds_read_b64_tr_b16 v[106:107], v7 offset:2432
    v_mfma_f32_16x16x32_bf16 v[32:35], v[140:143], a[88:91], v[32:35]
    ds_read_b64_tr_b16 v[108:109], v7 offset:160
    v_mfma_f32_16x16x32_bf16 v[68:71], v[140:143], a[92:95], v[68:71]
    ds_read_b64_tr_b16 v[110:111], v7 offset:2464
    ds_read_b64_tr_b16 v[112:113], v7 offset:192
    v_mfma_f32_16x16x32_bf16 v[36:39], v[144:147], a[88:91], v[36:39]
    ds_read_b64_tr_b16 v[114:115], v7 offset:2496
    v_mfma_f32_16x16x32_bf16 v[72:75], v[144:147], a[92:95], v[72:75]
    ds_read_b64_tr_b16 v[116:117], v7 offset:224
    ds_read_b64_tr_b16 v[118:119], v7 offset:2528
    v_mfma_f32_16x16x32_bf16 v[40:43], v[148:151], a[88:91], v[40:43]
    ds_read_b64_tr_b16 v[120:121], v7 offset:256
    v_mfma_f32_16x16x32_bf16 v[76:79], v[148:151], a[92:95], v[76:79]
    ds_read_b64_tr_b16 v[122:123], v7 offset:2560
    s_cmp_eq_u32 s50, 2
    s_cbranch_scc1 K5_ND11
    v_mfma_f32_16x16x32_bf16 v[44:47], v[152:155], a[88:91], v[44:47]
    buffer_load_dwordx4 a[24:27], v1, s[16:19], s41 offen
    buffer_load_dwordx4 a[28:31], v1, s[16:19], s41 offen offset:1024
    v_mfma_f32_16x16x32_bf16 v[80:83], v[152:155], a[92:95], v[80:83]
    s_mov_b64 exec, s[44:45]
    s_add_u32 m0, s49, 0
    s_nop 0
    buffer_load_dwordx4 v2, s[4:7], s42 offen lds
    s_add_u32 m0, s49, 768
    s_nop 0
    buffer_load_dwordx4 v3, s[4:7], s42 offen lds
    s_add_u32 m0, s49, 1536
    s_nop 0
    buffer_load_dwordx4 v4, s[4:7], s42 offen lds
    s_mov_b64 exec, -1
    v_mfma_f32_16x16x32_bf16 v[48:51], v[156:159], a[88:91], v[48:51]
    s_add_u32 s41, s41, 131072
    v_mfma_f32_16x16x32_bf16 v[84:87], v[156:159], a[92:95], v[84:87]
    s_add_u32 s42, s42, 36864
K5_J11:
    s_add_u32 s50, s50, 1
    s_cmp_lt_u32 s50, 3
    s_cbranch_scc1 K5_LOOP
    s_nop 3
    s_branch K5_EPI
K5_TW9:
    s_waitcnt vmcnt(5) lgkmcnt(0)
    s_branch K5_WB9
K5_TW10:
    s_waitcnt vmcnt(0) lgkmcnt(0)
    s_branch K5_WB10
K5_ND8:
    v_mfma_f32_16x16x32_bf16 v[44:47], v[116:119], a[64:67], v[44:47]
    v_mfma_f32_16x16x32_bf16 v[80:83], v[116:119], a[68:71], v[80:83]
    v_mfma_f32_16x16x32_bf16 v[48:51], v[120:123], a[64:67], v[48:51]
    v_mfma_f32_16x16x32_bf16 v[84:87], v[120:123], a[68:71], v[84:87]
    s_branch K5_J8
    s_nop 6
K5_ND9:
    v_mfma_f32_16x16x32_bf16 v[44:47], v[152:155], a[72:75], v[44:47]
    v_mfma_f32_16x16x32_bf16 v[80:83], v[152:155], a[76:79], v[80:83]
    v_mfma_f32_16x16x32_bf16 v[48:51], v[156:159], a[72:75], v[48:51]
    v_mfma_f32_16x16x32_bf16 v[84:87], v[156:159], a[76:79], v[84:87]
    s_branch K5_J9
    s_nop 6
K5_ND10:
    v_mfma_f32_16x16x32_bf16 v[44:47], v[116:119], a[80:83], v[44:47]
    v_mfma_f32_16x16x32_bf16 v[80:83], v[116:119], a[84:87], v[80:83]
    v_mfma_f32_16x16x32_bf16 v[48:51], v[120:123], a[80:83], v[48:51]
    v_mfma_f32_16x16x32_bf16 v[84:87], v[120:123], a[84:87], v[84:87]
    s_branch K5_J10
    s_nop 6
K5_ND11:
    v_mfma_f32_16x16x32_bf16 v[44:47], v[152:155], a[88:91], v[44:47]
    v_mfma_f32_16x16x32_bf16 v[80:83], v[152:155], a[92:95], v[80:83]
    v_mfma_f32_16x16x32_bf16 v[48:51], v[156:159], a[88:91], v[48:51]
    v_mfma_f32_16x16x32_bf16 v[84:87], v[156:159], a[92:95], v[84:87]
    s_branch K5_J11
    s_nop 6
K5_EPI:
    s_waitcnt lgkmcnt(0)
    s_nop 7
    s_lshr_b32 s56, s39, 1
    s_and_b32 s57, s39, 1
    s_lshl_b32 s58, s36, 2
    s_add_u32 s58, s58, s37
    s_lshl_b32 s65, s58, 7
    s_lshl_b32 s59, s58, 2
    s_add_u32 s59, s59, s38
    s_lshl_b32 s59, s59, 1
    s_add_u32 s59, s59, s56
    s_mul_i32 s59, s59, 5120
    s_lshl_b32 s60, s36, 7
    s_lshl_b32 s61, s38, 5
    s_add_u32 s60, s60, s61
    s_lshl_b32 s61, s56, 4
    s_add_u32 s60, s60, s61
    s_mul_i32 s61, s37, 144
    s_lshl_b32 s62, s57, 6
    s_add_u32 s61, s61, s62
    s_mul_i32 s62, s60, 1152
    s_lshl_b32 s63, s61, 1
    s_add_u32 s62, s62, s63
    s_lshl_b32 s63, s61, 2
    s_add_u32 s63, s63, 11520
    v_and_b32 v2, 15, v0
    v_mul_u32_u24 v2, 1152, v2
    v_lshrrev_b32 v3, 4, v0
    v_lshl_add_u32 v2, v3, 3, v2
    v_lshlrev_b32 v3, 4, v3
    s_lshl_b32 s64, s57, 11
    s_add_u32 s64, s64, s59
    buffer_load_dwordx2 v[136:137], v2, s[28:31], s62 offen offset:0 sc1
    buffer_load_dwordx2 v[138:139], v2, s[28:31], s62 offen offset:32 sc1
    buffer_load_dwordx2 v[140:141], v2, s[28:31], s62 offen offset:64 sc1
    buffer_load_dwordx2 v[142:143], v2, s[28:31], s62 offen offset:96 sc1
    buffer_load_dwordx2 v[144:145], v2, s[28:31], s62 offen offset:128 sc1
    buffer_load_dwordx4 v[148:151], v3, s[24:27], s63 offen offset:0
    buffer_load_dwordx4 v[152:155], v3, s[24:27], s63 offen offset:64
    buffer_load_dwordx4 v[156:159], v3, s[24:27], s63 offen offset:128
    buffer_load_dwordx4 v[160:163], v3, s[24:27], s63 offen offset:192
    buffer_load_dwordx4 v[164:167], v3, s[24:27], s63 offen offset:256
    s_lshl_b32 s41, s38, 6
    s_lshl_b32 s42, s36, 2
    s_add_u32 s41, s41, s42
    s_add_u32 s41, s41, s37
    s_lshl_b32 s41, s41, 2
    s_add_u32 s41, s41, s39
    s_mul_i32 s41, s41, 10240
    v_max3_f32 v88, |v16|, |v17|, |v18|
    v_max3_f32 v89, |v25|, |v26|, |v27|
    v_max3_f32 v90, |v34|, |v35|, |v36|
    v_max3_f32 v91, |v43|, |v44|, |v45|
    v_max3_f32 v88, |v19|, |v20|, v88
    v_max3_f32 v89, |v28|, |v29|, v89
    v_max3_f32 v90, |v37|, |v38|, v90
    v_max3_f32 v91, |v46|, |v47|, v91
    v_max3_f32 v88, |v21|, |v22|, v88
    v_max3_f32 v89, |v30|, |v31|, v89
    v_max3_f32 v90, |v39|, |v40|, v90
    v_max3_f32 v91, |v48|, |v49|, v91
    v_max3_f32 v88, |v23|, |v24|, v88
    v_max3_f32 v89, |v32|, |v33|, v89
    v_max3_f32 v90, |v41|, |v42|, v90
    v_max3_f32 v91, |v50|, |v51|, v91
    v_max3_f32 v88, v88, v89, v90
    v_max_f32 v88, v88, v91
    v_frexp_exp_i32_f32 v89, v88
    v_sub_u32 v90, 15, v89
    v_max_i32 v90, -100, v90
    v_min_i32 v90, 100, v90
    v_ldexp_f32 v91, 1.0, v90
    v_sub_u32 v90, 0, v90
    v_ldexp_f32 v110, 1.0, v90
    v_mul_f32 v16, v16, v91
    v_mul_f32 v17, v17, v91
    v_mul_f32 v18, v18, v91
    v_mul_f32 v19, v19, v91
    v_mul_f32 v20, v20, v91
    v_mul_f32 v21, v21, v91
    v_mul_f32 v22, v22, v91
    v_mul_f32 v23, v23, v91
    v_mul_f32 v24, v24, v91
    v_mul_f32 v25, v25, v91
    v_mul_f32 v26, v26, v91
    v_mul_f32 v27, v27, v91
    v_mul_f32 v28, v28, v91
    v_mul_f32 v29, v29, v91
    v_mul_f32 v30, v30, v91
    v_mul_f32 v31, v31, v91
    v_mul_f32 v32, v32, v91
    v_mul_f32 v33, v33, v91
    v_mul_f32 v34, v34, v91
    v_mul_f32 v35, v35, v91
    v_mul_f32 v36, v36, v91
    v_mul_f32 v37, v37, v91
    v_mul_f32 v38, v38, v91
    v_mul_f32 v39, v39, v91
    v_mul_f32 v40, v40, v91
    v_mul_f32 v41, v41, v91
    v_mul_f32 v42, v42, v91
    v_mul_f32 v43, v43, v91
    v_mul_f32 v44, v44, v91
    v_mul_f32 v45, v45, v91
    v_mul_f32 v46, v46, v91
    v_mul_f32 v47, v47, v91
    v_mul_f32 v48, v48, v91
    v_mul_f32 v49, v49, v91
    v_mul_f32 v50, v50, v91
    v_mul_f32 v51, v51, v91
    v_cvt_pk_f16_f32 v92, v16, v17
    v_cvt_pk_f16_f32 v93, v18, v19
    v_cvt_pk_f16_f32 v94, v20, v21
    v_cvt_pk_f16_f32 v95, v22, v23
    v_cvt_pk_f16_f32 v96, v24, v25
    v_cvt_pk_f16_f32 v97, v26, v27
    v_cvt_pk_f16_f32 v98, v28, v29
    v_cvt_pk_f16_f32 v99, v30, v31
    v_cvt_pk_f16_f32 v100, v32, v33
    v_cvt_pk_f16_f32 v101, v34, v35
    v_cvt_pk_f16_f32 v102, v36, v37
    v_cvt_pk_f16_f32 v103, v38, v39
    v_cvt_pk_f16_f32 v104, v40, v41
    v_cvt_pk_f16_f32 v105, v42, v43
    v_cvt_pk_f16_f32 v106, v44, v45
    v_cvt_pk_f16_f32 v107, v46, v47
    v_cvt_pk_f16_f32 v108, v48, v49
    v_cvt_pk_f16_f32 v109, v50, v51
    v_mov_b32 v111, 0
    buffer_store_dwordx4 v[92:95], v1, s[20:23], s41 offen offset:0 sc1
    buffer_store_dwordx4 v[96:99], v1, s[20:23], s41 offen offset:1024 sc1
    buffer_store_dwordx4 v[100:103], v1, s[20:23], s41 offen offset:2048 sc1
    buffer_store_dwordx4 v[104:107], v1, s[20:23], s41 offen offset:3072 sc1
    s_add_u32 s41, s41, 4096
    buffer_store_dwordx4 v[108:111], v1, s[20:23], s41 offen offset:0 sc1
    v_max3_f32 v112, |v52|, |v53|, |v54|
    v_max3_f32 v113, |v61|, |v62|, |v63|
    v_max3_f32 v114, |v70|, |v71|, |v72|
    v_max3_f32 v115, |v79|, |v80|, |v81|
    v_max3_f32 v112, |v55|, |v56|, v112
    v_max3_f32 v113, |v64|, |v65|, v113
    v_max3_f32 v114, |v73|, |v74|, v114
    v_max3_f32 v115, |v82|, |v83|, v115
    v_max3_f32 v112, |v57|, |v58|, v112
    v_max3_f32 v113, |v66|, |v67|, v113
    v_max3_f32 v114, |v75|, |v76|, v114
    v_max3_f32 v115, |v84|, |v85|, v115
    v_max3_f32 v112, |v59|, |v60|, v112
    v_max3_f32 v113, |v68|, |v69|, v113
    v_max3_f32 v114, |v77|, |v78|, v114
    v_max3_f32 v115, |v86|, |v87|, v115
    v_max3_f32 v112, v112, v113, v114
    v_max_f32 v112, v112, v115
    v_frexp_exp_i32_f32 v113, v112
    v_sub_u32 v114, 15, v113
    v_max_i32 v114, -100, v114
    v_min_i32 v114, 100, v114
    v_ldexp_f32 v115, 1.0, v114
    v_sub_u32 v114, 0, v114
    v_ldexp_f32 v134, 1.0, v114
    v_mul_f32 v52, v52, v115
    v_mul_f32 v53, v53, v115
    v_mul_f32 v54, v54, v115
    v_mul_f32 v55, v55, v115
    v_mul_f32 v56, v56, v115
    v_mul_f32 v57, v57, v115
    v_mul_f32 v58, v58, v115
    v_mul_f32 v59, v59, v115
    v_mul_f32 v60, v60, v115
    v_mul_f32 v61, v61, v115
    v_mul_f32 v62, v62, v115
    v_mul_f32 v63, v63, v115
    v_mul_f32 v64, v64, v115
    v_mul_f32 v65, v65, v115
    v_mul_f32 v66, v66, v115
    v_mul_f32 v67, v67, v115
    v_mul_f32 v68, v68, v115
    v_mul_f32 v69, v69, v115
    v_mul_f32 v70, v70, v115
    v_mul_f32 v71, v71, v115
    v_mul_f32 v72, v72, v115
    v_mul_f32 v73, v73, v115
    v_mul_f32 v74, v74, v115
    v_mul_f32 v75, v75, v115
    v_mul_f32 v76, v76, v115
    v_mul_f32 v77, v77, v115
    v_mul_f32 v78, v78, v115
    v_mul_f32 v79, v79, v115
    v_mul_f32 v80, v80, v115
    v_mul_f32 v81, v81, v115
    v_mul_f32 v82, v82, v115
    v_mul_f32 v83, v83, v115
    v_mul_f32 v84, v84, v115
    v_mul_f32 v85, v85, v115
    v_mul_f32 v86, v86, v115
    v_mul_f32 v87, v87, v115
    v_cvt_pk_f16_f32 v116, v52, v53
    v_cvt_pk_f16_f32 v117, v54, v55
    v_cvt_pk_f16_f32 v118, v56, v57
    v_cvt_pk_f16_f32 v119, v58, v59
    v_cvt_pk_f16_f32 v120, v60, v61
    v_cvt_pk_f16_f32 v121, v62, v63
    v_cvt_pk_f16_f32 v122, v64, v65
    v_cvt_pk_f16_f32 v123, v66, v67
    v_cvt_pk_f16_f32 v124, v68, v69
    v_cvt_pk_f16_f32 v125, v70, v71
    v_cvt_pk_f16_f32 v126, v72, v73
    v_cvt_pk_f16_f32 v127, v74, v75
    v_cvt_pk_f16_f32 v128, v76, v77
    v_cvt_pk_f16_f32 v129, v78, v79
    v_cvt_pk_f16_f32 v130, v80, v81
    v_cvt_pk_f16_f32 v131, v82, v83
    v_cvt_pk_f16_f32 v132, v84, v85
    v_cvt_pk_f16_f32 v133, v86, v87
    v_mov_b32 v135, 0
    buffer_store_dwordx4 v[116:119], v1, s[20:23], s41 offen offset:1024 sc1
    buffer_store_dwordx4 v[120:123], v1, s[20:23], s41 offen offset:2048 sc1
    buffer_store_dwordx4 v[124:127], v1, s[20:23], s41 offen offset:3072 sc1
    s_add_u32 s41, s41, 4096
    buffer_store_dwordx4 v[128:131], v1, s[20:23], s41 offen offset:0 sc1
    buffer_store_dwordx4 v[132:135], v1, s[20:23], s41 offen offset:1024 sc1
    s_waitcnt vmcnt(0)
    s_barrier
    s_cmp_lg_u32 s39, 0
    s_cbranch_scc1 K5_PD
    s_mov_b64 exec, 1
    v_mov_b32 v11, 1
    buffer_atomic_add v11, off, s[52:55], s65 sc0 sc1
    s_mov_b64 exec, -1
    s_mov_b32 s67, 0
    s_waitcnt vmcnt(0)
    v_readfirstlane_b32 s66, v11
    s_cmp_ge_u32 s66, 3
    s_nop 3
    s_cbranch_scc1 K5_PD
K5_PL:
    buffer_load_dword v11, off, s[52:55], s65 sc1
    s_waitcnt vmcnt(0)
    v_readfirstlane_b32 s66, v11
    s_cmp_ge_u32 s66, 4
    s_nop 3
    s_cbranch_scc1 K5_PD
    s_add_u32 s67, s67, 1
    s_cmp_lt_u32 s67, 0x10000
    s_cbranch_scc1 K5_PL
K5_PD:
    s_barrier
    s_add_u32 s60, s59, 4096
    buffer_load_dword v60, v1, s[20:23], s60 offen offset:8 sc1
    buffer_load_dwordx4 v[8:11], v1, s[20:23], s64 offen sc1
    buffer_load_dwordx4 v[12:15], v1, s[20:23], s64 offen offset:1024 sc1
    buffer_load_dwordx2 v[16:17], v1, s[20:23], s64 offen offset:2048 sc1
    s_add_u32 s64, s64, 2621440
    s_add_u32 s60, s60, 2621440
    buffer_load_dword v61, v1, s[20:23], s60 offen offset:8 sc1
    buffer_load_dwordx4 v[20:23], v1, s[20:23], s64 offen sc1
    buffer_load_dwordx4 v[24:27], v1, s[20:23], s64 offen offset:1024 sc1
    buffer_load_dwordx2 v[28:29], v1, s[20:23], s64 offen offset:2048 sc1
    s_add_u32 s64, s64, 2621440
    s_add_u32 s60, s60, 2621440
    buffer_load_dword v62, v1, s[20:23], s60 offen offset:8 sc1
    buffer_load_dwordx4 v[32:35], v1, s[20:23], s64 offen sc1
    buffer_load_dwordx4 v[36:39], v1, s[20:23], s64 offen offset:1024 sc1
    buffer_load_dwordx2 v[40:41], v1, s[20:23], s64 offen offset:2048 sc1
    s_add_u32 s64, s64, 2621440
    s_add_u32 s60, s60, 2621440
    buffer_load_dword v63, v1, s[20:23], s60 offen offset:8 sc1
    buffer_load_dwordx4 v[44:47], v1, s[20:23], s64 offen sc1
    buffer_load_dwordx4 v[48:51], v1, s[20:23], s64 offen offset:1024 sc1
    buffer_load_dwordx2 v[52:53], v1, s[20:23], s64 offen offset:2048 sc1
    s_waitcnt vmcnt(12)
    v_fma_mix_f32 v88, v8, v60, 0 op_sel:[0,0,0] op_sel_hi:[1,0,0]
    v_fma_mix_f32 v89, v8, v60, 0 op_sel:[1,0,0] op_sel_hi:[1,0,0]
    v_fma_mix_f32 v90, v9, v60, 0 op_sel:[0,0,0] op_sel_hi:[1,0,0]
    v_fma_mix_f32 v91, v9, v60, 0 op_sel:[1,0,0] op_sel_hi:[1,0,0]
    v_fma_mix_f32 v92, v10, v60, 0 op_sel:[0,0,0] op_sel_hi:[1,0,0]
    v_fma_mix_f32 v93, v10, v60, 0 op_sel:[1,0,0] op_sel_hi:[1,0,0]
    v_fma_mix_f32 v94, v11, v60, 0 op_sel:[0,0,0] op_sel_hi:[1,0,0]
    v_fma_mix_f32 v95, v11, v60, 0 op_sel:[1,0,0] op_sel_hi:[1,0,0]
    v_fma_mix_f32 v96, v12, v60, 0 op_sel:[0,0,0] op_sel_hi:[1,0,0]
    v_fma_mix_f32 v97, v12, v60, 0 op_sel:[1,0,0] op_sel_hi:[1,0,0]
    v_fma_mix_f32 v98, v13, v60, 0 op_sel:[0,0,0] op_sel_hi:[1,0,0]
    v_fma_mix_f32 v99, v13, v60, 0 op_sel:[1,0,0] op_sel_hi:[1,0,0]
    v_fma_mix_f32 v100, v14, v60, 0 op_sel:[0,0,0] op_sel_hi:[1,0,0]
    v_fma_mix_f32 v101, v14, v60, 0 op_sel:[1,0,0] op_sel_hi:[1,0,0]
    v_fma_mix_f32 v102, v15, v60, 0 op_sel:[0,0,0] op_sel_hi:[1,0,0]
    v_fma_mix_f32 v103, v15, v60, 0 op_sel:[1,0,0] op_sel_hi:[1,0,0]
    v_fma_mix_f32 v104, v16, v60, 0 op_sel:[0,0,0] op_sel_hi:[1,0,0]
    v_fma_mix_f32 v105, v16, v60, 0 op_sel:[1,0,0] op_sel_hi:[1,0,0]
    v_fma_mix_f32 v106, v17, v60, 0 op_sel:[0,0,0] op_sel_hi:[1,0,0]
    v_fma_mix_f32 v107, v17, v60, 0 op_sel:[1,0,0] op_sel_hi:[1,0,0]
    s_waitcnt vmcnt(8)
    v_fma_mix_f32 v88, v20, v61, v88 op_sel:[0,0,0] op_sel_hi:[1,0,0]
    v_fma_mix_f32 v89, v20, v61, v89 op_sel:[1,0,0] op_sel_hi:[1,0,0]
    v_fma_mix_f32 v90, v21, v61, v90 op_sel:[0,0,0] op_sel_hi:[1,0,0]
    v_fma_mix_f32 v91, v21, v61, v91 op_sel:[1,0,0] op_sel_hi:[1,0,0]
    v_fma_mix_f32 v92, v22, v61, v92 op_sel:[0,0,0] op_sel_hi:[1,0,0]
    v_fma_mix_f32 v93, v22, v61, v93 op_sel:[1,0,0] op_sel_hi:[1,0,0]
    v_fma_mix_f32 v94, v23, v61, v94 op_sel:[0,0,0] op_sel_hi:[1,0,0]
    v_fma_mix_f32 v95, v23, v61, v95 op_sel:[1,0,0] op_sel_hi:[1,0,0]
    v_fma_mix_f32 v96, v24, v61, v96 op_sel:[0,0,0] op_sel_hi:[1,0,0]
    v_fma_mix_f32 v97, v24, v61, v97 op_sel:[1,0,0] op_sel_hi:[1,0,0]
    v_fma_mix_f32 v98, v25, v61, v98 op_sel:[0,0,0] op_sel_hi:[1,0,0]
    v_fma_mix_f32 v99, v25, v61, v99 op_sel:[1,0,0] op_sel_hi:[1,0,0]
    v_fma_mix_f32 v100, v26, v61, v100 op_sel:[0,0,0] op_sel_hi:[1,0,0]
    v_fma_mix_f32 v101, v26, v61, v101 op_sel:[1,0,0] op_sel_hi:[1,0,0]
    v_fma_mix_f32 v102, v27, v61, v102 op_sel:[0,0,0] op_sel_hi:[1,0,0]
    v_fma_mix_f32 v103, v27, v61, v103 op_sel:[1,0,0] op_sel_hi:[1,0,0]
    v_fma_mix_f32 v104, v28, v61, v104 op_sel:[0,0,0] op_sel_hi:[1,0,0]
    v_fma_mix_f32 v105, v28, v61, v105 op_sel:[1,0,0] op_sel_hi:[1,0,0]
    v_fma_mix_f32 v106, v29, v61, v106 op_sel:[0,0,0] op_sel_hi:[1,0,0]
    v_fma_mix_f32 v107, v29, v61, v107 op_sel:[1,0,0] op_sel_hi:[1,0,0]
    s_waitcnt vmcnt(4)
    v_fma_mix_f32 v88, v32, v62, v88 op_sel:[0,0,0] op_sel_hi:[1,0,0]
    v_fma_mix_f32 v89, v32, v62, v89 op_sel:[1,0,0] op_sel_hi:[1,0,0]
    v_fma_mix_f32 v90, v33, v62, v90 op_sel:[0,0,0] op_sel_hi:[1,0,0]
    v_fma_mix_f32 v91, v33, v62, v91 op_sel:[1,0,0] op_sel_hi:[1,0,0]
    v_fma_mix_f32 v92, v34, v62, v92 op_sel:[0,0,0] op_sel_hi:[1,0,0]
    v_fma_mix_f32 v93, v34, v62, v93 op_sel:[1,0,0] op_sel_hi:[1,0,0]
    v_fma_mix_f32 v94, v35, v62, v94 op_sel:[0,0,0] op_sel_hi:[1,0,0]
    v_fma_mix_f32 v95, v35, v62, v95 op_sel:[1,0,0] op_sel_hi:[1,0,0]
    v_fma_mix_f32 v96, v36, v62, v96 op_sel:[0,0,0] op_sel_hi:[1,0,0]
    v_fma_mix_f32 v97, v36, v62, v97 op_sel:[1,0,0] op_sel_hi:[1,0,0]
    v_fma_mix_f32 v98, v37, v62, v98 op_sel:[0,0,0] op_sel_hi:[1,0,0]
    v_fma_mix_f32 v99, v37, v62, v99 op_sel:[1,0,0] op_sel_hi:[1,0,0]
    v_fma_mix_f32 v100, v38, v62, v100 op_sel:[0,0,0] op_sel_hi:[1,0,0]
    v_fma_mix_f32 v101, v38, v62, v101 op_sel:[1,0,0] op_sel_hi:[1,0,0]
    v_fma_mix_f32 v102, v39, v62, v102 op_sel:[0,0,0] op_sel_hi:[1,0,0]
    v_fma_mix_f32 v103, v39, v62, v103 op_sel:[1,0,0] op_sel_hi:[1,0,0]
    v_fma_mix_f32 v104, v40, v62, v104 op_sel:[0,0,0] op_sel_hi:[1,0,0]
    v_fma_mix_f32 v105, v40, v62, v105 op_sel:[1,0,0] op_sel_hi:[1,0,0]
    v_fma_mix_f32 v106, v41, v62, v106 op_sel:[0,0,0] op_sel_hi:[1,0,0]
    v_fma_mix_f32 v107, v41, v62, v107 op_sel:[1,0,0] op_sel_hi:[1,0,0]
    s_waitcnt vmcnt(0)
    v_fma_mix_f32 v88, v44, v63, v88 op_sel:[0,0,0] op_sel_hi:[1,0,0]
    v_fma_mix_f32 v89, v44, v63, v89 op_sel:[1,0,0] op_sel_hi:[1,0,0]
    v_fma_mix_f32 v90, v45, v63, v90 op_sel:[0,0,0] op_sel_hi:[1,0,0]
    v_fma_mix_f32 v91, v45, v63, v91 op_sel:[1,0,0] op_sel_hi:[1,0,0]
    v_fma_mix_f32 v92, v46, v63, v92 op_sel:[0,0,0] op_sel_hi:[1,0,0]
    v_fma_mix_f32 v93, v46, v63, v93 op_sel:[1,0,0] op_sel_hi:[1,0,0]
    v_fma_mix_f32 v94, v47, v63, v94 op_sel:[0,0,0] op_sel_hi:[1,0,0]
    v_fma_mix_f32 v95, v47, v63, v95 op_sel:[1,0,0] op_sel_hi:[1,0,0]
    v_fma_mix_f32 v96, v48, v63, v96 op_sel:[0,0,0] op_sel_hi:[1,0,0]
    v_fma_mix_f32 v97, v48, v63, v97 op_sel:[1,0,0] op_sel_hi:[1,0,0]
    v_fma_mix_f32 v98, v49, v63, v98 op_sel:[0,0,0] op_sel_hi:[1,0,0]
    v_fma_mix_f32 v99, v49, v63, v99 op_sel:[1,0,0] op_sel_hi:[1,0,0]
    v_fma_mix_f32 v100, v50, v63, v100 op_sel:[0,0,0] op_sel_hi:[1,0,0]
    v_fma_mix_f32 v101, v50, v63, v101 op_sel:[1,0,0] op_sel_hi:[1,0,0]
    v_fma_mix_f32 v102, v51, v63, v102 op_sel:[0,0,0] op_sel_hi:[1,0,0]
    v_fma_mix_f32 v103, v51, v63, v103 op_sel:[1,0,0] op_sel_hi:[1,0,0]
    v_fma_mix_f32 v104, v52, v63, v104 op_sel:[0,0,0] op_sel_hi:[1,0,0]
    v_fma_mix_f32 v105, v52, v63, v105 op_sel:[1,0,0] op_sel_hi:[1,0,0]
    v_fma_mix_f32 v106, v53, v63, v106 op_sel:[0,0,0] op_sel_hi:[1,0,0]
    v_fma_mix_f32 v107, v53, v63, v107 op_sel:[1,0,0] op_sel_hi:[1,0,0]
    v_cvt_pk_bf16_f32 v108, v88, v89
    v_cvt_pk_bf16_f32 v109, v90, v91
    v_cvt_pk_bf16_f32 v110, v92, v93
    v_cvt_pk_bf16_f32 v111, v94, v95
    v_cvt_pk_bf16_f32 v112, v96, v97
    v_cvt_pk_bf16_f32 v113, v98, v99
    v_cvt_pk_bf16_f32 v114, v100, v101
    v_cvt_pk_bf16_f32 v115, v102, v103
    v_cvt_pk_bf16_f32 v116, v104, v105
    v_cvt_pk_bf16_f32 v117, v106, v107
    v_lshlrev_b32 v88, 16, v108
    v_and_b32 v89, 0xffff0000, v108
    v_lshlrev_b32 v90, 16, v109
    v_and_b32 v91, 0xffff0000, v109
    v_lshlrev_b32 v92, 16, v110
    v_and_b32 v93, 0xffff0000, v110
    v_lshlrev_b32 v94, 16, v111
    v_and_b32 v95, 0xffff0000, v111
    v_lshlrev_b32 v96, 16, v112
    v_and_b32 v97, 0xffff0000, v112
    v_lshlrev_b32 v98, 16, v113
    v_and_b32 v99, 0xffff0000, v113
    v_lshlrev_b32 v100, 16, v114
    v_and_b32 v101, 0xffff0000, v114
    v_lshlrev_b32 v102, 16, v115
    v_and_b32 v103, 0xffff0000, v115
    v_lshlrev_b32 v104, 16, v116
    v_and_b32 v105, 0xffff0000, v116
    v_lshlrev_b32 v106, 16, v117
    v_and_b32 v107, 0xffff0000, v117
    v_mul_f32 v88, v88, v148
    v_mul_f32 v89, v89, v149
    v_mul_f32 v90, v90, v150
    v_mul_f32 v91, v91, v151
    v_mul_f32 v92, v92, v152
    v_mul_f32 v93, v93, v153
    v_mul_f32 v94, v94, v154
    v_mul_f32 v95, v95, v155
    v_mul_f32 v96, v96, v156
    v_mul_f32 v97, v97, v157
    v_mul_f32 v98, v98, v158
    v_mul_f32 v99, v99, v159
    v_mul_f32 v100, v100, v160
    v_mul_f32 v101, v101, v161
    v_mul_f32 v102, v102, v162
    v_mul_f32 v103, v103, v163
    v_mul_f32 v104, v104, v164
    v_mul_f32 v105, v105, v165
    v_mul_f32 v106, v106, v166
    v_mul_f32 v107, v107, v167
    v_cvt_pk_bf16_f32 v108, v88, v89
    v_cvt_pk_bf16_f32 v109, v90, v91
    v_cvt_pk_bf16_f32 v110, v92, v93
    v_cvt_pk_bf16_f32 v111, v94, v95
    v_cvt_pk_bf16_f32 v112, v96, v97
    v_cvt_pk_bf16_f32 v113, v98, v99
    v_cvt_pk_bf16_f32 v114, v100, v101
    v_cvt_pk_bf16_f32 v115, v102, v103
    v_cvt_pk_bf16_f32 v116, v104, v105
    v_cvt_pk_bf16_f32 v117, v106, v107
    v_lshlrev_b32 v88, 16, v108
    v_and_b32 v89, 0xffff0000, v108
    v_lshlrev_b32 v90, 16, v109
    v_and_b32 v91, 0xffff0000, v109
    v_lshlrev_b32 v92, 16, v110
    v_and_b32 v93, 0xffff0000, v110
    v_lshlrev_b32 v94, 16, v111
    v_and_b32 v95, 0xffff0000, v111
    v_lshlrev_b32 v96, 16, v112
    v_and_b32 v97, 0xffff0000, v112
    v_lshlrev_b32 v98, 16, v113
    v_and_b32 v99, 0xffff0000, v113
    v_lshlrev_b32 v100, 16, v114
    v_and_b32 v101, 0xffff0000, v114
    v_lshlrev_b32 v102, 16, v115
    v_and_b32 v103, 0xffff0000, v115
    v_lshlrev_b32 v104, 16, v116
    v_and_b32 v105, 0xffff0000, v116
    v_lshlrev_b32 v106, 16, v117
    v_and_b32 v107, 0xffff0000, v117
    v_lshlrev_b32 v8, 16, v136
    v_and_b32 v9, 0xffff0000, v136
    v_lshlrev_b32 v10, 16, v137
    v_and_b32 v11, 0xffff0000, v137
    v_lshlrev_b32 v12, 16, v138
    v_and_b32 v13, 0xffff0000, v138
    v_lshlrev_b32 v14, 16, v139
    v_and_b32 v15, 0xffff0000, v139
    v_lshlrev_b32 v16, 16, v140
    v_and_b32 v17, 0xffff0000, v140
    v_lshlrev_b32 v18, 16, v141
    v_and_b32 v19, 0xffff0000, v141
    v_lshlrev_b32 v20, 16, v142
    v_and_b32 v21, 0xffff0000, v142
    v_lshlrev_b32 v22, 16, v143
    v_and_b32 v23, 0xffff0000, v143
    v_lshlrev_b32 v24, 16, v144
    v_and_b32 v25, 0xffff0000, v144
    v_lshlrev_b32 v26, 16, v145
    v_and_b32 v27, 0xffff0000, v145
    v_add_f32 v88, v88, v8
    v_add_f32 v89, v89, v9
    v_add_f32 v90, v90, v10
    v_add_f32 v91, v91, v11
    v_add_f32 v92, v92, v12
    v_add_f32 v93, v93, v13
    v_add_f32 v94, v94, v14
    v_add_f32 v95, v95, v15
    v_add_f32 v96, v96, v16
    v_add_f32 v97, v97, v17
    v_add_f32 v98, v98, v18
    v_add_f32 v99, v99, v19
    v_add_f32 v100, v100, v20
    v_add_f32 v101, v101, v21
    v_add_f32 v102, v102, v22
    v_add_f32 v103, v103, v23
    v_add_f32 v104, v104, v24
    v_add_f32 v105, v105, v25
    v_add_f32 v106, v106, v26
    v_add_f32 v107, v107, v27
    v_cvt_pk_bf16_f32 v108, v88, v89
    v_cvt_pk_bf16_f32 v109, v90, v91
    v_cvt_pk_bf16_f32 v110, v92, v93
    v_cvt_pk_bf16_f32 v111, v94, v95
    v_cvt_pk_bf16_f32 v112, v96, v97
    v_cvt_pk_bf16_f32 v113, v98, v99
    v_cvt_pk_bf16_f32 v114, v100, v101
    v_cvt_pk_bf16_f32 v115, v102, v103
    v_cvt_pk_bf16_f32 v116, v104, v105
    v_cvt_pk_bf16_f32 v117, v106, v107
    buffer_store_dwordx2 v[108:109], v2, s[8:11], s62 offen offset:0
    buffer_store_dwordx2 v[110:111], v2, s[8:11], s62 offen offset:32
    buffer_store_dwordx2 v[112:113], v2, s[8:11], s62 offen offset:64
    buffer_store_dwordx2 v[114:115], v2, s[8:11], s62 offen offset:96
    buffer_store_dwordx2 v[116:117], v2, s[8:11], s62 offen offset:128
K5_END:
    s_endpgm
.section .rodata,"a"
.p2align 6
.amdhsa_kernel k1_kernel
  .amdhsa_next_free_vgpr 128
  .amdhsa_next_free_sgpr 102
  .amdhsa_accum_offset 128
  .amdhsa_group_segment_fixed_size 0
  .amdhsa_kernarg_size 144
  .amdhsa_user_sgpr_count 2
  .amdhsa_user_sgpr_kernarg_segment_ptr 1
  .amdhsa_system_sgpr_workgroup_id_x 1
  .amdhsa_float_denorm_mode_32 3
.end_amdhsa_kernel
.section .rodata,"a"
.p2align 6
.amdhsa_kernel k2_kernel
  .amdhsa_next_free_vgpr 160
  .amdhsa_next_free_sgpr 102
  .amdhsa_accum_offset 160
  .amdhsa_group_segment_fixed_size 0
  .amdhsa_kernarg_size 144
  .amdhsa_user_sgpr_count 2
  .amdhsa_user_sgpr_kernarg_segment_ptr 1
  .amdhsa_system_sgpr_workgroup_id_x 1
  .amdhsa_float_denorm_mode_32 3
.end_amdhsa_kernel
.section .rodata,"a"
.p2align 6
.amdhsa_kernel k34_kernel
  .amdhsa_next_free_vgpr 432
  .amdhsa_next_free_sgpr 102
  .amdhsa_accum_offset 176
  .amdhsa_group_segment_fixed_size 0
  .amdhsa_kernarg_size 144
  .amdhsa_user_sgpr_count 2
  .amdhsa_user_sgpr_kernarg_segment_ptr 1
  .amdhsa_system_sgpr_workgroup_id_x 1
  .amdhsa_float_denorm_mode_32 3
.end_amdhsa_kernel
```
